```python
import torch

def _softmax(x, axis=-1):
    return torch.softmax(x, dim=axis)

def _gelu(x):
    return torch.nn.functional.gelu(x, approximate='tanh')

def _silu(x):
    return torch.nn.functional.silu(x)

def _sigmoid(x):
    return torch.sigmoid(x)

def _layernorm(x, axis=-1, eps=1e-05):
    m = x.mean(dim=axis, keepdim=True)
    v = x.var(dim=axis, keepdim=True, unbiased=False)
    return (x - m) / torch.sqrt(v + eps)

def _scatter_add(tgt, idx, src, axis=0):
    return tgt.clone().index_add_(axis, idx, src)

def _segment_sum(src, seg, n):
    out = torch.zeros((n,) + src.shape[1:], dtype=src.dtype)
    return out.index_add_(0, seg, src)

def _pad(x, pw):
    flat = tuple((v for pair in reversed(pw) for v in pair))
    return torch.nn.functional.pad(x, flat)
kernel_name = 'adaLN_cond__compressed_kv_cla__glu_gated_swiglu__prompt'

def setup_inputs():

    _w = lambda a: (lambda t: t.to(torch.bfloat16) if t.is_floating_point() else t)(torch.as_tensor(a))

    def _A_setup():
        B, H, Sq, Sk, D, M = (1, 32, 2048, 2048, 128, 512)
        Dc = 4 * D
        return {'x': _w((lambda *s: torch.randn(*s, dtype=torch.bfloat16) * 0.05)(B, Sq, M)), 'c_kv': _w((lambda *s: torch.randn(*s, dtype=torch.bfloat16) * 0.8)(B, Sk, Dc)), 'w_q': _w((lambda *s: torch.randn(*s, dtype=torch.bfloat16) * 1.6)(M, H, D) * M ** (-0.5)), 'w_uk': _w((lambda *s: torch.randn(*s, dtype=torch.bfloat16) * 1.6)(Dc, H, D) * Dc ** (-0.5)), 'w_uv': _w((lambda *s: torch.randn(*s, dtype=torch.bfloat16) * 0.8)(Dc, H, D) * Dc ** (-0.5)), 'w_o': _w((lambda *s: torch.randn(*s, dtype=torch.bfloat16) * 0.8)(H, D, M) * (H * D) ** (-0.5))}
    _A_in = _A_setup()

    def _B_setup():
        B, S, D, F = (1, 2048, 512, 1792)
        return {'x': _w((lambda *s: torch.randn(*s, dtype=torch.bfloat16) * 0.05)(B, S, D)), 'w1': _w((lambda *s: torch.randn(*s, dtype=torch.bfloat16) * 0.4)(D, F) * (2.0 / D) ** 0.5), 'w3': _w((lambda *s: torch.randn(*s, dtype=torch.bfloat16) * 0.4)(D, F) * (2.0 / D) ** 0.5), 'w2': _w((lambda *s: torch.randn(*s, dtype=torch.bfloat16) * 0.4)(F, D) * (2.0 / F) ** 0.5)}
    _B_in = _B_setup()
    return {'A_x': _A_in['x'], 'A_c_kv': _A_in['c_kv'], 'A_w_q': _A_in['w_q'], 'A_w_uk': _A_in['w_uk'], 'A_w_uv': _A_in['w_uv'], 'A_w_o': _A_in['w_o'], 'B_x': _B_in['x'], 'B_w1': _B_in['w1'], 'B_w3': _B_in['w3'], 'B_w2': _B_in['w2'], 'c': _w((lambda *s: torch.randn(*s, dtype=torch.bfloat16) * 0.1)(1, 512) * 8.0), 'w_mod': _w((lambda *s: torch.randn(*s, dtype=torch.bfloat16) * 0.1)(512, 6 * 512) * 512 ** (-0.5) * 8.0)}

def reference(A_x, A_c_kv, A_w_q, A_w_uk, A_w_uv, A_w_o, B_x, B_w1, B_w3, B_w2, c, w_mod):

    def _A_ref(x, c_kv, w_q, w_uk, w_uv, w_o):
        B, Sq, M = (x.shape[0], x.shape[1], x.shape[2])
        Sk = c_kv.shape[1]
        H, D = (w_q.shape[1], w_q.shape[2])
        q = torch.einsum('bqm,mhd->bhqd', x, w_q)
        k = torch.einsum('bkc,chd->bhkd', c_kv, w_uk)
        v = torch.einsum('bkc,chd->bhkd', c_kv, w_uv)
        scores = torch.einsum('bhqd,bhkd->bhqk', q, k) * D ** (-0.5)
        off = Sk - Sq
        qi = torch.arange(Sq)[:, None]
        kj = torch.arange(Sk)[None, :]
        cmask = kj <= qi + off
        scores = torch.where(cmask[None, None], scores, -1000000000.0)
        p = _softmax(scores, axis=-1)
        ctx = torch.einsum('bhqk,bhkd->bhqd', p, v)
        return torch.einsum('bhqd,hdm->bqm', ctx, w_o)

    def _B_ref(x, w1, w3, w2):
        gate = torch.einsum('bsd,df->bsf', x, w1)
        up = torch.einsum('bsd,df->bsf', x, w3)
        h = _silu(gate) * up
        out = torch.einsum('bsf,fd->bsd', h, w2)
        return out
    x = A_x
    mod = (_silu(c) @ w_mod).reshape(c.shape[0], 6, 1, -1)
    sa, ca, ga, sb, cb, gb = (mod[:, 0].clone(), mod[:, 1].clone(), mod[:, 2].clone(), mod[:, 3].clone(), mod[:, 4].clone(), mod[:, 5].clone())
    h = _layernorm(x, axis=-1) * (1 + ca) + sa
    x = x + ga * _A_ref(h, A_c_kv, A_w_q, A_w_uk, A_w_uv, A_w_o)
    h = _layernorm(x, axis=-1) * (1 + cb) + sb
    x = x + gb * _B_ref(h, B_w1, B_w3, B_w2)
    return x
```

```asm
; @launch kernel=kvattn_kernel grid=(256,1,1) block=(512,1,1) lds=163840
.amdgcn_target "amdgcn-amd-amdhsa--gfx950"
.text
.globl kvattn_kernel
.p2align 8
.type kvattn_kernel,@function
kvattn_kernel:
  s_cmp_ge_u32 s2, 256
  s_cbranch_scc1 kvattn_kernel_done
  s_load_dwordx2 s[4:5], s[0:1], 8
  s_load_dwordx2 s[6:7], s[0:1], 24
  s_load_dwordx2 s[8:9], s[0:1], 32
  s_load_dwordx2 s[10:11], s[0:1], 112
  s_load_dwordx2 s[52:53], s[0:1], 80
  s_load_dwordx2 s[54:55], s[0:1], 88
  s_load_dwordx2 s[56:57], s[0:1], 0
  s_load_dwordx2 s[58:59], s[0:1], 104
  s_load_dwordx2 s[60:61], s[0:1], 16
  s_load_dwordx4 s[88:91], s[0:1], 56
  s_load_dwordx2 s[86:87], s[0:1], 72
  s_load_dwordx2 s[92:93], s[0:1], 96
  s_load_dwordx2 s[94:95], s[0:1], 0
  v_lshrrev_b32 v1, 6, v0
  v_and_b32 v0, 63, v0
  v_readfirstlane_b32 s12, v1
  s_and_b32 s13, s2, 7
  s_lshl_b32 s13, s13, 2
  s_bfe_u32 s14, s2, 0x20003
  s_add_u32 s13, s13, s14
  s_lshr_b32 s14, s2, 5
  v_lshrrev_b32 v32, 4, v0
  v_lshlrev_b32 v33, 1, v32
  v_and_b32 v1, 15, v0
  v_xor_b32 v1, v1, v33
  s_and_b32 s15, s12, 1
  s_lshl_b32 s15, s15, 3
  v_xor_b32 v1, s15, v1
  v_lshlrev_b32 v1, 4, v1
  v_lshl_add_u32 v1, v32, 13, v1
  s_lshl_b32 s15, s12, 16
  v_add_u32 v1, s15, v1
  v_and_b32 v254, 7, v0
  v_xor_b32 v254, v254, v32
  v_lshlrev_b32 v254, 4, v254
  v_lshrrev_b32 v33, 3, v0
  v_lshl_add_u32 v254, v33, 10, v254
  v_xor_b32 v255, 64, v254
  s_lshl_b32 s16, s12, 13
  s_add_u32 s16, s16, 98304
  s_lshl_b32 s40, s14, 3
  s_add_u32 s40, s40, s12
  s_lshl_b32 s41, s40, 15
  s_lshl_b32 s45, s13, 8
  s_lshl_b32 s46, s12, 11
  s_waitcnt lgkmcnt(0)
  s_mov_b32 s20, s4
  s_mov_b32 s21, s5
  s_mov_b32 s22, 0x200000
  s_mov_b32 s23, 0x20000
  s_mov_b32 s24, s6
  s_mov_b32 s25, s7
  s_mov_b32 s26, 0x400000
  s_mov_b32 s27, 0x20000
  s_add_u32 m0, s46, 0
  s_add_u32 s47, s45, 0
  buffer_load_dwordx4 v1, s[24:27], s47 offen offset:0 lds
  s_add_u32 m0, s46, 0
  s_add_u32 s47, s45, 31744
  buffer_load_dwordx4 v1, s[24:27], s47 offen offset:1024 lds
  s_add_u32 m0, s16, 0
  s_add_u32 s47, s41, 0
  buffer_load_dwordx4 v254, s[20:23], s47 offen offset:0 lds
  s_add_u32 m0, s16, 0
  s_add_u32 s47, s41, 7168
  buffer_load_dwordx4 v255, s[20:23], s47 offen offset:1024 lds
  s_add_u32 m0, s16, 0
  s_add_u32 s47, s41, 14336
  buffer_load_dwordx4 v254, s[20:23], s47 offen offset:2048 lds
  s_add_u32 m0, s16, 0
  s_add_u32 s47, s41, 21504
  buffer_load_dwordx4 v255, s[20:23], s47 offen offset:3072 lds
  s_mov_b32 s36, s10
  s_mov_b32 s37, s11
  s_mov_b32 s38, 0x3000
  s_mov_b32 s39, 0x20000
  s_add_u32 s96, s10, 0x8000
  s_addc_u32 s97, s11, 0
  s_mov_b32 s98, 0x68080
  s_mov_b32 s99, 0x20000
  v_lshlrev_b32 v2, 4, v0
  s_load_dword s85, s[10:11], 0x70000
  s_lshl_b32 s101, s13, 3
  s_add_u32 s101, s101, s14
  s_lshl_b32 s101, s101, 3
  s_add_u32 s101, s101, s12
  s_lshl_b32 s101, s101, 7
  s_add_u32 s101, s101, 0x10000
  s_lshl_b32 s62, s12, 3
  s_add_u32 s62, s62, s14
  s_lshl_b32 s62, s62, 2
  s_and_b32 s47, s13, 3
  s_add_u32 s62, s62, s47
  s_lshl_b32 s62, s62, 7
  s_and_b32 s47, s13, 28
  s_add_u32 s62, s62, s47
  s_add_u32 s62, s62, 327680
  s_mov_b64 exec, 1
  buffer_load_dword v60, off, s[96:99], s101 sc1
  buffer_load_dword v61, off, s[96:99], s62 sc1
  s_mov_b64 exec, -1
  s_mov_b32 s32, s54
  s_mov_b32 s33, s55
  s_mov_b32 s34, 0x300000
  s_mov_b32 s35, 0x20000
  v_and_b32 v33, 7, v0
  v_min_u32 v33, 5, v33
  v_lshlrev_b32 v33, 7, v33
  v_bfe_u32 v3, v0, 3, 1
  v_mul_u32_u24 v3, 6144, v3
  v_add_u32 v3, v33, v3
  s_lshr_b32 s42, s2, 3
  s_lshl_b32 s42, s42, 3
  s_add_u32 s42, s42, s12
  s_mul_i32 s42, s42, 12288
  s_and_b32 s62, s2, 7
  s_mul_i32 s62, s62, 768
  s_add_u32 s42, s42, s62
  buffer_load_dword v3, v3, s[32:35], s42 offen
  s_lshl_b32 s43, s13, 19
  s_lshl_b32 s44, s40, 13
  s_add_u32 s43, s43, s44
  s_add_u32 s44, s43, 4096
  s_lshl_b32 s15, s13, 19
  v_bfe_u32 v32, v0, 2, 2
  v_lshrrev_b32 v33, 4, v0
  v_lshl_add_u32 v33, v33, 3, v32
  v_lshlrev_b32 v33, 8, v33
  v_bfe_u32 v32, v0, 2, 3
  v_lshl_add_u32 v33, v32, 5, v33
  v_and_b32 v32, 3, v0
  v_lshl_add_u32 v4, v32, 3, v33
  v_xor_b32 v5, 32, v4
  v_xor_b32 v6, 64, v4
  v_xor_b32 v7, 96, v4
  v_xor_b32 v8, 128, v4
  v_xor_b32 v9, 160, v4
  v_xor_b32 v10, 192, v4
  v_xor_b32 v11, 224, v4
  v_and_b32 v32, 15, v0
  v_bfe_u32 v33, v0, 1, 3
  v_lshrrev_b32 v40, 4, v0
  v_xor_b32 v40, v40, v33
  v_lshlrev_b32 v40, 4, v40
  v_lshl_add_u32 v40, v32, 7, v40
  v_add_u32 v40, s16, v40
  v_xor_b32 v41, 64, v40
  s_mov_b32 s28, s52
  s_mov_b32 s29, s53
  s_mov_b32 s30, 0x400
  s_mov_b32 s31, 0x20000
  s_and_b32 s17, s2, 7
  s_mul_i32 s17, s17, 24
  s_lshr_b32 s18, s2, 3
  s_add_u32 s17, s17, s18
  s_cmp_lt_u32 s18, 24
  s_cselect_b32 s17, s17, 0x100000
  v_lshrrev_b32 v42, 1, v0
  v_mul_u32_u24 v42, 6144, v42
  v_and_b32 v43, 1, v0
  v_lshl_add_u32 v42, v43, 4, v42
  v_lshlrev_b32 v43, 1, v0
  s_lshl_b32 s18, s17, 5
  s_mul_i32 s19, s12, 393216
  s_add_u32 s18, s18, s19
  s_lshl_b32 s19, s12, 7
  s_lshl_b32 s63, s13, 3
  s_add_u32 s63, s63, s12
  s_sub_u32 s62, 14, s14
  s_cmp_lt_u32 s63, 128
  s_cselect_b32 s62, s14, s62
  s_lshl_b32 s62, s62, 7
  s_add_u32 s63, s63, s62
  s_lshl_b32 s100, s13, 3
  s_add_u32 s100, s100, s14
  s_lshl_b32 s100, s100, 7
  s_cmp_eq_u32 s12, 0
  s_cselect_b32 s100, s100, 16777216
  s_mov_b64 exec, 1
  buffer_load_dword v62, off, s[96:99], s100 sc1
  s_and_b32 s62, s2, 127
  s_lshl_b32 s62, s62, 7
  s_add_u32 s62, s62, 0x8000
  s_cmp_eq_u32 s12, 2
  s_cselect_b32 s62, s62, 16777216
  buffer_load_dword v59, off, s[96:99], s62 sc1
  s_mov_b64 exec, -1
  s_barrier
  s_add_u32 m0, s16, 4096
  s_add_u32 s47, s41, 128
  buffer_load_dwordx4 v254, s[20:23], s47 offen offset:0 lds
  s_add_u32 m0, s16, 4096
  s_add_u32 s47, s41, 7296
  buffer_load_dwordx4 v255, s[20:23], s47 offen offset:1024 lds
  s_add_u32 m0, s16, 4096
  s_add_u32 s47, s41, 14464
  buffer_load_dwordx4 v254, s[20:23], s47 offen offset:2048 lds
  s_add_u32 m0, s16, 4096
  s_add_u32 s47, s41, 21632
  buffer_load_dwordx4 v255, s[20:23], s47 offen offset:3072 lds
  s_add_u32 m0, s46, 16384
  s_add_u32 s47, s45, 524288
  buffer_load_dwordx4 v1, s[24:27], s47 offen offset:0 lds
  s_add_u32 m0, s46, 16384
  s_add_u32 s47, s45, 556032
  buffer_load_dwordx4 v1, s[24:27], s47 offen offset:1024 lds
  s_mov_b32 s52, s60
  s_mov_b32 s53, s61
  s_mov_b32 s54, 0x400000
  s_mov_b32 s55, 0x20000
  v_bfe_u32 v33, v0, 1, 3
  v_lshlrev_b32 v33, 13, v33
  v_and_b32 v58, 1, v0
  v_lshl_add_u32 v33, v58, 7, v33
  s_waitcnt vmcnt(11)
  ds_read_b128 v[128:131], v40 offset:0
  ds_read_b128 v[132:135], v40 offset:2048
  ds_read_b128 v[136:139], v41 offset:0
  ds_read_b128 v[140:143], v41 offset:2048
  s_waitcnt lgkmcnt(0)
  s_add_u32 s85, s85, 1
  s_bitset1_b32 s85, 15
  s_barrier
  ds_read_b64_tr_b16 v[12:13], v4 offset:0
  ds_read_b64_tr_b16 v[14:15], v4 offset:1024
  ds_read_b64_tr_b16 v[16:17], v5 offset:0
  ds_read_b64_tr_b16 v[18:19], v5 offset:1024
  ds_read_b64_tr_b16 v[20:21], v6 offset:0
  ds_read_b64_tr_b16 v[22:23], v6 offset:1024
  ds_read_b64_tr_b16 v[24:25], v7 offset:0
  ds_read_b64_tr_b16 v[26:27], v7 offset:1024
  s_waitcnt lgkmcnt(6)
  v_mfma_f32_16x16x32_bf16 v[64:67], v[12:15], v[128:131], 0
  ds_read_b64_tr_b16 v[28:29], v8 offset:0
  v_mfma_f32_16x16x32_bf16 v[68:71], v[12:15], v[132:135], 0
  ds_read_b64_tr_b16 v[30:31], v8 offset:1024
  s_add_u32 m0, s46, 32768
  s_add_u32 s47, s45, 1048576
  buffer_load_dwordx4 v1, s[24:27], s47 offen offset:0 lds
  s_waitcnt lgkmcnt(6)
  v_mfma_f32_16x16x32_bf16 v[72:75], v[16:19], v[128:131], 0
  ds_read_b64_tr_b16 v[12:13], v9 offset:0
  v_mfma_f32_16x16x32_bf16 v[76:79], v[16:19], v[132:135], 0
  ds_read_b64_tr_b16 v[14:15], v9 offset:1024
  s_add_u32 m0, s46, 32768
  s_add_u32 s47, s45, 1080320
  buffer_load_dwordx4 v1, s[24:27], s47 offen offset:1024 lds
  s_waitcnt lgkmcnt(6)
  v_mfma_f32_16x16x32_bf16 v[80:83], v[20:23], v[128:131], 0
  ds_read_b64_tr_b16 v[16:17], v10 offset:0
  v_mfma_f32_16x16x32_bf16 v[84:87], v[20:23], v[132:135], 0
  ds_read_b64_tr_b16 v[18:19], v10 offset:1024
  s_add_u32 m0, s46, 49152
  s_add_u32 s47, s45, 1572864
  buffer_load_dwordx4 v1, s[24:27], s47 offen offset:0 lds
  s_waitcnt lgkmcnt(6)
  v_mfma_f32_16x16x32_bf16 v[88:91], v[24:27], v[128:131], 0
  ds_read_b64_tr_b16 v[20:21], v11 offset:0
  v_mfma_f32_16x16x32_bf16 v[92:95], v[24:27], v[132:135], 0
  ds_read_b64_tr_b16 v[22:23], v11 offset:1024
  s_waitcnt lgkmcnt(6)
  v_mfma_f32_16x16x32_bf16 v[96:99], v[28:31], v[128:131], 0
  ds_read_b64_tr_b16 v[24:25], v4 offset:8192
  v_mfma_f32_16x16x32_bf16 v[100:103], v[28:31], v[132:135], 0
  ds_read_b64_tr_b16 v[26:27], v4 offset:9216
  s_add_u32 m0, s46, 49152
  s_add_u32 s47, s45, 1604608
  buffer_load_dwordx4 v1, s[24:27], s47 offen offset:1024 lds
  s_add_u32 m0, s16, 0
  s_add_u32 s47, s41, 256
  buffer_load_dwordx4 v254, s[20:23], s47 offen offset:0 lds
  s_waitcnt lgkmcnt(6)
  v_mfma_f32_16x16x32_bf16 v[104:107], v[12:15], v[128:131], 0
  ds_read_b64_tr_b16 v[28:29], v5 offset:8192
  v_mfma_f32_16x16x32_bf16 v[108:111], v[12:15], v[132:135], 0
  ds_read_b64_tr_b16 v[30:31], v5 offset:9216
  s_waitcnt lgkmcnt(6)
  v_mfma_f32_16x16x32_bf16 v[112:115], v[16:19], v[128:131], 0
  ds_read_b64_tr_b16 v[12:13], v6 offset:8192
  v_mfma_f32_16x16x32_bf16 v[116:119], v[16:19], v[132:135], 0
  ds_read_b64_tr_b16 v[14:15], v6 offset:9216
  s_waitcnt vmcnt(7)
  ds_read_b128 v[144:147], v40 offset:4096
  ds_read_b128 v[148:151], v40 offset:6144
  ds_read_b128 v[152:155], v41 offset:4096
  ds_read_b128 v[156:159], v41 offset:6144
  s_waitcnt lgkmcnt(10)
  v_mfma_f32_16x16x32_bf16 v[120:123], v[20:23], v[128:131], 0
  ds_read_b64_tr_b16 v[16:17], v7 offset:8192
  v_mfma_f32_16x16x32_bf16 v[124:127], v[20:23], v[132:135], 0
  ds_read_b64_tr_b16 v[18:19], v7 offset:9216
  s_add_u32 m0, s16, 0
  s_add_u32 s47, s41, 7424
  buffer_load_dwordx4 v255, s[20:23], s47 offen offset:1024 lds
  s_waitcnt lgkmcnt(10)
  v_mfma_f32_16x16x32_bf16 v[64:67], v[24:27], v[136:139], v[64:67]
  ds_read_b64_tr_b16 v[20:21], v8 offset:8192
  v_mfma_f32_16x16x32_bf16 v[68:71], v[24:27], v[140:143], v[68:71]
  ds_read_b64_tr_b16 v[22:23], v8 offset:9216
  s_waitcnt lgkmcnt(10)
  v_mfma_f32_16x16x32_bf16 v[72:75], v[28:31], v[136:139], v[72:75]
  ds_read_b64_tr_b16 v[24:25], v9 offset:8192
  v_mfma_f32_16x16x32_bf16 v[76:79], v[28:31], v[140:143], v[76:79]
  ds_read_b64_tr_b16 v[26:27], v9 offset:9216
  s_waitcnt lgkmcnt(10)
  v_mfma_f32_16x16x32_bf16 v[80:83], v[12:15], v[136:139], v[80:83]
  ds_read_b64_tr_b16 v[28:29], v10 offset:8192
  v_mfma_f32_16x16x32_bf16 v[84:87], v[12:15], v[140:143], v[84:87]
  ds_read_b64_tr_b16 v[30:31], v10 offset:9216
  s_add_u32 m0, s16, 0
  s_add_u32 s47, s41, 14592
  buffer_load_dwordx4 v254, s[20:23], s47 offen offset:2048 lds
  s_waitcnt lgkmcnt(6)
  v_mfma_f32_16x16x32_bf16 v[88:91], v[16:19], v[136:139], v[88:91]
  ds_read_b64_tr_b16 v[12:13], v11 offset:8192
  v_mfma_f32_16x16x32_bf16 v[92:95], v[16:19], v[140:143], v[92:95]
  ds_read_b64_tr_b16 v[14:15], v11 offset:9216
  s_waitcnt lgkmcnt(6)
  v_mfma_f32_16x16x32_bf16 v[96:99], v[20:23], v[136:139], v[96:99]
  s_waitcnt vmcnt(7)
  s_barrier
  ds_read_b64_tr_b16 v[16:17], v4 offset:16384
  v_mfma_f32_16x16x32_bf16 v[100:103], v[20:23], v[140:143], v[100:103]
  ds_read_b64_tr_b16 v[18:19], v4 offset:17408
  s_waitcnt lgkmcnt(6)
  v_mfma_f32_16x16x32_bf16 v[104:107], v[24:27], v[136:139], v[104:107]
  ds_read_b64_tr_b16 v[20:21], v5 offset:16384
  v_mfma_f32_16x16x32_bf16 v[108:111], v[24:27], v[140:143], v[108:111]
  ds_read_b64_tr_b16 v[22:23], v5 offset:17408
  s_add_u32 m0, s16, 0
  s_add_u32 s47, s41, 21760
  buffer_load_dwordx4 v255, s[20:23], s47 offen offset:3072 lds
  s_waitcnt lgkmcnt(6)
  v_mfma_f32_16x16x32_bf16 v[112:115], v[28:31], v[136:139], v[112:115]
  ds_read_b64_tr_b16 v[24:25], v6 offset:16384
  v_mfma_f32_16x16x32_bf16 v[116:119], v[28:31], v[140:143], v[116:119]
  ds_read_b64_tr_b16 v[26:27], v6 offset:17408
  buffer_load_ushort v36, v43, s[28:31], s19 offen
  s_add_u32 m0, s46, 81920
  s_add_u32 s47, s18, 0
  buffer_load_dwordx4 v42, s[32:35], s47 offen lds
  s_waitcnt lgkmcnt(6)
  v_mfma_f32_16x16x32_bf16 v[120:123], v[12:15], v[136:139], v[120:123]
  ds_read_b64_tr_b16 v[28:29], v7 offset:16384
  v_mfma_f32_16x16x32_bf16 v[124:127], v[12:15], v[140:143], v[124:127]
  ds_read_b64_tr_b16 v[30:31], v7 offset:17408
  s_waitcnt lgkmcnt(6)
  v_mfma_f32_16x16x32_bf16 v[64:67], v[16:19], v[144:147], v[64:67]
  ds_read_b64_tr_b16 v[12:13], v8 offset:16384
  v_mfma_f32_16x16x32_bf16 v[68:71], v[16:19], v[148:151], v[68:71]
  ds_read_b64_tr_b16 v[14:15], v8 offset:17408
  s_add_u32 m0, s46, 82944
  s_add_u32 s47, s18, 196608
  buffer_load_dwordx4 v42, s[32:35], s47 offen lds
  s_waitcnt lgkmcnt(6)
  v_mfma_f32_16x16x32_bf16 v[72:75], v[20:23], v[144:147], v[72:75]
  ds_read_b64_tr_b16 v[16:17], v9 offset:16384
  v_mfma_f32_16x16x32_bf16 v[76:79], v[20:23], v[148:151], v[76:79]
  ds_read_b64_tr_b16 v[18:19], v9 offset:17408
  s_mov_b32 s28, s8
  s_mov_b32 s29, s9
  s_mov_b32 s30, 0x400000
  s_mov_b32 s31, 0x20000
  s_add_u32 s32, s10, 0x1000000
  s_addc_u32 s33, s11, 0
  s_mov_b32 s34, 0x1000000
  s_mov_b32 s35, 0x20000
  s_add_u32 m0, s46, 65536
  s_add_u32 s47, s45, 2097152
  buffer_load_dwordx4 v1, s[24:27], s47 offen offset:0 lds
  s_waitcnt lgkmcnt(6)
  v_mfma_f32_16x16x32_bf16 v[80:83], v[24:27], v[144:147], v[80:83]
  ds_read_b64_tr_b16 v[20:21], v10 offset:16384
  v_mfma_f32_16x16x32_bf16 v[84:87], v[24:27], v[148:151], v[84:87]
  ds_read_b64_tr_b16 v[22:23], v10 offset:17408
  s_waitcnt lgkmcnt(6)
  v_mfma_f32_16x16x32_bf16 v[88:91], v[28:31], v[144:147], v[88:91]
  ds_read_b64_tr_b16 v[24:25], v11 offset:16384
  v_mfma_f32_16x16x32_bf16 v[92:95], v[28:31], v[148:151], v[92:95]
  ds_read_b64_tr_b16 v[26:27], v11 offset:17408
  s_add_u32 m0, s46, 65536
  s_add_u32 s47, s45, 2128896
  buffer_load_dwordx4 v1, s[24:27], s47 offen offset:1024 lds
  s_waitcnt lgkmcnt(6)
  v_mfma_f32_16x16x32_bf16 v[96:99], v[12:15], v[144:147], v[96:99]
  ds_read_b64_tr_b16 v[28:29], v4 offset:24576
  v_mfma_f32_16x16x32_bf16 v[100:103], v[12:15], v[148:151], v[100:103]
  ds_read_b64_tr_b16 v[30:31], v4 offset:25600
  s_add_u32 m0, s16, 4096
  s_add_u32 s47, s41, 384
  buffer_load_dwordx4 v254, s[20:23], s47 offen offset:0 lds
  s_waitcnt lgkmcnt(6)
  v_mfma_f32_16x16x32_bf16 v[104:107], v[16:19], v[144:147], v[104:107]
  ds_read_b64_tr_b16 v[12:13], v5 offset:24576
  v_mfma_f32_16x16x32_bf16 v[108:111], v[16:19], v[148:151], v[108:111]
  ds_read_b64_tr_b16 v[14:15], v5 offset:25600
  s_waitcnt lgkmcnt(6)
  v_mfma_f32_16x16x32_bf16 v[112:115], v[20:23], v[144:147], v[112:115]
  ds_read_b64_tr_b16 v[16:17], v6 offset:24576
  v_mfma_f32_16x16x32_bf16 v[116:119], v[20:23], v[148:151], v[116:119]
  ds_read_b64_tr_b16 v[18:19], v6 offset:25600
  s_waitcnt vmcnt(6)
  ds_read_b128 v[160:163], v40 offset:0
  ds_read_b128 v[164:167], v40 offset:2048
  ds_read_b128 v[168:171], v41 offset:0
  ds_read_b128 v[172:175], v41 offset:2048
  s_waitcnt lgkmcnt(10)
  v_mfma_f32_16x16x32_bf16 v[120:123], v[24:27], v[144:147], v[120:123]
  ds_read_b64_tr_b16 v[20:21], v7 offset:24576
  v_mfma_f32_16x16x32_bf16 v[124:127], v[24:27], v[148:151], v[124:127]
  ds_read_b64_tr_b16 v[22:23], v7 offset:25600
  s_add_u32 m0, s16, 4096
  s_add_u32 s47, s41, 7552
  buffer_load_dwordx4 v255, s[20:23], s47 offen offset:1024 lds
  s_waitcnt lgkmcnt(10)
  v_mfma_f32_16x16x32_bf16 v[64:67], v[28:31], v[152:155], v[64:67]
  ds_read_b64_tr_b16 v[24:25], v8 offset:24576
  v_mfma_f32_16x16x32_bf16 v[68:71], v[28:31], v[156:159], v[68:71]
  ds_read_b64_tr_b16 v[26:27], v8 offset:25600
  v_lshrrev_b32 v38, 4, v0
  v_bfe_u32 v39, v0, 2, 2
  v_lshlrev_b32 v38, 8, v38
  s_waitcnt lgkmcnt(10)
  v_mfma_f32_16x16x32_bf16 v[72:75], v[12:15], v[152:155], v[72:75]
  ds_read_b64_tr_b16 v[28:29], v9 offset:24576
  v_mfma_f32_16x16x32_bf16 v[76:79], v[12:15], v[156:159], v[76:79]
  ds_read_b64_tr_b16 v[30:31], v9 offset:25600
  v_lshl_add_u32 v38, v39, 5, v38
  v_and_b32 v39, 3, v0
  v_lshl_add_u32 v38, v39, 3, v38
  s_waitcnt lgkmcnt(10)
  v_mfma_f32_16x16x32_bf16 v[80:83], v[16:19], v[152:155], v[80:83]
  ds_read_b64_tr_b16 v[12:13], v10 offset:24576
  v_mfma_f32_16x16x32_bf16 v[84:87], v[16:19], v[156:159], v[84:87]
  ds_read_b64_tr_b16 v[14:15], v10 offset:25600
  s_add_u32 m0, s16, 4096
  s_add_u32 s47, s41, 14720
  buffer_load_dwordx4 v254, s[20:23], s47 offen offset:2048 lds
  s_add_u32 s18, s46, 81920
  v_add_u32 v38, s18, v38
  s_waitcnt vmcnt(5)
  s_waitcnt lgkmcnt(6)
  v_mfma_f32_16x16x32_bf16 v[88:91], v[20:23], v[152:155], v[88:91]
  ds_read_b64_tr_b16 v[16:17], v11 offset:24576
  v_mfma_f32_16x16x32_bf16 v[92:95], v[20:23], v[156:159], v[92:95]
  ds_read_b64_tr_b16 v[18:19], v11 offset:25600
  v_lshlrev_b32 v36, 16, v36
  v_mul_f32 v37, 0xbfb8aa3b, v36
  v_exp_f32 v37, v37
  s_waitcnt lgkmcnt(6)
  v_mfma_f32_16x16x32_bf16 v[96:99], v[24:27], v[152:155], v[96:99]
  s_barrier
  ds_read_b64_tr_b16 v[20:21], v4 offset:32768
  v_mfma_f32_16x16x32_bf16 v[100:103], v[24:27], v[156:159], v[100:103]
  ds_read_b64_tr_b16 v[22:23], v4 offset:33792
  ds_read_b64_tr_b16 v[48:49], v38 offset:0
  ds_read_b64_tr_b16 v[50:51], v38 offset:128
  ds_read_b64_tr_b16 v[52:53], v38 offset:1024
  s_waitcnt lgkmcnt(9)
  v_mfma_f32_16x16x32_bf16 v[104:107], v[28:31], v[152:155], v[104:107]
  ds_read_b64_tr_b16 v[24:25], v5 offset:32768
  v_mfma_f32_16x16x32_bf16 v[108:111], v[28:31], v[156:159], v[108:111]
  ds_read_b64_tr_b16 v[26:27], v5 offset:33792
  s_add_u32 m0, s16, 4096
  s_add_u32 s47, s41, 21888
  buffer_load_dwordx4 v255, s[20:23], s47 offen offset:3072 lds
  ds_read_b64_tr_b16 v[54:55], v38 offset:1152
  v_add_f32 v37, 1.0, v37
  v_rcp_f32 v37, v37
  s_waitcnt lgkmcnt(10)
  v_mfma_f32_16x16x32_bf16 v[112:115], v[12:15], v[152:155], v[112:115]
  ds_read_b64_tr_b16 v[28:29], v6 offset:32768
  v_mfma_f32_16x16x32_bf16 v[116:119], v[12:15], v[156:159], v[116:119]
  ds_read_b64_tr_b16 v[30:31], v6 offset:33792
  v_lshl_add_u32 v39, v0, 1, s18
  v_lshrrev_b32 v38, 4, v0
  v_mul_f32 v36, v36, v37
  s_waitcnt lgkmcnt(10)
  v_mfma_f32_16x16x32_bf16 v[120:123], v[16:19], v[152:155], v[120:123]
  ds_read_b64_tr_b16 v[12:13], v7 offset:32768
  v_mfma_f32_16x16x32_bf16 v[124:127], v[16:19], v[156:159], v[124:127]
  ds_read_b64_tr_b16 v[14:15], v7 offset:33792
  v_lshl_add_u32 v38, v38, 4, s18
  v_cvt_pk_bf16_f32 v36, v36, v36
  ds_write_b16 v39, v36
  s_waitcnt lgkmcnt(11)
  v_mfma_f32_16x16x32_bf16 v[64:67], v[20:23], v[160:163], v[64:67]
  ds_read_b64_tr_b16 v[16:17], v8 offset:32768
  v_mfma_f32_16x16x32_bf16 v[68:71], v[20:23], v[164:167], v[68:71]
  ds_read_b64_tr_b16 v[18:19], v8 offset:33792
  ds_read_b128 v[56:59], v38
  ds_read_b128 v[60:63], v38 offset:64
  v_and_b32 v39, 15, v0
  s_waitcnt lgkmcnt(10)
  v_mfma_f32_16x16x32_bf16 v[72:75], v[24:27], v[160:163], v[72:75]
  ds_read_b64_tr_b16 v[20:21], v9 offset:32768
  v_mfma_f32_16x16x32_bf16 v[76:79], v[24:27], v[164:167], v[76:79]
  ds_read_b64_tr_b16 v[22:23], v9 offset:33792
  s_add_u32 m0, s46, 0
  s_add_u32 s47, s45, 2621440
  buffer_load_dwordx4 v1, s[24:27], s47 offen offset:0 lds
  v_lshlrev_b32 v39, 2, v39
  v_add_u32 v38, s18, v39
  s_waitcnt lgkmcnt(9)
  v_mfma_f32_16x16x32_bf16 v[80:83], v[28:31], v[160:163], v[80:83]
  ds_read_b64_tr_b16 v[24:25], v10 offset:32768
  v_mfma_f32_16x16x32_bf16 v[84:87], v[28:31], v[164:167], v[84:87]
  ds_read_b64_tr_b16 v[26:27], v10 offset:33792
  s_waitcnt lgkmcnt(9)
  v_mfma_f32_16x16x32_bf16 v[88:91], v[12:15], v[160:163], v[88:91]
  ds_read_b64_tr_b16 v[28:29], v11 offset:32768
  v_mfma_f32_16x16x32_bf16 v[92:95], v[12:15], v[164:167], v[92:95]
  ds_read_b64_tr_b16 v[30:31], v11 offset:33792
  s_add_u32 m0, s46, 0
  s_add_u32 s47, s45, 2653184
  buffer_load_dwordx4 v1, s[24:27], s47 offen offset:1024 lds
  s_waitcnt lgkmcnt(6)
  v_mfma_f32_16x16x32_bf16 v[44:47], v[56:59], v[48:51], 0
  v_mfma_f32_16x16x32_bf16 v[44:47], v[60:63], v[52:55], v[44:47]
  v_mfma_f32_16x16x32_bf16 v[96:99], v[16:19], v[160:163], v[96:99]
  ds_read_b64_tr_b16 v[12:13], v4 offset:40960
  v_mfma_f32_16x16x32_bf16 v[100:103], v[16:19], v[164:167], v[100:103]
  ds_read_b64_tr_b16 v[14:15], v4 offset:41984
  s_add_u32 m0, s16, 0
  s_add_u32 s47, s41, 512
  buffer_load_dwordx4 v254, s[20:23], s47 offen offset:0 lds
  s_waitcnt lgkmcnt(6)
  v_mfma_f32_16x16x32_bf16 v[104:107], v[20:23], v[160:163], v[104:107]
  ds_read_b64_tr_b16 v[16:17], v5 offset:40960
  v_mfma_f32_16x16x32_bf16 v[108:111], v[20:23], v[164:167], v[108:111]
  ds_read_b64_tr_b16 v[18:19], v5 offset:41984
  s_waitcnt lgkmcnt(6)
  v_mfma_f32_16x16x32_bf16 v[112:115], v[24:27], v[160:163], v[112:115]
  ds_read_b64_tr_b16 v[20:21], v6 offset:40960
  v_mfma_f32_16x16x32_bf16 v[116:119], v[24:27], v[164:167], v[116:119]
  ds_read_b64_tr_b16 v[22:23], v6 offset:41984
  s_waitcnt vmcnt(3)
  ds_read_b128 v[176:179], v40 offset:4096
  ds_read_b128 v[180:183], v40 offset:6144
  ds_read_b128 v[184:187], v41 offset:4096
  ds_read_b128 v[188:191], v41 offset:6144
  ds_write_b32 v38, v44 offset:128
  v_add_u32 v38, 82048, v39
  s_waitcnt lgkmcnt(11)
  v_mfma_f32_16x16x32_bf16 v[120:123], v[28:31], v[160:163], v[120:123]
  ds_read_b64_tr_b16 v[24:25], v7 offset:40960
  v_mfma_f32_16x16x32_bf16 v[124:127], v[28:31], v[164:167], v[124:127]
  ds_read_b64_tr_b16 v[26:27], v7 offset:41984
  s_add_u32 m0, s16, 0
  s_add_u32 s47, s41, 7680
  buffer_load_dwordx4 v255, s[20:23], s47 offen offset:1024 lds
  s_waitcnt lgkmcnt(11)
  v_mfma_f32_16x16x32_bf16 v[64:67], v[12:15], v[168:171], v[64:67]
  ds_read_b64_tr_b16 v[28:29], v8 offset:40960
  v_mfma_f32_16x16x32_bf16 v[68:71], v[12:15], v[172:175], v[68:71]
  ds_read_b64_tr_b16 v[30:31], v8 offset:41984
  s_lshl_b32 s62, s40, 16
  s_add_u32 s62, s62, s45
  buffer_load_dword v32, v33, s[28:31], s62 offen
  s_waitcnt lgkmcnt(11)
  v_mfma_f32_16x16x32_bf16 v[72:75], v[16:19], v[168:171], v[72:75]
  ds_read_b64_tr_b16 v[12:13], v9 offset:40960
  v_mfma_f32_16x16x32_bf16 v[76:79], v[16:19], v[172:175], v[76:79]
  ds_read_b64_tr_b16 v[14:15], v9 offset:41984
  s_waitcnt lgkmcnt(11)
  v_mfma_f32_16x16x32_bf16 v[80:83], v[20:23], v[168:171], v[80:83]
  ds_read_b64_tr_b16 v[16:17], v10 offset:40960
  v_mfma_f32_16x16x32_bf16 v[84:87], v[20:23], v[172:175], v[84:87]
  ds_read_b64_tr_b16 v[18:19], v10 offset:41984
  s_add_u32 m0, s16, 0
  s_add_u32 s47, s41, 14848
  buffer_load_dwordx4 v254, s[20:23], s47 offen offset:2048 lds
  s_waitcnt lgkmcnt(6)
  v_mfma_f32_16x16x32_bf16 v[88:91], v[24:27], v[168:171], v[88:91]
  ds_read_b64_tr_b16 v[20:21], v11 offset:40960
  v_mfma_f32_16x16x32_bf16 v[92:95], v[24:27], v[172:175], v[92:95]
  ds_read_b64_tr_b16 v[22:23], v11 offset:41984
  s_waitcnt lgkmcnt(6)
  v_mfma_f32_16x16x32_bf16 v[96:99], v[28:31], v[168:171], v[96:99]
  s_barrier
  ds_read_b64_tr_b16 v[24:25], v4 offset:49152
  v_mfma_f32_16x16x32_bf16 v[100:103], v[28:31], v[172:175], v[100:103]
  ds_read_b64_tr_b16 v[26:27], v4 offset:50176
  s_waitcnt lgkmcnt(6)
  v_mfma_f32_16x16x32_bf16 v[104:107], v[12:15], v[168:171], v[104:107]
  ds_read_b64_tr_b16 v[28:29], v5 offset:49152
  v_mfma_f32_16x16x32_bf16 v[108:111], v[12:15], v[172:175], v[108:111]
  ds_read_b64_tr_b16 v[30:31], v5 offset:50176
  s_add_u32 m0, s16, 0
  s_add_u32 s47, s41, 22016
  buffer_load_dwordx4 v255, s[20:23], s47 offen offset:3072 lds
  ds_read_b32 v48, v38 offset:0
  ds_read_b32 v49, v38 offset:2048
  ds_read_b32 v50, v38 offset:4096
  s_waitcnt lgkmcnt(9)
  v_mfma_f32_16x16x32_bf16 v[112:115], v[16:19], v[168:171], v[112:115]
  ds_read_b64_tr_b16 v[12:13], v6 offset:49152
  v_mfma_f32_16x16x32_bf16 v[116:119], v[16:19], v[172:175], v[116:119]
  ds_read_b64_tr_b16 v[14:15], v6 offset:50176
  ds_read_b32 v51, v38 offset:6144
  ds_read_b32 v52, v38 offset:8192
  ds_read_b32 v53, v38 offset:10240
  s_waitcnt lgkmcnt(12)
  v_mfma_f32_16x16x32_bf16 v[120:123], v[20:23], v[168:171], v[120:123]
  ds_read_b64_tr_b16 v[16:17], v7 offset:49152
  v_mfma_f32_16x16x32_bf16 v[124:127], v[20:23], v[172:175], v[124:127]
  ds_read_b64_tr_b16 v[18:19], v7 offset:50176
  ds_read_b32 v54, v38 offset:12288
  ds_read_b32 v55, v38 offset:14336
  s_lshr_b32 s18, s17, 5
  s_cmp_eq_u32 s18, 1
  s_cselect_b32 s19, 1.0, 0
  s_waitcnt lgkmcnt(14)
  v_mfma_f32_16x16x32_bf16 v[64:67], v[24:27], v[176:179], v[64:67]
  ds_read_b64_tr_b16 v[20:21], v8 offset:49152
  v_mfma_f32_16x16x32_bf16 v[68:71], v[24:27], v[180:183], v[68:71]
  ds_read_b64_tr_b16 v[22:23], v8 offset:50176
  s_cmp_eq_u32 s18, 4
  s_cselect_b32 s19, 1.0, s19
  s_lshl_b32 s18, s17, 6
  s_cmp_eq_u32 s12, 0
  s_cselect_b32 s18, s18, 16777216
  s_waitcnt lgkmcnt(2)
  v_mfma_f32_16x16x32_bf16 v[72:75], v[28:31], v[176:179], v[72:75]
  ds_read_b64_tr_b16 v[24:25], v9 offset:49152
  v_mfma_f32_16x16x32_bf16 v[76:79], v[28:31], v[180:183], v[76:79]
  ds_read_b64_tr_b16 v[26:27], v9 offset:50176
  s_add_u32 m0, s46, 16384
  s_add_u32 s47, s45, 3145728
  buffer_load_dwordx4 v1, s[24:27], s47 offen offset:0 lds
  v_add_f32 v48, v48, v52
  v_add_f32 v49, v49, v53
  v_add_f32 v50, v50, v54
  v_mfma_f32_16x16x32_bf16 v[80:83], v[12:15], v[176:179], v[80:83]
  ds_read_b64_tr_b16 v[28:29], v10 offset:49152
  v_mfma_f32_16x16x32_bf16 v[84:87], v[12:15], v[180:183], v[84:87]
  ds_read_b64_tr_b16 v[30:31], v10 offset:50176
  v_add_f32 v51, v51, v55
  v_add_f32 v48, v48, v50
  v_add_f32 v49, v49, v51
  v_mfma_f32_16x16x32_bf16 v[88:91], v[16:19], v[176:179], v[88:91]
  ds_read_b64_tr_b16 v[12:13], v11 offset:49152
  v_mfma_f32_16x16x32_bf16 v[92:95], v[16:19], v[180:183], v[92:95]
  ds_read_b64_tr_b16 v[14:15], v11 offset:50176
  s_add_u32 m0, s46, 16384
  s_add_u32 s47, s45, 3177472
  buffer_load_dwordx4 v1, s[24:27], s47 offen offset:1024 lds
  v_add_f32 v48, v48, v49
  v_cvt_pk_bf16_f32 v48, v48, v48
  v_lshlrev_b32 v48, 16, v48
  s_waitcnt lgkmcnt(6)
  v_mfma_f32_16x16x32_bf16 v[96:99], v[20:23], v[176:179], v[96:99]
  ds_read_b64_tr_b16 v[16:17], v4 offset:57344
  v_mfma_f32_16x16x32_bf16 v[100:103], v[20:23], v[180:183], v[100:103]
  ds_read_b64_tr_b16 v[18:19], v4 offset:58368
  s_add_u32 m0, s16, 4096
  s_add_u32 s47, s41, 640
  buffer_load_dwordx4 v254, s[20:23], s47 offen offset:0 lds
  v_add_f32 v48, s19, v48
  v_cvt_pk_bf16_f32 v48, v48, v48
  v_lshlrev_b32 v48, 16, v48
  s_waitcnt lgkmcnt(6)
  v_mfma_f32_16x16x32_bf16 v[104:107], v[24:27], v[176:179], v[104:107]
  ds_read_b64_tr_b16 v[20:21], v5 offset:57344
  v_mfma_f32_16x16x32_bf16 v[108:111], v[24:27], v[180:183], v[108:111]
  ds_read_b64_tr_b16 v[22:23], v5 offset:58368
  v_xor_b32 v48, s85, v48
  buffer_store_dword v48, v39, s[36:39], s18 offen sc1
  s_waitcnt lgkmcnt(6)
  v_mfma_f32_16x16x32_bf16 v[112:115], v[28:31], v[176:179], v[112:115]
  ds_read_b64_tr_b16 v[24:25], v6 offset:57344
  v_mfma_f32_16x16x32_bf16 v[116:119], v[28:31], v[180:183], v[116:119]
  ds_read_b64_tr_b16 v[26:27], v6 offset:58368
  s_waitcnt vmcnt(4)
  ds_read_b128 v[192:195], v40 offset:0
  ds_read_b128 v[196:199], v40 offset:2048
  ds_read_b128 v[200:203], v41 offset:0
  ds_read_b128 v[204:207], v41 offset:2048
  s_waitcnt lgkmcnt(10)
  v_mfma_f32_16x16x32_bf16 v[120:123], v[12:15], v[176:179], v[120:123]
  ds_read_b64_tr_b16 v[28:29], v7 offset:57344
  v_mfma_f32_16x16x32_bf16 v[124:127], v[12:15], v[180:183], v[124:127]
  ds_read_b64_tr_b16 v[30:31], v7 offset:58368
  s_add_u32 m0, s16, 4096
  s_add_u32 s47, s41, 7808
  buffer_load_dwordx4 v255, s[20:23], s47 offen offset:1024 lds
  s_waitcnt lgkmcnt(10)
  v_mfma_f32_16x16x32_bf16 v[64:67], v[16:19], v[184:187], v[64:67]
  ds_read_b64_tr_b16 v[12:13], v8 offset:57344
  v_mfma_f32_16x16x32_bf16 v[68:71], v[16:19], v[188:191], v[68:71]
  ds_read_b64_tr_b16 v[14:15], v8 offset:58368
  s_mov_b32 s58, 0x200000
  s_mov_b32 s59, 0x20000
  s_lshl_b32 s62, s63, 10
  buffer_load_dwordx4 v[44:47], v2, s[56:59], s62 offen
  s_waitcnt lgkmcnt(10)
  v_mfma_f32_16x16x32_bf16 v[72:75], v[20:23], v[184:187], v[72:75]
  ds_read_b64_tr_b16 v[16:17], v9 offset:57344
  v_mfma_f32_16x16x32_bf16 v[76:79], v[20:23], v[188:191], v[76:79]
  ds_read_b64_tr_b16 v[18:19], v9 offset:58368
  s_waitcnt lgkmcnt(10)
  v_mfma_f32_16x16x32_bf16 v[80:83], v[24:27], v[184:187], v[80:83]
  ds_read_b64_tr_b16 v[20:21], v10 offset:57344
  v_mfma_f32_16x16x32_bf16 v[84:87], v[24:27], v[188:191], v[84:87]
  ds_read_b64_tr_b16 v[22:23], v10 offset:58368
  s_add_u32 m0, s16, 4096
  s_add_u32 s47, s41, 14976
  buffer_load_dwordx4 v254, s[20:23], s47 offen offset:2048 lds
  s_waitcnt lgkmcnt(6)
  v_mfma_f32_16x16x32_bf16 v[88:91], v[28:31], v[184:187], v[88:91]
  ds_read_b64_tr_b16 v[24:25], v11 offset:57344
  v_mfma_f32_16x16x32_bf16 v[92:95], v[28:31], v[188:191], v[92:95]
  ds_read_b64_tr_b16 v[26:27], v11 offset:58368
  s_waitcnt lgkmcnt(6)
  v_mfma_f32_16x16x32_bf16 v[96:99], v[12:15], v[184:187], v[96:99]
  s_barrier
  v_xor_b32 v4, 0x10000, v4
  v_xor_b32 v5, 0x10000, v5
  v_xor_b32 v6, 0x10000, v6
  v_xor_b32 v7, 0x10000, v7
  v_xor_b32 v8, 0x10000, v8
  v_xor_b32 v9, 0x10000, v9
  v_xor_b32 v10, 0x10000, v10
  v_xor_b32 v11, 0x10000, v11
  ds_read_b64_tr_b16 v[28:29], v4 offset:0
  v_mfma_f32_16x16x32_bf16 v[100:103], v[12:15], v[188:191], v[100:103]
  ds_read_b64_tr_b16 v[30:31], v4 offset:1024
  s_waitcnt lgkmcnt(6)
  v_mfma_f32_16x16x32_bf16 v[104:107], v[16:19], v[184:187], v[104:107]
  ds_read_b64_tr_b16 v[12:13], v5 offset:0
  v_mfma_f32_16x16x32_bf16 v[108:111], v[16:19], v[188:191], v[108:111]
  ds_read_b64_tr_b16 v[14:15], v5 offset:1024
  s_add_u32 m0, s16, 4096
  s_add_u32 s47, s41, 22144
  buffer_load_dwordx4 v255, s[20:23], s47 offen offset:3072 lds
  s_waitcnt lgkmcnt(6)
  v_mfma_f32_16x16x32_bf16 v[112:115], v[20:23], v[184:187], v[112:115]
  ds_read_b64_tr_b16 v[16:17], v6 offset:0
  v_mfma_f32_16x16x32_bf16 v[116:119], v[20:23], v[188:191], v[116:119]
  ds_read_b64_tr_b16 v[18:19], v6 offset:1024
  s_waitcnt lgkmcnt(6)
  v_mfma_f32_16x16x32_bf16 v[120:123], v[24:27], v[184:187], v[120:123]
  ds_read_b64_tr_b16 v[20:21], v7 offset:0
  v_mfma_f32_16x16x32_bf16 v[124:127], v[24:27], v[188:191], v[124:127]
  ds_read_b64_tr_b16 v[22:23], v7 offset:1024
  s_waitcnt lgkmcnt(6)
  v_mfma_f32_16x16x32_bf16 v[64:67], v[28:31], v[192:195], v[64:67]
  ds_read_b64_tr_b16 v[24:25], v8 offset:0
  v_mfma_f32_16x16x32_bf16 v[68:71], v[28:31], v[196:199], v[68:71]
  ds_read_b64_tr_b16 v[26:27], v8 offset:1024
  s_waitcnt lgkmcnt(6)
  v_mfma_f32_16x16x32_bf16 v[72:75], v[12:15], v[192:195], v[72:75]
  ds_read_b64_tr_b16 v[28:29], v9 offset:0
  v_mfma_f32_16x16x32_bf16 v[76:79], v[12:15], v[196:199], v[76:79]
  ds_read_b64_tr_b16 v[30:31], v9 offset:1024
  s_add_u32 m0, s46, 32768
  s_add_u32 s47, s45, 3670016
  buffer_load_dwordx4 v1, s[24:27], s47 offen offset:0 lds
  s_waitcnt lgkmcnt(6)
  v_mfma_f32_16x16x32_bf16 v[80:83], v[16:19], v[192:195], v[80:83]
  ds_read_b64_tr_b16 v[12:13], v10 offset:0
  v_mfma_f32_16x16x32_bf16 v[84:87], v[16:19], v[196:199], v[84:87]
  ds_read_b64_tr_b16 v[14:15], v10 offset:1024
  s_waitcnt lgkmcnt(6)
  v_mfma_f32_16x16x32_bf16 v[88:91], v[20:23], v[192:195], v[88:91]
  ds_read_b64_tr_b16 v[16:17], v11 offset:0
  v_mfma_f32_16x16x32_bf16 v[92:95], v[20:23], v[196:199], v[92:95]
  ds_read_b64_tr_b16 v[18:19], v11 offset:1024
  s_add_u32 m0, s46, 32768
  s_add_u32 s47, s45, 3701760
  buffer_load_dwordx4 v1, s[24:27], s47 offen offset:1024 lds
  s_waitcnt lgkmcnt(6)
  v_mfma_f32_16x16x32_bf16 v[96:99], v[24:27], v[192:195], v[96:99]
  ds_read_b64_tr_b16 v[20:21], v4 offset:8192
  v_mfma_f32_16x16x32_bf16 v[100:103], v[24:27], v[196:199], v[100:103]
  ds_read_b64_tr_b16 v[22:23], v4 offset:9216
  s_add_u32 m0, s16, 0
  s_add_u32 s47, s41, 768
  buffer_load_dwordx4 v254, s[20:23], s47 offen offset:0 lds
  s_waitcnt lgkmcnt(6)
  v_mfma_f32_16x16x32_bf16 v[104:107], v[28:31], v[192:195], v[104:107]
  ds_read_b64_tr_b16 v[24:25], v5 offset:8192
  v_mfma_f32_16x16x32_bf16 v[108:111], v[28:31], v[196:199], v[108:111]
  ds_read_b64_tr_b16 v[26:27], v5 offset:9216
  s_waitcnt lgkmcnt(6)
  v_mfma_f32_16x16x32_bf16 v[112:115], v[12:15], v[192:195], v[112:115]
  ds_read_b64_tr_b16 v[28:29], v6 offset:8192
  v_mfma_f32_16x16x32_bf16 v[116:119], v[12:15], v[196:199], v[116:119]
  ds_read_b64_tr_b16 v[30:31], v6 offset:9216
  s_waitcnt vmcnt(3)
  ds_read_b128 v[208:211], v40 offset:4096
  ds_read_b128 v[212:215], v40 offset:6144
  ds_read_b128 v[216:219], v41 offset:4096
  ds_read_b128 v[220:223], v41 offset:6144
  s_waitcnt lgkmcnt(10)
  v_mfma_f32_16x16x32_bf16 v[120:123], v[16:19], v[192:195], v[120:123]
  ds_read_b64_tr_b16 v[12:13], v7 offset:8192
  v_mfma_f32_16x16x32_bf16 v[124:127], v[16:19], v[196:199], v[124:127]
  ds_read_b64_tr_b16 v[14:15], v7 offset:9216
  s_add_u32 m0, s16, 0
  s_add_u32 s47, s41, 7936
  buffer_load_dwordx4 v255, s[20:23], s47 offen offset:1024 lds
  v_lshlrev_b32 v48, 16, v44
  v_and_b32 v49, 0xffff0000, v44
  s_waitcnt lgkmcnt(10)
  v_mfma_f32_16x16x32_bf16 v[64:67], v[20:23], v[200:203], v[64:67]
  ds_read_b64_tr_b16 v[16:17], v8 offset:8192
  v_mfma_f32_16x16x32_bf16 v[68:71], v[20:23], v[204:207], v[68:71]
  ds_read_b64_tr_b16 v[18:19], v8 offset:9216
  s_lshl_b32 s62, s40, 16
  s_add_u32 s62, s62, s45
  buffer_load_dword v32, v33, s[52:55], s62 offen
  v_lshlrev_b32 v50, 16, v45
  v_and_b32 v51, 0xffff0000, v45
  v_lshlrev_b32 v52, 16, v46
  s_waitcnt lgkmcnt(10)
  v_mfma_f32_16x16x32_bf16 v[72:75], v[24:27], v[200:203], v[72:75]
  ds_read_b64_tr_b16 v[20:21], v9 offset:8192
  v_mfma_f32_16x16x32_bf16 v[76:79], v[24:27], v[204:207], v[76:79]
  ds_read_b64_tr_b16 v[22:23], v9 offset:9216
  v_and_b32 v53, 0xffff0000, v46
  v_lshlrev_b32 v54, 16, v47
  v_and_b32 v55, 0xffff0000, v47
  s_waitcnt lgkmcnt(10)
  v_mfma_f32_16x16x32_bf16 v[80:83], v[28:31], v[200:203], v[80:83]
  ds_read_b64_tr_b16 v[24:25], v10 offset:8192
  v_mfma_f32_16x16x32_bf16 v[84:87], v[28:31], v[204:207], v[84:87]
  ds_read_b64_tr_b16 v[26:27], v10 offset:9216
  s_add_u32 m0, s16, 0
  s_add_u32 s47, s41, 15104
  buffer_load_dwordx4 v254, s[20:23], s47 offen offset:2048 lds
  v_add_f32 v36, v48, v49
  v_add_f32 v36, v36, v50
  v_add_f32 v36, v36, v51
  s_waitcnt lgkmcnt(6)
  v_mfma_f32_16x16x32_bf16 v[88:91], v[12:15], v[200:203], v[88:91]
  ds_read_b64_tr_b16 v[28:29], v11 offset:8192
  v_mfma_f32_16x16x32_bf16 v[92:95], v[12:15], v[204:207], v[92:95]
  ds_read_b64_tr_b16 v[30:31], v11 offset:9216
  v_add_f32 v36, v36, v52
  v_add_f32 v36, v36, v53
  v_add_f32 v36, v36, v54
  s_waitcnt lgkmcnt(6)
  v_mfma_f32_16x16x32_bf16 v[96:99], v[16:19], v[200:203], v[96:99]
  s_barrier
  v_xor_b32 v4, 0x10000, v4
  v_xor_b32 v5, 0x10000, v5
  v_xor_b32 v6, 0x10000, v6
  v_xor_b32 v7, 0x10000, v7
  v_xor_b32 v8, 0x10000, v8
  v_xor_b32 v9, 0x10000, v9
  v_xor_b32 v10, 0x10000, v10
  v_xor_b32 v11, 0x10000, v11
  ds_read_b64_tr_b16 v[12:13], v4 offset:0
  v_mfma_f32_16x16x32_bf16 v[100:103], v[16:19], v[204:207], v[100:103]
  ds_read_b64_tr_b16 v[14:15], v4 offset:1024
  v_add_f32 v36, v36, v55
  s_waitcnt lgkmcnt(6)
  v_mfma_f32_16x16x32_bf16 v[104:107], v[20:23], v[200:203], v[104:107]
  ds_read_b64_tr_b16 v[16:17], v5 offset:0
  v_mfma_f32_16x16x32_bf16 v[108:111], v[20:23], v[204:207], v[108:111]
  ds_read_b64_tr_b16 v[18:19], v5 offset:1024
  s_add_u32 m0, s16, 0
  s_add_u32 s47, s41, 22272
  buffer_load_dwordx4 v255, s[20:23], s47 offen offset:3072 lds
  v_add_f32_dpp v36, v36, v36 row_ror:8 row_mask:0xf bank_mask:0xf
  s_waitcnt lgkmcnt(6)
  v_mfma_f32_16x16x32_bf16 v[112:115], v[24:27], v[200:203], v[112:115]
  ds_read_b64_tr_b16 v[20:21], v6 offset:0
  v_mfma_f32_16x16x32_bf16 v[116:119], v[24:27], v[204:207], v[116:119]
  ds_read_b64_tr_b16 v[22:23], v6 offset:1024
  v_add_f32_dpp v36, v36, v36 row_ror:4 row_mask:0xf bank_mask:0xf
  s_waitcnt lgkmcnt(6)
  v_mfma_f32_16x16x32_bf16 v[120:123], v[28:31], v[200:203], v[120:123]
  ds_read_b64_tr_b16 v[24:25], v7 offset:0
  v_mfma_f32_16x16x32_bf16 v[124:127], v[28:31], v[204:207], v[124:127]
  ds_read_b64_tr_b16 v[26:27], v7 offset:1024
  v_add_f32_dpp v36, v36, v36 row_ror:2 row_mask:0xf bank_mask:0xf
  s_waitcnt lgkmcnt(6)
  v_mfma_f32_16x16x32_bf16 v[64:67], v[12:15], v[208:211], v[64:67]
  ds_read_b64_tr_b16 v[28:29], v8 offset:0
  v_mfma_f32_16x16x32_bf16 v[68:71], v[12:15], v[212:215], v[68:71]
  ds_read_b64_tr_b16 v[30:31], v8 offset:1024
  v_add_f32_dpp v36, v36, v36 row_ror:1 row_mask:0xf bank_mask:0xf
  v_mov_b32 v37, v36
  s_waitcnt lgkmcnt(6)
  v_mfma_f32_16x16x32_bf16 v[72:75], v[16:19], v[208:211], v[72:75]
  ds_read_b64_tr_b16 v[12:13], v9 offset:0
  v_mfma_f32_16x16x32_bf16 v[76:79], v[16:19], v[212:215], v[76:79]
  ds_read_b64_tr_b16 v[14:15], v9 offset:1024
  s_add_u32 m0, s46, 49152
  s_add_u32 s47, s45, 0
  buffer_load_dwordx4 v1, s[28:31], s47 offen offset:0 lds
  v_permlane16_swap_b32 v37, v36
  s_waitcnt lgkmcnt(6)
  v_mfma_f32_16x16x32_bf16 v[80:83], v[20:23], v[208:211], v[80:83]
  ds_read_b64_tr_b16 v[16:17], v10 offset:0
  v_mfma_f32_16x16x32_bf16 v[84:87], v[20:23], v[212:215], v[84:87]
  ds_read_b64_tr_b16 v[18:19], v10 offset:1024
  v_add_f32 v36, v36, v37
  v_mov_b32 v37, v36
  s_waitcnt lgkmcnt(6)
  v_mfma_f32_16x16x32_bf16 v[88:91], v[24:27], v[208:211], v[88:91]
  ds_read_b64_tr_b16 v[20:21], v11 offset:0
  v_mfma_f32_16x16x32_bf16 v[92:95], v[24:27], v[212:215], v[92:95]
  ds_read_b64_tr_b16 v[22:23], v11 offset:1024
  s_add_u32 m0, s46, 49152
  s_add_u32 s47, s45, 31744
  buffer_load_dwordx4 v1, s[28:31], s47 offen offset:1024 lds
  v_permlane32_swap_b32 v37, v36
  s_waitcnt lgkmcnt(6)
  v_mfma_f32_16x16x32_bf16 v[96:99], v[28:31], v[208:211], v[96:99]
  ds_read_b64_tr_b16 v[24:25], v4 offset:8192
  v_mfma_f32_16x16x32_bf16 v[100:103], v[28:31], v[212:215], v[100:103]
  ds_read_b64_tr_b16 v[26:27], v4 offset:9216
  s_add_u32 m0, s16, 4096
  s_add_u32 s47, s41, 896
  buffer_load_dwordx4 v254, s[20:23], s47 offen offset:0 lds
  v_add_f32 v36, v36, v37
  v_mul_f32 v36, 0x3b000000, v36
  v_sub_f32 v48, v48, v36
  s_waitcnt lgkmcnt(6)
  v_mfma_f32_16x16x32_bf16 v[104:107], v[12:15], v[208:211], v[104:107]
  ds_read_b64_tr_b16 v[28:29], v5 offset:8192
  v_mfma_f32_16x16x32_bf16 v[108:111], v[12:15], v[212:215], v[108:111]
  ds_read_b64_tr_b16 v[30:31], v5 offset:9216
  v_sub_f32 v49, v49, v36
  v_sub_f32 v50, v50, v36
  v_sub_f32 v51, v51, v36
  s_waitcnt lgkmcnt(6)
  v_mfma_f32_16x16x32_bf16 v[112:115], v[16:19], v[208:211], v[112:115]
  ds_read_b64_tr_b16 v[12:13], v6 offset:8192
  v_mfma_f32_16x16x32_bf16 v[116:119], v[16:19], v[212:215], v[116:119]
  ds_read_b64_tr_b16 v[14:15], v6 offset:9216
  s_waitcnt vmcnt(3)
  ds_read_b128 v[224:227], v40 offset:0
  ds_read_b128 v[228:231], v40 offset:2048
  ds_read_b128 v[232:235], v41 offset:0
  ds_read_b128 v[236:239], v41 offset:2048
  v_sub_f32 v52, v52, v36
  v_sub_f32 v53, v53, v36
  v_sub_f32 v54, v54, v36
  s_waitcnt lgkmcnt(10)
  v_mfma_f32_16x16x32_bf16 v[120:123], v[20:23], v[208:211], v[120:123]
  ds_read_b64_tr_b16 v[16:17], v7 offset:8192
  v_mfma_f32_16x16x32_bf16 v[124:127], v[20:23], v[212:215], v[124:127]
  ds_read_b64_tr_b16 v[18:19], v7 offset:9216
  s_add_u32 m0, s16, 4096
  s_add_u32 s47, s41, 8064
  buffer_load_dwordx4 v255, s[20:23], s47 offen offset:1024 lds
  v_sub_f32 v55, v55, v36
  v_mul_f32 v36, v48, v48
  v_fmac_f32 v36, v49, v49
  s_waitcnt lgkmcnt(10)
  v_mfma_f32_16x16x32_bf16 v[64:67], v[24:27], v[216:219], v[64:67]
  ds_read_b64_tr_b16 v[20:21], v8 offset:8192
  v_mfma_f32_16x16x32_bf16 v[68:71], v[24:27], v[220:223], v[68:71]
  ds_read_b64_tr_b16 v[22:23], v8 offset:9216
  v_fmac_f32 v36, v50, v50
  v_fmac_f32 v36, v51, v51
  v_fmac_f32 v36, v52, v52
  s_waitcnt lgkmcnt(10)
  v_mfma_f32_16x16x32_bf16 v[72:75], v[28:31], v[216:219], v[72:75]
  ds_read_b64_tr_b16 v[24:25], v9 offset:8192
  v_mfma_f32_16x16x32_bf16 v[76:79], v[28:31], v[220:223], v[76:79]
  ds_read_b64_tr_b16 v[26:27], v9 offset:9216
  v_fmac_f32 v36, v53, v53
  v_fmac_f32 v36, v54, v54
  v_fmac_f32 v36, v55, v55
  s_waitcnt lgkmcnt(10)
  v_mfma_f32_16x16x32_bf16 v[80:83], v[12:15], v[216:219], v[80:83]
  ds_read_b64_tr_b16 v[28:29], v10 offset:8192
  v_mfma_f32_16x16x32_bf16 v[84:87], v[12:15], v[220:223], v[84:87]
  ds_read_b64_tr_b16 v[30:31], v10 offset:9216
  s_add_u32 m0, s16, 4096
  s_add_u32 s47, s41, 15232
  buffer_load_dwordx4 v254, s[20:23], s47 offen offset:2048 lds
  v_add_f32_dpp v36, v36, v36 row_ror:8 row_mask:0xf bank_mask:0xf
  s_lshl_b32 s62, s12, 9
  v_lshl_add_u32 v39, v0, 3, s62
  buffer_load_dwordx2 v[32:33], v39, s[36:39], 0 offen sc1
  s_waitcnt lgkmcnt(6)
  v_mfma_f32_16x16x32_bf16 v[88:91], v[16:19], v[216:219], v[88:91]
  ds_read_b64_tr_b16 v[12:13], v11 offset:8192
  v_mfma_f32_16x16x32_bf16 v[92:95], v[16:19], v[220:223], v[92:95]
  ds_read_b64_tr_b16 v[14:15], v11 offset:9216
  v_add_f32_dpp v36, v36, v36 row_ror:4 row_mask:0xf bank_mask:0xf
  s_waitcnt lgkmcnt(6)
  v_mfma_f32_16x16x32_bf16 v[96:99], v[20:23], v[216:219], v[96:99]
  s_barrier
  ds_read_b64_tr_b16 v[16:17], v4 offset:16384
  v_mfma_f32_16x16x32_bf16 v[100:103], v[20:23], v[220:223], v[100:103]
  ds_read_b64_tr_b16 v[18:19], v4 offset:17408
  v_add_f32_dpp v36, v36, v36 row_ror:2 row_mask:0xf bank_mask:0xf
  s_waitcnt lgkmcnt(6)
  v_mfma_f32_16x16x32_bf16 v[104:107], v[24:27], v[216:219], v[104:107]
  ds_read_b64_tr_b16 v[20:21], v5 offset:16384
  v_mfma_f32_16x16x32_bf16 v[108:111], v[24:27], v[220:223], v[108:111]
  ds_read_b64_tr_b16 v[22:23], v5 offset:17408
  s_add_u32 m0, s16, 4096
  s_add_u32 s47, s41, 22400
  buffer_load_dwordx4 v255, s[20:23], s47 offen offset:3072 lds
  v_add_f32_dpp v36, v36, v36 row_ror:1 row_mask:0xf bank_mask:0xf
  v_mov_b32 v37, v36
  s_waitcnt lgkmcnt(6)
  v_mfma_f32_16x16x32_bf16 v[112:115], v[28:31], v[216:219], v[112:115]
  ds_read_b64_tr_b16 v[24:25], v6 offset:16384
  v_mfma_f32_16x16x32_bf16 v[116:119], v[28:31], v[220:223], v[116:119]
  ds_read_b64_tr_b16 v[26:27], v6 offset:17408
  v_permlane16_swap_b32 v37, v36
  s_waitcnt lgkmcnt(6)
  v_mfma_f32_16x16x32_bf16 v[120:123], v[12:15], v[216:219], v[120:123]
  ds_read_b64_tr_b16 v[28:29], v7 offset:16384
  v_mfma_f32_16x16x32_bf16 v[124:127], v[12:15], v[220:223], v[124:127]
  ds_read_b64_tr_b16 v[30:31], v7 offset:17408
  v_add_f32 v36, v36, v37
  v_mov_b32 v37, v36
  s_waitcnt lgkmcnt(6)
  v_mfma_f32_16x16x32_bf16 v[64:67], v[16:19], v[224:227], v[64:67]
  ds_read_b64_tr_b16 v[12:13], v8 offset:16384
  v_mfma_f32_16x16x32_bf16 v[68:71], v[16:19], v[228:231], v[68:71]
  ds_read_b64_tr_b16 v[14:15], v8 offset:17408
  v_permlane32_swap_b32 v37, v36
  s_waitcnt lgkmcnt(6)
  v_mfma_f32_16x16x32_bf16 v[72:75], v[20:23], v[224:227], v[72:75]
  ds_read_b64_tr_b16 v[16:17], v9 offset:16384
  v_mfma_f32_16x16x32_bf16 v[76:79], v[20:23], v[228:231], v[76:79]
  ds_read_b64_tr_b16 v[18:19], v9 offset:17408
  s_add_u32 m0, s46, 65536
  s_add_u32 s47, s45, 524288
  buffer_load_dwordx4 v1, s[28:31], s47 offen offset:0 lds
  v_add_f32 v36, v36, v37
  v_mov_b32 v37, 0x3727c5ac
  v_fmac_f32 v37, 0x3b000000, v36
  s_waitcnt lgkmcnt(6)
  v_mfma_f32_16x16x32_bf16 v[80:83], v[24:27], v[224:227], v[80:83]
  ds_read_b64_tr_b16 v[20:21], v10 offset:16384
  v_mfma_f32_16x16x32_bf16 v[84:87], v[24:27], v[228:231], v[84:87]
  ds_read_b64_tr_b16 v[22:23], v10 offset:17408
  v_rsq_f32 v36, v37
  s_lshr_b32 s62, s63, 5
  s_lshl_b32 s62, s62, 15
  s_bfe_u32 s3, s63, 0x10004
  s_lshl_b32 s3, s3, 10
  s_add_u32 s62, s62, s3
  s_and_b32 s3, s63, 8
  s_lshl_b32 s3, s3, 4
  s_add_u32 s3, s3, s62
  s_lshl_b32 s62, s12, 12
  s_add_u32 s3, s3, s62
  s_lshl_b32 s62, s12, 4
  s_add_u32 s62, s62, 147456
  v_lshl_add_u32 v38, v0, 7, s62
  s_waitcnt lgkmcnt(6)
  v_mfma_f32_16x16x32_bf16 v[88:91], v[28:31], v[224:227], v[88:91]
  ds_read_b64_tr_b16 v[24:25], v11 offset:16384
  v_mfma_f32_16x16x32_bf16 v[92:95], v[28:31], v[228:231], v[92:95]
  ds_read_b64_tr_b16 v[26:27], v11 offset:17408
  s_add_u32 m0, s46, 65536
  s_add_u32 s47, s45, 556032
  buffer_load_dwordx4 v1, s[28:31], s47 offen offset:1024 lds
  v_lshrrev_b32 v42, 5, v0
  v_bfe_u32 v43, v0, 3, 2
  v_lshlrev_b32 v42, 11, v42
  s_waitcnt lgkmcnt(6)
  v_mfma_f32_16x16x32_bf16 v[96:99], v[12:15], v[224:227], v[96:99]
  ds_read_b64_tr_b16 v[28:29], v4 offset:24576
  v_mfma_f32_16x16x32_bf16 v[100:103], v[12:15], v[228:231], v[100:103]
  ds_read_b64_tr_b16 v[30:31], v4 offset:25600
  v_lshl_add_u32 v42, v43, 8, v42
  v_and_b32 v43, 7, v0
  v_lshl_add_u32 v42, v43, 4, v42
  s_waitcnt lgkmcnt(6)
  v_mfma_f32_16x16x32_bf16 v[104:107], v[16:19], v[224:227], v[104:107]
  ds_read_b64_tr_b16 v[12:13], v5 offset:24576
  v_mfma_f32_16x16x32_bf16 v[108:111], v[16:19], v[228:231], v[108:111]
  ds_read_b64_tr_b16 v[14:15], v5 offset:25600
  s_lshl_b32 s62, s12, 10
  s_add_u32 s62, s62, 147456
  v_add_u32 v43, s62, v2
  v_mul_f32 v48, v48, v36
  v_mul_f32 v49, v49, v36
  s_waitcnt lgkmcnt(6)
  v_mfma_f32_16x16x32_bf16 v[112:115], v[20:23], v[224:227], v[112:115]
  ds_read_b64_tr_b16 v[16:17], v6 offset:24576
  v_mfma_f32_16x16x32_bf16 v[116:119], v[20:23], v[228:231], v[116:119]
  ds_read_b64_tr_b16 v[18:19], v6 offset:25600
  s_waitcnt vmcnt(2)
  ds_read_b128 v[240:243], v40 offset:4096
  ds_read_b128 v[244:247], v40 offset:6144
  ds_read_b128 v[248:251], v41 offset:4096
  ds_read_b128 v[252:255], v41 offset:6144
  v_mul_f32 v50, v50, v36
  v_mul_f32 v51, v51, v36
  v_mul_f32 v52, v52, v36
  s_lshr_b32 s62, s12, 1
  s_lshl_b32 s62, s62, 10
  s_add_u32 s62, s62, 82944
  v_add_u32 v34, s62, v39
  v_and_b32 v35, 32, v0
  v_add_u32 v35, v35, v0
  v_lshlrev_b32 v35, 5, v35
  v_add_u32 v35, 82944, v35
  s_waitcnt lgkmcnt(10)
  v_mfma_f32_16x16x32_bf16 v[120:123], v[24:27], v[224:227], v[120:123]
  ds_read_b64_tr_b16 v[20:21], v7 offset:24576
  v_mfma_f32_16x16x32_bf16 v[124:127], v[24:27], v[228:231], v[124:127]
  ds_read_b64_tr_b16 v[22:23], v7 offset:25600
  v_mul_f32 v53, v53, v36
  v_mul_f32 v54, v54, v36
  v_mul_f32 v55, v55, v36
  v_xor_b32 v32, s85, v32
  v_xor_b32 v33, s85, v33
  v_or_b32 v3, v32, v33
  v_cmp_ne_u16 vcc, 0, v3
  s_cbranch_vccnz kvattn_kernel_spinm
kvattn_kernel_readym:
  s_add_u32 s36, s10, 0x2000000
  s_addc_u32 s37, s11, 0
  s_mov_b32 s38, 0x1000000
  s_mov_b32 s39, 0x20000
  s_waitcnt lgkmcnt(10)
  v_mfma_f32_16x16x32_bf16 v[64:67], v[28:31], v[232:235], v[64:67]
  ds_read_b64_tr_b16 v[24:25], v8 offset:24576
  v_mfma_f32_16x16x32_bf16 v[68:71], v[28:31], v[236:239], v[68:71]
  ds_read_b64_tr_b16 v[26:27], v8 offset:25600
  s_add_u32 s24, s10, 0x100000
  s_addc_u32 s25, s11, 0
  s_mov_b32 s26, 0x200000
  s_mov_b32 s27, 0x20000
  ds_write_b64 v34, v[32:33]
  s_waitcnt lgkmcnt(11)
  v_mfma_f32_16x16x32_bf16 v[72:75], v[12:15], v[232:235], v[72:75]
  ds_read_b64_tr_b16 v[28:29], v9 offset:24576
  v_mfma_f32_16x16x32_bf16 v[76:79], v[12:15], v[236:239], v[76:79]
  ds_read_b64_tr_b16 v[30:31], v9 offset:25600
  s_waitcnt lgkmcnt(11)
  v_mfma_f32_16x16x32_bf16 v[80:83], v[16:19], v[232:235], v[80:83]
  ds_read_b64_tr_b16 v[12:13], v10 offset:24576
  v_mfma_f32_16x16x32_bf16 v[84:87], v[16:19], v[236:239], v[84:87]
  ds_read_b64_tr_b16 v[14:15], v10 offset:25600
  s_waitcnt lgkmcnt(7)
  v_mfma_f32_16x16x32_bf16 v[88:91], v[20:23], v[232:235], v[88:91]
  ds_read_b64_tr_b16 v[16:17], v11 offset:24576
  v_mfma_f32_16x16x32_bf16 v[92:95], v[20:23], v[236:239], v[92:95]
  ds_read_b64_tr_b16 v[18:19], v11 offset:25600
  s_waitcnt lgkmcnt(7)
  v_mfma_f32_16x16x32_bf16 v[96:99], v[24:27], v[232:235], v[96:99]
  s_waitcnt lgkmcnt(6)
  s_barrier
  ds_read_b64_tr_b16 v[20:21], v4 offset:32768
  v_mfma_f32_16x16x32_bf16 v[100:103], v[24:27], v[236:239], v[100:103]
  ds_read_b64_tr_b16 v[22:23], v4 offset:33792
  ds_read_b128 v[44:47], v35 offset:16
  ds_read_b128 v[56:59], v35 offset:4096
  ds_read_b128 v[60:63], v35 offset:4112
  ds_read_b128 v[32:35], v35 offset:0
  s_waitcnt lgkmcnt(10)
  v_mfma_f32_16x16x32_bf16 v[104:107], v[28:31], v[232:235], v[104:107]
  ds_read_b64_tr_b16 v[24:25], v5 offset:32768
  v_mfma_f32_16x16x32_bf16 v[108:111], v[28:31], v[236:239], v[108:111]
  ds_read_b64_tr_b16 v[26:27], v5 offset:33792
  s_waitcnt lgkmcnt(10)
  v_mfma_f32_16x16x32_bf16 v[112:115], v[12:15], v[232:235], v[112:115]
  ds_read_b64_tr_b16 v[28:29], v6 offset:32768
  v_mfma_f32_16x16x32_bf16 v[116:119], v[12:15], v[236:239], v[116:119]
  ds_read_b64_tr_b16 v[30:31], v6 offset:33792
  s_add_u32 m0, s46, 98304
  s_add_u32 s47, s45, 2097152
  buffer_load_dwordx4 v1, s[28:31], s47 offen offset:0 lds
  s_waitcnt lgkmcnt(10)
  v_mfma_f32_16x16x32_bf16 v[120:123], v[16:19], v[232:235], v[120:123]
  ds_read_b64_tr_b16 v[12:13], v7 offset:32768
  v_mfma_f32_16x16x32_bf16 v[124:127], v[16:19], v[236:239], v[124:127]
  ds_read_b64_tr_b16 v[14:15], v7 offset:33792
  s_waitcnt lgkmcnt(6)
  v_fma_f32 v48, v48, v56, v32
  v_fma_f32 v49, v49, v57, v33
  v_fma_f32 v50, v50, v58, v34
  v_mfma_f32_16x16x32_bf16 v[64:67], v[20:23], v[240:243], v[64:67]
  ds_read_b64_tr_b16 v[16:17], v8 offset:32768
  v_mfma_f32_16x16x32_bf16 v[68:71], v[20:23], v[244:247], v[68:71]
  ds_read_b64_tr_b16 v[18:19], v8 offset:33792
  s_add_u32 m0, s46, 98304
  s_add_u32 s47, s45, 2128896
  buffer_load_dwordx4 v1, s[28:31], s47 offen offset:1024 lds
  v_fma_f32 v51, v51, v59, v35
  v_fma_f32 v52, v52, v60, v44
  v_fma_f32 v53, v53, v61, v45
  v_fma_f32 v54, v54, v62, v46
  s_waitcnt lgkmcnt(6)
  v_mfma_f32_16x16x32_bf16 v[72:75], v[24:27], v[240:243], v[72:75]
  ds_read_b64_tr_b16 v[20:21], v9 offset:32768
  v_mfma_f32_16x16x32_bf16 v[76:79], v[24:27], v[244:247], v[76:79]
  ds_read_b64_tr_b16 v[22:23], v9 offset:33792
  s_add_u32 m0, s46, 0
  s_add_u32 s47, s45, 1048576
  buffer_load_dwordx4 v1, s[28:31], s47 offen offset:0 lds
  v_fma_f32 v55, v55, v63, v47
  v_mul_f32 v48, 0x3e0293ee, v48
  v_mul_f32 v49, 0x3e0293ee, v49
  v_mul_f32 v50, 0x3e0293ee, v50
  s_waitcnt lgkmcnt(6)
  v_mfma_f32_16x16x32_bf16 v[80:83], v[28:31], v[240:243], v[80:83]
  ds_read_b64_tr_b16 v[24:25], v10 offset:32768
  v_mfma_f32_16x16x32_bf16 v[84:87], v[28:31], v[244:247], v[84:87]
  ds_read_b64_tr_b16 v[26:27], v10 offset:33792
  v_mul_f32 v51, 0x3e0293ee, v51
  v_mul_f32 v52, 0x3e0293ee, v52
  v_mul_f32 v53, 0x3e0293ee, v53
  v_mul_f32 v54, 0x3e0293ee, v54
  s_waitcnt lgkmcnt(6)
  v_mfma_f32_16x16x32_bf16 v[88:91], v[12:15], v[240:243], v[88:91]
  ds_read_b64_tr_b16 v[28:29], v11 offset:32768
  v_mfma_f32_16x16x32_bf16 v[92:95], v[12:15], v[244:247], v[92:95]
  ds_read_b64_tr_b16 v[30:31], v11 offset:33792
  s_add_u32 m0, s46, 0
  s_add_u32 s47, s45, 1080320
  buffer_load_dwordx4 v1, s[28:31], s47 offen offset:1024 lds
  v_mul_f32 v55, 0x3e0293ee, v55
  v_cvt_pk_bf16_f32 v44, v48, v49
  v_cvt_pk_bf16_f32 v45, v50, v51
  v_cvt_pk_bf16_f32 v46, v52, v53
  s_waitcnt lgkmcnt(6)
  v_mfma_f32_16x16x32_bf16 v[96:99], v[16:19], v[240:243], v[96:99]
  ds_read_b64_tr_b16 v[12:13], v4 offset:40960
  v_mfma_f32_16x16x32_bf16 v[100:103], v[16:19], v[244:247], v[100:103]
  ds_read_b64_tr_b16 v[14:15], v4 offset:41984
  v_cvt_pk_bf16_f32 v47, v54, v55
  ds_write_b128 v38, v[44:47]
  s_waitcnt lgkmcnt(7)
  v_mfma_f32_16x16x32_bf16 v[104:107], v[20:23], v[240:243], v[104:107]
  ds_read_b64_tr_b16 v[16:17], v5 offset:40960
  v_mfma_f32_16x16x32_bf16 v[108:111], v[20:23], v[244:247], v[108:111]
  ds_read_b64_tr_b16 v[18:19], v5 offset:41984
  s_waitcnt lgkmcnt(7)
  v_mfma_f32_16x16x32_bf16 v[112:115], v[24:27], v[240:243], v[112:115]
  ds_read_b64_tr_b16 v[20:21], v6 offset:40960
  v_mfma_f32_16x16x32_bf16 v[116:119], v[24:27], v[244:247], v[116:119]
  ds_read_b64_tr_b16 v[22:23], v6 offset:41984
  s_waitcnt lgkmcnt(7)
  v_mfma_f32_16x16x32_bf16 v[120:123], v[28:31], v[240:243], v[120:123]
  ds_read_b64_tr_b16 v[24:25], v7 offset:40960
  v_mfma_f32_16x16x32_bf16 v[124:127], v[28:31], v[244:247], v[124:127]
  ds_read_b64_tr_b16 v[26:27], v7 offset:41984
  s_waitcnt lgkmcnt(7)
  v_mfma_f32_16x16x32_bf16 v[64:67], v[12:15], v[248:251], v[64:67]
  ds_read_b64_tr_b16 v[28:29], v8 offset:40960
  v_mfma_f32_16x16x32_bf16 v[68:71], v[12:15], v[252:255], v[68:71]
  ds_read_b64_tr_b16 v[30:31], v8 offset:41984
  s_waitcnt lgkmcnt(6)
  v_mfma_f32_16x16x32_bf16 v[72:75], v[16:19], v[248:251], v[72:75]
  ds_read_b64_tr_b16 v[12:13], v9 offset:40960
  v_mfma_f32_16x16x32_bf16 v[76:79], v[16:19], v[252:255], v[76:79]
  ds_read_b64_tr_b16 v[14:15], v9 offset:41984
  s_waitcnt lgkmcnt(6)
  v_mfma_f32_16x16x32_bf16 v[80:83], v[20:23], v[248:251], v[80:83]
  ds_read_b64_tr_b16 v[16:17], v10 offset:40960
  v_mfma_f32_16x16x32_bf16 v[84:87], v[20:23], v[252:255], v[84:87]
  ds_read_b64_tr_b16 v[18:19], v10 offset:41984
  s_waitcnt lgkmcnt(6)
  v_mfma_f32_16x16x32_bf16 v[88:91], v[24:27], v[248:251], v[88:91]
  ds_read_b64_tr_b16 v[20:21], v11 offset:40960
  v_mfma_f32_16x16x32_bf16 v[92:95], v[24:27], v[252:255], v[92:95]
  ds_read_b64_tr_b16 v[22:23], v11 offset:41984
  s_waitcnt lgkmcnt(6)
  v_mfma_f32_16x16x32_bf16 v[96:99], v[28:31], v[248:251], v[96:99]
  s_barrier
  ds_read_b64_tr_b16 v[24:25], v4 offset:49152
  v_mfma_f32_16x16x32_bf16 v[100:103], v[28:31], v[252:255], v[100:103]
  ds_read_b64_tr_b16 v[26:27], v4 offset:50176
  ds_read_b128 v[44:47], v43
  s_waitcnt lgkmcnt(7)
  v_mfma_f32_16x16x32_bf16 v[104:107], v[12:15], v[248:251], v[104:107]
  ds_read_b64_tr_b16 v[28:29], v5 offset:49152
  v_mfma_f32_16x16x32_bf16 v[108:111], v[12:15], v[252:255], v[108:111]
  ds_read_b64_tr_b16 v[30:31], v5 offset:50176
  s_waitcnt lgkmcnt(7)
  v_mfma_f32_16x16x32_bf16 v[112:115], v[16:19], v[248:251], v[112:115]
  ds_read_b64_tr_b16 v[12:13], v6 offset:49152
  v_mfma_f32_16x16x32_bf16 v[116:119], v[16:19], v[252:255], v[116:119]
  ds_read_b64_tr_b16 v[14:15], v6 offset:50176
  s_add_u32 m0, s46, 81920
  s_add_u32 s47, s45, 1572864
  buffer_load_dwordx4 v1, s[28:31], s47 offen offset:0 lds
  s_waitcnt lgkmcnt(4)
  buffer_store_dwordx4 v[44:47], v42, s[24:27], s3 offen sc1
  v_mfma_f32_16x16x32_bf16 v[120:123], v[20:23], v[248:251], v[120:123]
  ds_read_b64_tr_b16 v[16:17], v7 offset:49152
  v_mfma_f32_16x16x32_bf16 v[124:127], v[20:23], v[252:255], v[124:127]
  ds_read_b64_tr_b16 v[18:19], v7 offset:50176
  v_cvt_pk_bf16_f32 v32, v64, v65
  v_cvt_pk_bf16_f32 v33, v66, v67
  v_cvt_pk_bf16_f32 v48, v68, v69
  v_cvt_pk_bf16_f32 v49, v70, v71
  v_mfma_f32_16x16x32_bf16 v[64:67], v[128:131], v[24:27], 0
  ds_read_b64_tr_b16 v[20:21], v8 offset:49152
  v_mfma_f32_16x16x32_bf16 v[68:71], v[132:135], v[24:27], 0
  ds_read_b64_tr_b16 v[22:23], v8 offset:50176
  s_add_u32 m0, s46, 81920
  s_add_u32 s47, s45, 1604608
  buffer_load_dwordx4 v1, s[28:31], s47 offen offset:1024 lds
  s_add_u32 m0, s46, 114688
  s_add_u32 s47, s45, 2621440
  buffer_load_dwordx4 v1, s[28:31], s47 offen offset:0 lds
  v_cvt_pk_bf16_f32 v34, v72, v73
  v_cvt_pk_bf16_f32 v35, v74, v75
  v_cvt_pk_bf16_f32 v50, v76, v77
  v_cvt_pk_bf16_f32 v51, v78, v79
  s_waitcnt lgkmcnt(6)
  v_mfma_f32_16x16x32_bf16 v[72:75], v[128:131], v[28:31], 0
  ds_read_b64_tr_b16 v[24:25], v9 offset:49152
  v_mfma_f32_16x16x32_bf16 v[76:79], v[132:135], v[28:31], 0
  ds_read_b64_tr_b16 v[26:27], v9 offset:50176
  v_cvt_pk_bf16_f32 v36, v80, v81
  v_cvt_pk_bf16_f32 v37, v82, v83
  v_cvt_pk_bf16_f32 v52, v84, v85
  v_cvt_pk_bf16_f32 v53, v86, v87
  s_waitcnt lgkmcnt(6)
  v_mfma_f32_16x16x32_bf16 v[80:83], v[128:131], v[12:15], 0
  ds_read_b64_tr_b16 v[28:29], v10 offset:49152
  v_mfma_f32_16x16x32_bf16 v[84:87], v[132:135], v[12:15], 0
  ds_read_b64_tr_b16 v[30:31], v10 offset:50176
  s_add_u32 m0, s46, 114688
  s_add_u32 s47, s45, 2653184
  buffer_load_dwordx4 v1, s[28:31], s47 offen offset:1024 lds
  s_and_b32 s16, s12, 3
  s_sub_u32 s18, 15, s14
  s_cmp_lt_u32 s12, 4
  s_cselect_b32 s18, s18, s14
  s_lshl_b32 s18, s18, 2
  s_add_u32 s40, s18, s16
  s_lshl_b32 s18, s40, 15
  s_lshl_b32 s19, s14, 7
  s_add_u32 s19, s19, 4
  s_lshl_b32 s17, s13, 10
  v_cvt_pk_bf16_f32 v38, v88, v89
  v_cvt_pk_bf16_f32 v39, v90, v91
  v_cvt_pk_bf16_f32 v54, v92, v93
  v_cvt_pk_bf16_f32 v55, v94, v95
  s_waitcnt lgkmcnt(6)
  v_mfma_f32_16x16x32_bf16 v[88:91], v[128:131], v[16:19], 0
  ds_read_b64_tr_b16 v[12:13], v11 offset:49152
  v_mfma_f32_16x16x32_bf16 v[92:95], v[132:135], v[16:19], 0
  ds_read_b64_tr_b16 v[14:15], v11 offset:50176
  v_cvt_pk_bf16_f32 v40, v96, v97
  v_cvt_pk_bf16_f32 v41, v98, v99
  v_cvt_pk_bf16_f32 v56, v100, v101
  v_cvt_pk_bf16_f32 v57, v102, v103
  s_waitcnt lgkmcnt(6)
  v_mfma_f32_16x16x32_bf16 v[96:99], v[128:131], v[20:23], 0
  ds_read_b64_tr_b16 v[16:17], v4 offset:57344
  v_mfma_f32_16x16x32_bf16 v[100:103], v[132:135], v[20:23], 0
  ds_read_b64_tr_b16 v[18:19], v4 offset:58368
  v_cvt_pk_bf16_f32 v42, v104, v105
  v_cvt_pk_bf16_f32 v43, v106, v107
  v_cvt_pk_bf16_f32 v58, v108, v109
  v_cvt_pk_bf16_f32 v59, v110, v111
  s_waitcnt lgkmcnt(6)
  v_mfma_f32_16x16x32_bf16 v[104:107], v[128:131], v[24:27], 0
  ds_read_b64_tr_b16 v[20:21], v5 offset:57344
  v_mfma_f32_16x16x32_bf16 v[108:111], v[132:135], v[24:27], 0
  ds_read_b64_tr_b16 v[22:23], v5 offset:58368
  v_cvt_pk_bf16_f32 v44, v112, v113
  v_cvt_pk_bf16_f32 v45, v114, v115
  v_cvt_pk_bf16_f32 v60, v116, v117
  v_cvt_pk_bf16_f32 v61, v118, v119
  s_waitcnt lgkmcnt(6)
  v_mfma_f32_16x16x32_bf16 v[112:115], v[128:131], v[28:31], 0
  ds_read_b64_tr_b16 v[24:25], v6 offset:57344
  v_mfma_f32_16x16x32_bf16 v[116:119], v[132:135], v[28:31], 0
  ds_read_b64_tr_b16 v[26:27], v6 offset:58368
  s_add_u32 m0, s46, 131072
  s_add_u32 s47, s45, 3145728
  buffer_load_dwordx4 v1, s[28:31], s47 offen offset:0 lds
  v_cvt_pk_bf16_f32 v46, v120, v121
  v_cvt_pk_bf16_f32 v47, v122, v123
  v_cvt_pk_bf16_f32 v62, v124, v125
  v_cvt_pk_bf16_f32 v63, v126, v127
  s_waitcnt lgkmcnt(6)
  v_mfma_f32_16x16x32_bf16 v[120:123], v[128:131], v[12:15], 0
  ds_read_b64_tr_b16 v[28:29], v7 offset:57344
  v_mfma_f32_16x16x32_bf16 v[124:127], v[132:135], v[12:15], 0
  ds_read_b64_tr_b16 v[30:31], v7 offset:58368
  s_waitcnt lgkmcnt(6)
  v_mfma_f32_16x16x32_bf16 v[64:67], v[136:139], v[16:19], v[64:67]
  ds_read_b64_tr_b16 v[12:13], v8 offset:57344
  v_mfma_f32_16x16x32_bf16 v[68:71], v[140:143], v[16:19], v[68:71]
  ds_read_b64_tr_b16 v[14:15], v8 offset:58368
  s_add_u32 m0, s46, 131072
  s_add_u32 s47, s45, 3177472
  buffer_load_dwordx4 v1, s[28:31], s47 offen offset:1024 lds
  s_waitcnt lgkmcnt(6)
  v_mfma_f32_16x16x32_bf16 v[72:75], v[136:139], v[20:23], v[72:75]
  ds_read_b64_tr_b16 v[16:17], v9 offset:57344
  v_mfma_f32_16x16x32_bf16 v[76:79], v[140:143], v[20:23], v[76:79]
  ds_read_b64_tr_b16 v[18:19], v9 offset:58368
  s_cmp_eq_u32 s12, 7
  s_cbranch_scc1 kvattn_kernel_st1
  buffer_store_dwordx4 v[32:35], v2, s[32:35], s43 offen offset:0 sc1
kvattn_kernel_st1:
  s_waitcnt lgkmcnt(6)
  v_mfma_f32_16x16x32_bf16 v[80:83], v[136:139], v[24:27], v[80:83]
  ds_read_b64_tr_b16 v[20:21], v10 offset:57344
  v_mfma_f32_16x16x32_bf16 v[84:87], v[140:143], v[24:27], v[84:87]
  ds_read_b64_tr_b16 v[22:23], v10 offset:58368
  s_waitcnt lgkmcnt(6)
  v_mfma_f32_16x16x32_bf16 v[88:91], v[136:139], v[28:31], v[88:91]
  ds_read_b64_tr_b16 v[24:25], v11 offset:57344
  v_mfma_f32_16x16x32_bf16 v[92:95], v[140:143], v[28:31], v[92:95]
  ds_read_b64_tr_b16 v[26:27], v11 offset:58368
  s_waitcnt lgkmcnt(6)
  v_mfma_f32_16x16x32_bf16 v[96:99], v[136:139], v[12:15], v[96:99]
  s_waitcnt vmcnt(11)
  s_barrier
  v_xor_b32 v4, 0x10000, v4
  v_xor_b32 v5, 0x10000, v5
  v_xor_b32 v6, 0x10000, v6
  v_xor_b32 v7, 0x10000, v7
  v_xor_b32 v8, 0x10000, v8
  v_xor_b32 v9, 0x10000, v9
  v_xor_b32 v10, 0x10000, v10
  v_xor_b32 v11, 0x10000, v11
  ds_read_b64_tr_b16 v[28:29], v4 offset:0
  v_mfma_f32_16x16x32_bf16 v[100:103], v[140:143], v[12:15], v[100:103]
  ds_read_b64_tr_b16 v[30:31], v4 offset:1024
  s_waitcnt lgkmcnt(6)
  v_mfma_f32_16x16x32_bf16 v[104:107], v[136:139], v[16:19], v[104:107]
  ds_read_b64_tr_b16 v[12:13], v5 offset:0
  v_mfma_f32_16x16x32_bf16 v[108:111], v[140:143], v[16:19], v[108:111]
  ds_read_b64_tr_b16 v[14:15], v5 offset:1024
  s_waitcnt lgkmcnt(6)
  v_mfma_f32_16x16x32_bf16 v[112:115], v[136:139], v[20:23], v[112:115]
  ds_read_b64_tr_b16 v[16:17], v6 offset:0
  v_mfma_f32_16x16x32_bf16 v[116:119], v[140:143], v[20:23], v[116:119]
  ds_read_b64_tr_b16 v[18:19], v6 offset:1024
  s_add_u32 m0, s46, 147456
  s_add_u32 s47, s45, 3670016
  buffer_load_dwordx4 v1, s[28:31], s47 offen offset:0 lds
  s_waitcnt lgkmcnt(6)
  v_mfma_f32_16x16x32_bf16 v[120:123], v[136:139], v[24:27], v[120:123]
  ds_read_b64_tr_b16 v[20:21], v7 offset:0
  v_mfma_f32_16x16x32_bf16 v[124:127], v[140:143], v[24:27], v[124:127]
  ds_read_b64_tr_b16 v[22:23], v7 offset:1024
  s_cmp_eq_u32 s12, 7
  s_cbranch_scc1 kvattn_kernel_st2
  buffer_store_dwordx4 v[36:39], v2, s[32:35], s43 offen offset:1024 sc1
kvattn_kernel_st2:
  s_waitcnt lgkmcnt(6)
  v_mfma_f32_16x16x32_bf16 v[64:67], v[144:147], v[28:31], v[64:67]
  ds_read_b64_tr_b16 v[24:25], v8 offset:0
  v_mfma_f32_16x16x32_bf16 v[68:71], v[148:151], v[28:31], v[68:71]
  ds_read_b64_tr_b16 v[26:27], v8 offset:1024
  s_add_u32 m0, s46, 147456
  s_add_u32 s47, s45, 3701760
  buffer_load_dwordx4 v1, s[28:31], s47 offen offset:1024 lds
  s_waitcnt lgkmcnt(6)
  v_mfma_f32_16x16x32_bf16 v[72:75], v[144:147], v[12:15], v[72:75]
  ds_read_b64_tr_b16 v[28:29], v9 offset:0
  v_mfma_f32_16x16x32_bf16 v[76:79], v[148:151], v[12:15], v[76:79]
  ds_read_b64_tr_b16 v[30:31], v9 offset:1024
  s_waitcnt lgkmcnt(6)
  v_mfma_f32_16x16x32_bf16 v[80:83], v[144:147], v[16:19], v[80:83]
  ds_read_b64_tr_b16 v[12:13], v10 offset:0
  v_mfma_f32_16x16x32_bf16 v[84:87], v[148:151], v[16:19], v[84:87]
  ds_read_b64_tr_b16 v[14:15], v10 offset:1024
  s_waitcnt lgkmcnt(6)
  v_mfma_f32_16x16x32_bf16 v[88:91], v[144:147], v[20:23], v[88:91]
  ds_read_b64_tr_b16 v[16:17], v11 offset:0
  v_mfma_f32_16x16x32_bf16 v[92:95], v[148:151], v[20:23], v[92:95]
  ds_read_b64_tr_b16 v[18:19], v11 offset:1024
  s_waitcnt lgkmcnt(6)
  v_mfma_f32_16x16x32_bf16 v[96:99], v[144:147], v[24:27], v[96:99]
  ds_read_b64_tr_b16 v[20:21], v4 offset:8192
  v_mfma_f32_16x16x32_bf16 v[100:103], v[148:151], v[24:27], v[100:103]
  ds_read_b64_tr_b16 v[22:23], v4 offset:9216
  s_add_u32 m0, s46, 16384
  s_add_u32 s47, s45, 0
  buffer_load_dwordx4 v1, s[52:55], s47 offen offset:0 lds
  s_waitcnt lgkmcnt(6)
  v_mfma_f32_16x16x32_bf16 v[104:107], v[144:147], v[28:31], v[104:107]
  ds_read_b64_tr_b16 v[24:25], v5 offset:8192
  v_mfma_f32_16x16x32_bf16 v[108:111], v[148:151], v[28:31], v[108:111]
  ds_read_b64_tr_b16 v[26:27], v5 offset:9216
  s_cmp_eq_u32 s12, 7
  s_cbranch_scc1 kvattn_kernel_st3
  buffer_store_dwordx4 v[40:43], v2, s[32:35], s43 offen offset:2048 sc1
kvattn_kernel_st3:
  s_waitcnt lgkmcnt(6)
  v_mfma_f32_16x16x32_bf16 v[112:115], v[144:147], v[12:15], v[112:115]
  ds_read_b64_tr_b16 v[28:29], v6 offset:8192
  v_mfma_f32_16x16x32_bf16 v[116:119], v[148:151], v[12:15], v[116:119]
  ds_read_b64_tr_b16 v[30:31], v6 offset:9216
  s_add_u32 m0, s46, 16384
  s_add_u32 s47, s45, 31744
  buffer_load_dwordx4 v1, s[52:55], s47 offen offset:1024 lds
  s_waitcnt lgkmcnt(6)
  v_mfma_f32_16x16x32_bf16 v[120:123], v[144:147], v[16:19], v[120:123]
  ds_read_b64_tr_b16 v[12:13], v7 offset:8192
  v_mfma_f32_16x16x32_bf16 v[124:127], v[148:151], v[16:19], v[124:127]
  ds_read_b64_tr_b16 v[14:15], v7 offset:9216
  s_waitcnt lgkmcnt(6)
  v_mfma_f32_16x16x32_bf16 v[64:67], v[152:155], v[20:23], v[64:67]
  ds_read_b64_tr_b16 v[16:17], v8 offset:8192
  v_mfma_f32_16x16x32_bf16 v[68:71], v[156:159], v[20:23], v[68:71]
  ds_read_b64_tr_b16 v[18:19], v8 offset:9216
  s_waitcnt lgkmcnt(6)
  v_mfma_f32_16x16x32_bf16 v[72:75], v[152:155], v[24:27], v[72:75]
  ds_read_b64_tr_b16 v[20:21], v9 offset:8192
  v_mfma_f32_16x16x32_bf16 v[76:79], v[156:159], v[24:27], v[76:79]
  ds_read_b64_tr_b16 v[22:23], v9 offset:9216
  s_waitcnt lgkmcnt(6)
  v_mfma_f32_16x16x32_bf16 v[80:83], v[152:155], v[28:31], v[80:83]
  ds_read_b64_tr_b16 v[24:25], v10 offset:8192
  v_mfma_f32_16x16x32_bf16 v[84:87], v[156:159], v[28:31], v[84:87]
  ds_read_b64_tr_b16 v[26:27], v10 offset:9216
  s_add_u32 m0, s46, 32768
  s_add_u32 s47, s45, 524288
  buffer_load_dwordx4 v1, s[52:55], s47 offen offset:0 lds
  s_waitcnt lgkmcnt(6)
  v_mfma_f32_16x16x32_bf16 v[88:91], v[152:155], v[12:15], v[88:91]
  ds_read_b64_tr_b16 v[28:29], v11 offset:8192
  v_mfma_f32_16x16x32_bf16 v[92:95], v[156:159], v[12:15], v[92:95]
  ds_read_b64_tr_b16 v[30:31], v11 offset:9216
  s_cmp_eq_u32 s12, 7
  s_cbranch_scc1 kvattn_kernel_st4
  buffer_store_dwordx4 v[44:47], v2, s[32:35], s43 offen offset:3072 sc1
kvattn_kernel_st4:
  s_waitcnt lgkmcnt(6)
  v_mfma_f32_16x16x32_bf16 v[96:99], v[152:155], v[16:19], v[96:99]
  s_waitcnt vmcnt(12)
  s_waitcnt vmcnt(10)
  s_barrier
  v_mov_b32 v3, s85
  s_mov_b64 exec, 1
  buffer_store_dword v3, off, s[96:99], s100 offset:4 sc1
  s_mov_b64 exec, -1
  v_xor_b32 v4, 0x10000, v4
  v_xor_b32 v5, 0x10000, v5
  v_xor_b32 v6, 0x10000, v6
  v_xor_b32 v7, 0x10000, v7
  v_xor_b32 v8, 0x10000, v8
  v_xor_b32 v9, 0x10000, v9
  v_xor_b32 v10, 0x10000, v10
  v_xor_b32 v11, 0x10000, v11
  ds_read_b64_tr_b16 v[12:13], v4 offset:0
  v_mfma_f32_16x16x32_bf16 v[100:103], v[156:159], v[16:19], v[100:103]
  ds_read_b64_tr_b16 v[14:15], v4 offset:1024
  s_add_u32 m0, s46, 32768
  s_add_u32 s47, s45, 556032
  buffer_load_dwordx4 v1, s[52:55], s47 offen offset:1024 lds
  s_waitcnt lgkmcnt(6)
  v_mfma_f32_16x16x32_bf16 v[104:107], v[152:155], v[20:23], v[104:107]
  ds_read_b64_tr_b16 v[16:17], v5 offset:0
  v_mfma_f32_16x16x32_bf16 v[108:111], v[156:159], v[20:23], v[108:111]
  ds_read_b64_tr_b16 v[18:19], v5 offset:1024
  s_waitcnt lgkmcnt(6)
  v_mfma_f32_16x16x32_bf16 v[112:115], v[152:155], v[24:27], v[112:115]
  ds_read_b64_tr_b16 v[20:21], v6 offset:0
  v_mfma_f32_16x16x32_bf16 v[116:119], v[156:159], v[24:27], v[116:119]
  ds_read_b64_tr_b16 v[22:23], v6 offset:1024
  s_waitcnt lgkmcnt(6)
  v_mfma_f32_16x16x32_bf16 v[120:123], v[152:155], v[28:31], v[120:123]
  ds_read_b64_tr_b16 v[24:25], v7 offset:0
  v_mfma_f32_16x16x32_bf16 v[124:127], v[156:159], v[28:31], v[124:127]
  ds_read_b64_tr_b16 v[26:27], v7 offset:1024
  s_waitcnt lgkmcnt(6)
  v_mfma_f32_16x16x32_bf16 v[64:67], v[160:163], v[12:15], v[64:67]
  ds_read_b64_tr_b16 v[28:29], v8 offset:0
  v_mfma_f32_16x16x32_bf16 v[68:71], v[164:167], v[12:15], v[68:71]
  ds_read_b64_tr_b16 v[30:31], v8 offset:1024
  s_waitcnt lgkmcnt(6)
  v_mfma_f32_16x16x32_bf16 v[72:75], v[160:163], v[16:19], v[72:75]
  ds_read_b64_tr_b16 v[12:13], v9 offset:0
  v_mfma_f32_16x16x32_bf16 v[76:79], v[164:167], v[16:19], v[76:79]
  ds_read_b64_tr_b16 v[14:15], v9 offset:1024
  s_cmp_eq_u32 s12, 7
  s_cbranch_scc1 kvattn_kernel_st5
  buffer_store_dwordx4 v[48:51], v2, s[32:35], s44 offen offset:0 sc1
kvattn_kernel_st5:
  s_waitcnt lgkmcnt(6)
  v_mfma_f32_16x16x32_bf16 v[80:83], v[160:163], v[20:23], v[80:83]
  ds_read_b64_tr_b16 v[16:17], v10 offset:0
  v_mfma_f32_16x16x32_bf16 v[84:87], v[164:167], v[20:23], v[84:87]
  ds_read_b64_tr_b16 v[18:19], v10 offset:1024
  s_add_u32 m0, s46, 49152
  s_add_u32 s47, s45, 1048576
  buffer_load_dwordx4 v1, s[52:55], s47 offen offset:0 lds
  s_waitcnt lgkmcnt(6)
  v_mfma_f32_16x16x32_bf16 v[88:91], v[160:163], v[24:27], v[88:91]
  ds_read_b64_tr_b16 v[20:21], v11 offset:0
  v_mfma_f32_16x16x32_bf16 v[92:95], v[164:167], v[24:27], v[92:95]
  ds_read_b64_tr_b16 v[22:23], v11 offset:1024
  s_waitcnt lgkmcnt(6)
  v_mfma_f32_16x16x32_bf16 v[96:99], v[160:163], v[28:31], v[96:99]
  ds_read_b64_tr_b16 v[24:25], v4 offset:8192
  v_mfma_f32_16x16x32_bf16 v[100:103], v[164:167], v[28:31], v[100:103]
  ds_read_b64_tr_b16 v[26:27], v4 offset:9216
  s_add_u32 m0, s46, 49152
  s_add_u32 s47, s45, 1080320
  buffer_load_dwordx4 v1, s[52:55], s47 offen offset:1024 lds
  s_waitcnt lgkmcnt(6)
  v_mfma_f32_16x16x32_bf16 v[104:107], v[160:163], v[12:15], v[104:107]
  ds_read_b64_tr_b16 v[28:29], v5 offset:8192
  v_mfma_f32_16x16x32_bf16 v[108:111], v[164:167], v[12:15], v[108:111]
  ds_read_b64_tr_b16 v[30:31], v5 offset:9216
  s_waitcnt lgkmcnt(6)
  v_mfma_f32_16x16x32_bf16 v[112:115], v[160:163], v[16:19], v[112:115]
  ds_read_b64_tr_b16 v[12:13], v6 offset:8192
  v_mfma_f32_16x16x32_bf16 v[116:119], v[164:167], v[16:19], v[116:119]
  ds_read_b64_tr_b16 v[14:15], v6 offset:9216
  s_waitcnt lgkmcnt(6)
  v_mfma_f32_16x16x32_bf16 v[120:123], v[160:163], v[20:23], v[120:123]
  ds_read_b64_tr_b16 v[16:17], v7 offset:8192
  v_mfma_f32_16x16x32_bf16 v[124:127], v[164:167], v[20:23], v[124:127]
  ds_read_b64_tr_b16 v[18:19], v7 offset:9216
  s_cmp_eq_u32 s12, 7
  s_cbranch_scc1 kvattn_kernel_st6
  buffer_store_dwordx4 v[52:55], v2, s[32:35], s44 offen offset:1024 sc1
kvattn_kernel_st6:
  s_waitcnt lgkmcnt(6)
  v_mfma_f32_16x16x32_bf16 v[64:67], v[168:171], v[24:27], v[64:67]
  ds_read_b64_tr_b16 v[20:21], v8 offset:8192
  v_mfma_f32_16x16x32_bf16 v[68:71], v[172:175], v[24:27], v[68:71]
  ds_read_b64_tr_b16 v[22:23], v8 offset:9216
  s_waitcnt lgkmcnt(6)
  v_mfma_f32_16x16x32_bf16 v[72:75], v[168:171], v[28:31], v[72:75]
  ds_read_b64_tr_b16 v[24:25], v9 offset:8192
  v_mfma_f32_16x16x32_bf16 v[76:79], v[172:175], v[28:31], v[76:79]
  ds_read_b64_tr_b16 v[26:27], v9 offset:9216
  s_waitcnt lgkmcnt(6)
  v_mfma_f32_16x16x32_bf16 v[80:83], v[168:171], v[12:15], v[80:83]
  ds_read_b64_tr_b16 v[28:29], v10 offset:8192
  v_mfma_f32_16x16x32_bf16 v[84:87], v[172:175], v[12:15], v[84:87]
  ds_read_b64_tr_b16 v[30:31], v10 offset:9216
  s_waitcnt lgkmcnt(6)
  v_mfma_f32_16x16x32_bf16 v[88:91], v[168:171], v[16:19], v[88:91]
  ds_read_b64_tr_b16 v[12:13], v11 offset:8192
  v_mfma_f32_16x16x32_bf16 v[92:95], v[172:175], v[16:19], v[92:95]
  ds_read_b64_tr_b16 v[14:15], v11 offset:9216
  s_waitcnt lgkmcnt(6)
  v_mfma_f32_16x16x32_bf16 v[96:99], v[168:171], v[20:23], v[96:99]
  s_waitcnt vmcnt(13)
  s_barrier
  v_xor_b32 v4, 0x10000, v4
  v_xor_b32 v5, 0x10000, v5
  v_xor_b32 v6, 0x10000, v6
  v_xor_b32 v7, 0x10000, v7
  v_xor_b32 v8, 0x10000, v8
  v_xor_b32 v9, 0x10000, v9
  v_xor_b32 v10, 0x10000, v10
  v_xor_b32 v11, 0x10000, v11
  ds_read_b64_tr_b16 v[16:17], v4 offset:16384
  v_mfma_f32_16x16x32_bf16 v[100:103], v[172:175], v[20:23], v[100:103]
  ds_read_b64_tr_b16 v[18:19], v4 offset:17408
  s_cmp_eq_u32 s12, 7
  s_cbranch_scc0 kvattn_kernel_p1h
  v_and_b32 v3, 31, v0
  v_lshlrev_b32 v3, 10, v3
  buffer_load_dword v3, v3, s[96:99], s19 offen sc1
kvattn_kernel_p1h:
  s_waitcnt lgkmcnt(6)
  v_mfma_f32_16x16x32_bf16 v[104:107], v[168:171], v[24:27], v[104:107]
  ds_read_b64_tr_b16 v[20:21], v5 offset:16384
  v_mfma_f32_16x16x32_bf16 v[108:111], v[172:175], v[24:27], v[108:111]
  ds_read_b64_tr_b16 v[22:23], v5 offset:17408
  s_cmp_eq_u32 s12, 7
  s_cbranch_scc1 kvattn_kernel_st7
  buffer_store_dwordx4 v[56:59], v2, s[32:35], s44 offen offset:2048 sc1
kvattn_kernel_st7:
  s_waitcnt lgkmcnt(6)
  v_mfma_f32_16x16x32_bf16 v[112:115], v[168:171], v[28:31], v[112:115]
  ds_read_b64_tr_b16 v[24:25], v6 offset:16384
  v_mfma_f32_16x16x32_bf16 v[116:119], v[172:175], v[28:31], v[116:119]
  ds_read_b64_tr_b16 v[26:27], v6 offset:17408
  s_add_u32 m0, s46, 65536
  s_add_u32 s47, s45, 1572864
  buffer_load_dwordx4 v1, s[52:55], s47 offen offset:0 lds
  s_waitcnt lgkmcnt(6)
  v_mfma_f32_16x16x32_bf16 v[120:123], v[168:171], v[12:15], v[120:123]
  ds_read_b64_tr_b16 v[28:29], v7 offset:16384
  v_mfma_f32_16x16x32_bf16 v[124:127], v[172:175], v[12:15], v[124:127]
  ds_read_b64_tr_b16 v[30:31], v7 offset:17408
  s_waitcnt lgkmcnt(6)
  v_mfma_f32_16x16x32_bf16 v[64:67], v[176:179], v[16:19], v[64:67]
  ds_read_b64_tr_b16 v[12:13], v8 offset:16384
  v_mfma_f32_16x16x32_bf16 v[68:71], v[180:183], v[16:19], v[68:71]
  ds_read_b64_tr_b16 v[14:15], v8 offset:17408
  s_add_u32 m0, s46, 65536
  s_add_u32 s47, s45, 1604608
  buffer_load_dwordx4 v1, s[52:55], s47 offen offset:1024 lds
  s_waitcnt lgkmcnt(6)
  v_mfma_f32_16x16x32_bf16 v[72:75], v[176:179], v[20:23], v[72:75]
  ds_read_b64_tr_b16 v[16:17], v9 offset:16384
  v_mfma_f32_16x16x32_bf16 v[76:79], v[180:183], v[20:23], v[76:79]
  ds_read_b64_tr_b16 v[18:19], v9 offset:17408
  s_waitcnt lgkmcnt(6)
  v_mfma_f32_16x16x32_bf16 v[80:83], v[176:179], v[24:27], v[80:83]
  ds_read_b64_tr_b16 v[20:21], v10 offset:16384
  v_mfma_f32_16x16x32_bf16 v[84:87], v[180:183], v[24:27], v[84:87]
  ds_read_b64_tr_b16 v[22:23], v10 offset:17408
  s_waitcnt lgkmcnt(6)
  v_mfma_f32_16x16x32_bf16 v[88:91], v[176:179], v[28:31], v[88:91]
  ds_read_b64_tr_b16 v[24:25], v11 offset:16384
  v_mfma_f32_16x16x32_bf16 v[92:95], v[180:183], v[28:31], v[92:95]
  ds_read_b64_tr_b16 v[26:27], v11 offset:17408
  s_cmp_eq_u32 s12, 7
  s_cbranch_scc1 kvattn_kernel_st8
  buffer_store_dwordx4 v[60:63], v2, s[32:35], s44 offen offset:3072 sc1
kvattn_kernel_st8:
  s_waitcnt lgkmcnt(6)
  v_mfma_f32_16x16x32_bf16 v[96:99], v[176:179], v[12:15], v[96:99]
  ds_read_b64_tr_b16 v[28:29], v4 offset:24576
  v_mfma_f32_16x16x32_bf16 v[100:103], v[180:183], v[12:15], v[100:103]
  ds_read_b64_tr_b16 v[30:31], v4 offset:25600
  s_waitcnt lgkmcnt(6)
  v_mfma_f32_16x16x32_bf16 v[104:107], v[176:179], v[16:19], v[104:107]
  ds_read_b64_tr_b16 v[12:13], v5 offset:24576
  v_mfma_f32_16x16x32_bf16 v[108:111], v[180:183], v[16:19], v[108:111]
  ds_read_b64_tr_b16 v[14:15], v5 offset:25600
  s_waitcnt lgkmcnt(6)
  v_mfma_f32_16x16x32_bf16 v[112:115], v[176:179], v[20:23], v[112:115]
  ds_read_b64_tr_b16 v[16:17], v6 offset:24576
  v_mfma_f32_16x16x32_bf16 v[116:119], v[180:183], v[20:23], v[116:119]
  ds_read_b64_tr_b16 v[18:19], v6 offset:25600
  s_waitcnt lgkmcnt(6)
  v_mfma_f32_16x16x32_bf16 v[120:123], v[176:179], v[24:27], v[120:123]
  ds_read_b64_tr_b16 v[20:21], v7 offset:24576
  v_mfma_f32_16x16x32_bf16 v[124:127], v[180:183], v[24:27], v[124:127]
  ds_read_b64_tr_b16 v[22:23], v7 offset:25600
  s_waitcnt lgkmcnt(6)
  v_mfma_f32_16x16x32_bf16 v[64:67], v[184:187], v[28:31], v[64:67]
  ds_read_b64_tr_b16 v[24:25], v8 offset:24576
  v_mfma_f32_16x16x32_bf16 v[68:71], v[188:191], v[28:31], v[68:71]
  ds_read_b64_tr_b16 v[26:27], v8 offset:25600
  s_waitcnt lgkmcnt(6)
  v_mfma_f32_16x16x32_bf16 v[72:75], v[184:187], v[12:15], v[72:75]
  ds_read_b64_tr_b16 v[28:29], v9 offset:24576
  v_mfma_f32_16x16x32_bf16 v[76:79], v[188:191], v[12:15], v[76:79]
  ds_read_b64_tr_b16 v[30:31], v9 offset:25600
  s_waitcnt lgkmcnt(6)
  v_mfma_f32_16x16x32_bf16 v[80:83], v[184:187], v[16:19], v[80:83]
  ds_read_b64_tr_b16 v[12:13], v10 offset:24576
  v_mfma_f32_16x16x32_bf16 v[84:87], v[188:191], v[16:19], v[84:87]
  ds_read_b64_tr_b16 v[14:15], v10 offset:25600
  s_cmp_eq_u32 s12, 7
  s_cbranch_scc0 kvattn_kernel_p2h
  s_waitcnt vmcnt(2)
  v_cmp_ne_u32 vcc, s85, v3
  s_cbranch_vccnz kvattn_kernel_spinh
kvattn_kernel_readyh:
kvattn_kernel_p2h:
  s_waitcnt lgkmcnt(6)
  v_mfma_f32_16x16x32_bf16 v[88:91], v[184:187], v[20:23], v[88:91]
  ds_read_b64_tr_b16 v[16:17], v11 offset:24576
  v_mfma_f32_16x16x32_bf16 v[92:95], v[188:191], v[20:23], v[92:95]
  ds_read_b64_tr_b16 v[18:19], v11 offset:25600
  s_waitcnt lgkmcnt(6)
  v_mfma_f32_16x16x32_bf16 v[96:99], v[184:187], v[24:27], v[96:99]
  s_barrier
  ds_read_b64_tr_b16 v[20:21], v4 offset:32768
  v_mfma_f32_16x16x32_bf16 v[100:103], v[188:191], v[24:27], v[100:103]
  ds_read_b64_tr_b16 v[22:23], v4 offset:33792
  s_waitcnt lgkmcnt(6)
  v_mfma_f32_16x16x32_bf16 v[104:107], v[184:187], v[28:31], v[104:107]
  ds_read_b64_tr_b16 v[24:25], v5 offset:32768
  v_mfma_f32_16x16x32_bf16 v[108:111], v[188:191], v[28:31], v[108:111]
  ds_read_b64_tr_b16 v[26:27], v5 offset:33792
  s_add_u32 s62, s18, 0
  buffer_load_dwordx4 v[128:131], v2, s[24:27], s62 offen offset:0 sc1
  s_waitcnt lgkmcnt(6)
  v_mfma_f32_16x16x32_bf16 v[112:115], v[184:187], v[12:15], v[112:115]
  ds_read_b64_tr_b16 v[28:29], v6 offset:32768
  v_mfma_f32_16x16x32_bf16 v[116:119], v[188:191], v[12:15], v[116:119]
  ds_read_b64_tr_b16 v[30:31], v6 offset:33792
  s_add_u32 m0, s46, 0
  s_add_u32 s47, s45, 2097152
  buffer_load_dwordx4 v1, s[52:55], s47 offen offset:0 lds
  s_waitcnt lgkmcnt(6)
  v_mfma_f32_16x16x32_bf16 v[120:123], v[184:187], v[16:19], v[120:123]
  ds_read_b64_tr_b16 v[12:13], v7 offset:32768
  v_mfma_f32_16x16x32_bf16 v[124:127], v[188:191], v[16:19], v[124:127]
  ds_read_b64_tr_b16 v[14:15], v7 offset:33792
  s_add_u32 s62, s18, 0
  buffer_load_dwordx4 v[132:135], v2, s[24:27], s62 offen offset:1024 sc1
  s_waitcnt lgkmcnt(6)
  v_mfma_f32_16x16x32_bf16 v[64:67], v[192:195], v[20:23], v[64:67]
  ds_read_b64_tr_b16 v[16:17], v8 offset:32768
  v_mfma_f32_16x16x32_bf16 v[68:71], v[196:199], v[20:23], v[68:71]
  ds_read_b64_tr_b16 v[18:19], v8 offset:33792
  s_add_u32 m0, s46, 0
  s_add_u32 s47, s45, 2128896
  buffer_load_dwordx4 v1, s[52:55], s47 offen offset:1024 lds
  s_waitcnt lgkmcnt(6)
  v_mfma_f32_16x16x32_bf16 v[72:75], v[192:195], v[24:27], v[72:75]
  ds_read_b64_tr_b16 v[20:21], v9 offset:32768
  v_mfma_f32_16x16x32_bf16 v[76:79], v[196:199], v[24:27], v[76:79]
  ds_read_b64_tr_b16 v[22:23], v9 offset:33792
  s_cmp_eq_u32 s12, 7
  s_cbranch_scc0 kvattn_kernel_st9
  buffer_store_dwordx4 v[32:35], v2, s[32:35], s43 offen offset:0 sc1
kvattn_kernel_st9:
  s_waitcnt lgkmcnt(6)
  v_mfma_f32_16x16x32_bf16 v[80:83], v[192:195], v[28:31], v[80:83]
  ds_read_b64_tr_b16 v[24:25], v10 offset:32768
  v_mfma_f32_16x16x32_bf16 v[84:87], v[196:199], v[28:31], v[84:87]
  ds_read_b64_tr_b16 v[26:27], v10 offset:33792
  s_waitcnt lgkmcnt(6)
  v_mfma_f32_16x16x32_bf16 v[88:91], v[192:195], v[12:15], v[88:91]
  ds_read_b64_tr_b16 v[28:29], v11 offset:32768
  v_mfma_f32_16x16x32_bf16 v[92:95], v[196:199], v[12:15], v[92:95]
  ds_read_b64_tr_b16 v[30:31], v11 offset:33792
  s_add_u32 s62, s18, 2048
  buffer_load_dwordx4 v[136:139], v2, s[24:27], s62 offen offset:0 sc1
  s_waitcnt lgkmcnt(6)
  v_mfma_f32_16x16x32_bf16 v[96:99], v[192:195], v[16:19], v[96:99]
  ds_read_b64_tr_b16 v[12:13], v4 offset:40960
  v_mfma_f32_16x16x32_bf16 v[100:103], v[196:199], v[16:19], v[100:103]
  ds_read_b64_tr_b16 v[14:15], v4 offset:41984
  s_waitcnt lgkmcnt(6)
  v_mfma_f32_16x16x32_bf16 v[104:107], v[192:195], v[20:23], v[104:107]
  ds_read_b64_tr_b16 v[16:17], v5 offset:40960
  v_mfma_f32_16x16x32_bf16 v[108:111], v[196:199], v[20:23], v[108:111]
  ds_read_b64_tr_b16 v[18:19], v5 offset:41984
  s_add_u32 s62, s18, 2048
  buffer_load_dwordx4 v[140:143], v2, s[24:27], s62 offen offset:1024 sc1
  s_waitcnt lgkmcnt(6)
  v_mfma_f32_16x16x32_bf16 v[112:115], v[192:195], v[24:27], v[112:115]
  ds_read_b64_tr_b16 v[20:21], v6 offset:40960
  v_mfma_f32_16x16x32_bf16 v[116:119], v[196:199], v[24:27], v[116:119]
  ds_read_b64_tr_b16 v[22:23], v6 offset:41984
  s_waitcnt lgkmcnt(6)
  v_mfma_f32_16x16x32_bf16 v[120:123], v[192:195], v[28:31], v[120:123]
  ds_read_b64_tr_b16 v[24:25], v7 offset:40960
  v_mfma_f32_16x16x32_bf16 v[124:127], v[196:199], v[28:31], v[124:127]
  ds_read_b64_tr_b16 v[26:27], v7 offset:41984
  s_waitcnt lgkmcnt(6)
  v_mfma_f32_16x16x32_bf16 v[64:67], v[200:203], v[12:15], v[64:67]
  ds_read_b64_tr_b16 v[28:29], v8 offset:40960
  v_mfma_f32_16x16x32_bf16 v[68:71], v[204:207], v[12:15], v[68:71]
  ds_read_b64_tr_b16 v[30:31], v8 offset:41984
  s_cmp_eq_u32 s12, 7
  s_cbranch_scc0 kvattn_kernel_st10
  buffer_store_dwordx4 v[36:39], v2, s[32:35], s43 offen offset:1024 sc1
kvattn_kernel_st10:
  s_waitcnt lgkmcnt(6)
  v_mfma_f32_16x16x32_bf16 v[72:75], v[200:203], v[16:19], v[72:75]
  ds_read_b64_tr_b16 v[12:13], v9 offset:40960
  v_mfma_f32_16x16x32_bf16 v[76:79], v[204:207], v[16:19], v[76:79]
  ds_read_b64_tr_b16 v[14:15], v9 offset:41984
  s_waitcnt lgkmcnt(6)
  v_mfma_f32_16x16x32_bf16 v[80:83], v[200:203], v[20:23], v[80:83]
  ds_read_b64_tr_b16 v[16:17], v10 offset:40960
  v_mfma_f32_16x16x32_bf16 v[84:87], v[204:207], v[20:23], v[84:87]
  ds_read_b64_tr_b16 v[18:19], v10 offset:41984
  s_add_u32 s62, s18, 4096
  buffer_load_dwordx4 v[144:147], v2, s[24:27], s62 offen offset:0 sc1
  s_waitcnt lgkmcnt(6)
  v_mfma_f32_16x16x32_bf16 v[88:91], v[200:203], v[24:27], v[88:91]
  ds_read_b64_tr_b16 v[20:21], v11 offset:40960
  v_mfma_f32_16x16x32_bf16 v[92:95], v[204:207], v[24:27], v[92:95]
  ds_read_b64_tr_b16 v[22:23], v11 offset:41984
  s_waitcnt lgkmcnt(6)
  v_mfma_f32_16x16x32_bf16 v[96:99], v[200:203], v[28:31], v[96:99]
  s_waitcnt vmcnt(20)
  s_barrier
  ds_read_b64_tr_b16 v[24:25], v4 offset:49152
  v_mfma_f32_16x16x32_bf16 v[100:103], v[204:207], v[28:31], v[100:103]
  ds_read_b64_tr_b16 v[26:27], v4 offset:50176
  s_add_u32 s62, s18, 4096
  buffer_load_dwordx4 v[148:151], v2, s[24:27], s62 offen offset:1024 sc1
  s_waitcnt lgkmcnt(6)
  v_mfma_f32_16x16x32_bf16 v[104:107], v[200:203], v[12:15], v[104:107]
  ds_read_b64_tr_b16 v[28:29], v5 offset:49152
  v_mfma_f32_16x16x32_bf16 v[108:111], v[204:207], v[12:15], v[108:111]
  ds_read_b64_tr_b16 v[30:31], v5 offset:50176
  s_waitcnt lgkmcnt(6)
  v_mfma_f32_16x16x32_bf16 v[112:115], v[200:203], v[16:19], v[112:115]
  ds_read_b64_tr_b16 v[12:13], v6 offset:49152
  v_mfma_f32_16x16x32_bf16 v[116:119], v[204:207], v[16:19], v[116:119]
  ds_read_b64_tr_b16 v[14:15], v6 offset:50176
  s_waitcnt lgkmcnt(6)
  v_mfma_f32_16x16x32_bf16 v[120:123], v[200:203], v[20:23], v[120:123]
  ds_read_b64_tr_b16 v[16:17], v7 offset:49152
  v_mfma_f32_16x16x32_bf16 v[124:127], v[204:207], v[20:23], v[124:127]
  ds_read_b64_tr_b16 v[18:19], v7 offset:50176
  s_cmp_eq_u32 s12, 7
  s_cbranch_scc0 kvattn_kernel_st11
  buffer_store_dwordx4 v[40:43], v2, s[32:35], s43 offen offset:2048 sc1
kvattn_kernel_st11:
  s_waitcnt lgkmcnt(6)
  v_mfma_f32_16x16x32_bf16 v[64:67], v[208:211], v[24:27], v[64:67]
  ds_read_b64_tr_b16 v[20:21], v8 offset:49152
  v_mfma_f32_16x16x32_bf16 v[68:71], v[212:215], v[24:27], v[68:71]
  ds_read_b64_tr_b16 v[22:23], v8 offset:50176
  s_add_u32 s62, s18, 6144
  buffer_load_dwordx4 v[152:155], v2, s[24:27], s62 offen offset:0 sc1
  s_waitcnt lgkmcnt(6)
  v_mfma_f32_16x16x32_bf16 v[72:75], v[208:211], v[28:31], v[72:75]
  ds_read_b64_tr_b16 v[24:25], v9 offset:49152
  v_mfma_f32_16x16x32_bf16 v[76:79], v[212:215], v[28:31], v[76:79]
  ds_read_b64_tr_b16 v[26:27], v9 offset:50176
  s_waitcnt lgkmcnt(6)
  v_mfma_f32_16x16x32_bf16 v[80:83], v[208:211], v[12:15], v[80:83]
  ds_read_b64_tr_b16 v[28:29], v10 offset:49152
  v_mfma_f32_16x16x32_bf16 v[84:87], v[212:215], v[12:15], v[84:87]
  ds_read_b64_tr_b16 v[30:31], v10 offset:50176
  s_add_u32 s62, s18, 6144
  buffer_load_dwordx4 v[156:159], v2, s[24:27], s62 offen offset:1024 sc1
  s_waitcnt lgkmcnt(6)
  v_mfma_f32_16x16x32_bf16 v[88:91], v[208:211], v[16:19], v[88:91]
  ds_read_b64_tr_b16 v[12:13], v11 offset:49152
  v_mfma_f32_16x16x32_bf16 v[92:95], v[212:215], v[16:19], v[92:95]
  ds_read_b64_tr_b16 v[14:15], v11 offset:50176
  s_waitcnt lgkmcnt(6)
  v_mfma_f32_16x16x32_bf16 v[96:99], v[208:211], v[20:23], v[96:99]
  ds_read_b64_tr_b16 v[16:17], v4 offset:57344
  v_mfma_f32_16x16x32_bf16 v[100:103], v[212:215], v[20:23], v[100:103]
  ds_read_b64_tr_b16 v[18:19], v4 offset:58368
  s_waitcnt lgkmcnt(6)
  v_mfma_f32_16x16x32_bf16 v[104:107], v[208:211], v[24:27], v[104:107]
  ds_read_b64_tr_b16 v[20:21], v5 offset:57344
  v_mfma_f32_16x16x32_bf16 v[108:111], v[212:215], v[24:27], v[108:111]
  ds_read_b64_tr_b16 v[22:23], v5 offset:58368
  s_waitcnt lgkmcnt(6)
  v_mfma_f32_16x16x32_bf16 v[112:115], v[208:211], v[28:31], v[112:115]
  ds_read_b64_tr_b16 v[24:25], v6 offset:57344
  v_mfma_f32_16x16x32_bf16 v[116:119], v[212:215], v[28:31], v[116:119]
  ds_read_b64_tr_b16 v[26:27], v6 offset:58368
  s_cmp_eq_u32 s12, 7
  s_cbranch_scc0 kvattn_kernel_st12
  buffer_store_dwordx4 v[44:47], v2, s[32:35], s43 offen offset:3072 sc1
kvattn_kernel_st12:
  s_waitcnt lgkmcnt(6)
  v_mfma_f32_16x16x32_bf16 v[120:123], v[208:211], v[12:15], v[120:123]
  ds_read_b64_tr_b16 v[28:29], v7 offset:57344
  v_mfma_f32_16x16x32_bf16 v[124:127], v[212:215], v[12:15], v[124:127]
  ds_read_b64_tr_b16 v[30:31], v7 offset:58368
  s_add_u32 s62, s18, 8192
  buffer_load_dwordx4 v[160:163], v2, s[24:27], s62 offen offset:0 sc1
  s_waitcnt lgkmcnt(6)
  v_mfma_f32_16x16x32_bf16 v[64:67], v[216:219], v[16:19], v[64:67]
  ds_read_b64_tr_b16 v[12:13], v8 offset:57344
  v_mfma_f32_16x16x32_bf16 v[68:71], v[220:223], v[16:19], v[68:71]
  ds_read_b64_tr_b16 v[14:15], v8 offset:58368
  s_waitcnt lgkmcnt(6)
  v_mfma_f32_16x16x32_bf16 v[72:75], v[216:219], v[20:23], v[72:75]
  ds_read_b64_tr_b16 v[16:17], v9 offset:57344
  v_mfma_f32_16x16x32_bf16 v[76:79], v[220:223], v[20:23], v[76:79]
  ds_read_b64_tr_b16 v[18:19], v9 offset:58368
  s_add_u32 s62, s18, 8192
  buffer_load_dwordx4 v[164:167], v2, s[24:27], s62 offen offset:1024 sc1
  s_waitcnt lgkmcnt(6)
  v_mfma_f32_16x16x32_bf16 v[80:83], v[216:219], v[24:27], v[80:83]
  ds_read_b64_tr_b16 v[20:21], v10 offset:57344
  v_mfma_f32_16x16x32_bf16 v[84:87], v[220:223], v[24:27], v[84:87]
  ds_read_b64_tr_b16 v[22:23], v10 offset:58368
  s_waitcnt lgkmcnt(6)
  v_mfma_f32_16x16x32_bf16 v[88:91], v[216:219], v[28:31], v[88:91]
  ds_read_b64_tr_b16 v[24:25], v11 offset:57344
  v_mfma_f32_16x16x32_bf16 v[92:95], v[220:223], v[28:31], v[92:95]
  ds_read_b64_tr_b16 v[26:27], v11 offset:58368
  s_waitcnt lgkmcnt(6)
  v_mfma_f32_16x16x32_bf16 v[96:99], v[216:219], v[12:15], v[96:99]
  s_waitcnt vmcnt(23)
  s_barrier
  v_xor_b32 v4, 0x30000, v4
  v_xor_b32 v5, 0x30000, v5
  v_xor_b32 v6, 0x30000, v6
  v_xor_b32 v7, 0x30000, v7
  v_xor_b32 v8, 0x30000, v8
  v_xor_b32 v9, 0x30000, v9
  v_xor_b32 v10, 0x30000, v10
  v_xor_b32 v11, 0x30000, v11
  ds_read_b64_tr_b16 v[28:29], v4 offset:0
  v_mfma_f32_16x16x32_bf16 v[100:103], v[220:223], v[12:15], v[100:103]
  ds_read_b64_tr_b16 v[30:31], v4 offset:1024
  s_waitcnt lgkmcnt(6)
  v_mfma_f32_16x16x32_bf16 v[104:107], v[216:219], v[16:19], v[104:107]
  ds_read_b64_tr_b16 v[12:13], v5 offset:0
  v_mfma_f32_16x16x32_bf16 v[108:111], v[220:223], v[16:19], v[108:111]
  ds_read_b64_tr_b16 v[14:15], v5 offset:1024
  s_cmp_eq_u32 s12, 7
  s_cbranch_scc0 kvattn_kernel_st13
  buffer_store_dwordx4 v[48:51], v2, s[32:35], s44 offen offset:0 sc1
kvattn_kernel_st13:
  s_add_u32 s62, s18, 10240
  buffer_load_dwordx4 v[168:171], v2, s[24:27], s62 offen offset:0 sc1
  s_waitcnt lgkmcnt(6)
  v_mfma_f32_16x16x32_bf16 v[112:115], v[216:219], v[20:23], v[112:115]
  ds_read_b64_tr_b16 v[16:17], v6 offset:0
  v_mfma_f32_16x16x32_bf16 v[116:119], v[220:223], v[20:23], v[116:119]
  ds_read_b64_tr_b16 v[18:19], v6 offset:1024
  s_waitcnt lgkmcnt(6)
  v_mfma_f32_16x16x32_bf16 v[120:123], v[216:219], v[24:27], v[120:123]
  ds_read_b64_tr_b16 v[20:21], v7 offset:0
  v_mfma_f32_16x16x32_bf16 v[124:127], v[220:223], v[24:27], v[124:127]
  ds_read_b64_tr_b16 v[22:23], v7 offset:1024
  s_add_u32 s62, s18, 10240
  buffer_load_dwordx4 v[172:175], v2, s[24:27], s62 offen offset:1024 sc1
  s_waitcnt lgkmcnt(6)
  v_mfma_f32_16x16x32_bf16 v[64:67], v[224:227], v[28:31], v[64:67]
  ds_read_b64_tr_b16 v[24:25], v8 offset:0
  v_mfma_f32_16x16x32_bf16 v[68:71], v[228:231], v[28:31], v[68:71]
  ds_read_b64_tr_b16 v[26:27], v8 offset:1024
  s_waitcnt lgkmcnt(6)
  v_mfma_f32_16x16x32_bf16 v[72:75], v[224:227], v[12:15], v[72:75]
  ds_read_b64_tr_b16 v[28:29], v9 offset:0
  v_mfma_f32_16x16x32_bf16 v[76:79], v[228:231], v[12:15], v[76:79]
  ds_read_b64_tr_b16 v[30:31], v9 offset:1024
  s_waitcnt lgkmcnt(6)
  v_mfma_f32_16x16x32_bf16 v[80:83], v[224:227], v[16:19], v[80:83]
  ds_read_b64_tr_b16 v[12:13], v10 offset:0
  v_mfma_f32_16x16x32_bf16 v[84:87], v[228:231], v[16:19], v[84:87]
  ds_read_b64_tr_b16 v[14:15], v10 offset:1024
  s_add_u32 m0, s46, 81920
  s_add_u32 s47, s45, 2621440
  buffer_load_dwordx4 v1, s[52:55], s47 offen offset:0 lds
  s_waitcnt lgkmcnt(6)
  v_mfma_f32_16x16x32_bf16 v[88:91], v[224:227], v[20:23], v[88:91]
  ds_read_b64_tr_b16 v[16:17], v11 offset:0
  v_mfma_f32_16x16x32_bf16 v[92:95], v[228:231], v[20:23], v[92:95]
  ds_read_b64_tr_b16 v[18:19], v11 offset:1024
  s_waitcnt lgkmcnt(6)
  v_mfma_f32_16x16x32_bf16 v[96:99], v[224:227], v[24:27], v[96:99]
  ds_read_b64_tr_b16 v[20:21], v4 offset:8192
  v_mfma_f32_16x16x32_bf16 v[100:103], v[228:231], v[24:27], v[100:103]
  ds_read_b64_tr_b16 v[22:23], v4 offset:9216
  s_add_u32 m0, s46, 81920
  s_add_u32 s47, s45, 2653184
  buffer_load_dwordx4 v1, s[52:55], s47 offen offset:1024 lds
  s_cmp_eq_u32 s12, 7
  s_cbranch_scc0 kvattn_kernel_st14
  buffer_store_dwordx4 v[52:55], v2, s[32:35], s44 offen offset:1024 sc1
kvattn_kernel_st14:
  s_add_u32 s62, s18, 12288
  buffer_load_dwordx4 v[176:179], v2, s[24:27], s62 offen offset:0 sc1
  s_waitcnt lgkmcnt(6)
  v_mfma_f32_16x16x32_bf16 v[104:107], v[224:227], v[28:31], v[104:107]
  ds_read_b64_tr_b16 v[24:25], v5 offset:8192
  v_mfma_f32_16x16x32_bf16 v[108:111], v[228:231], v[28:31], v[108:111]
  ds_read_b64_tr_b16 v[26:27], v5 offset:9216
  s_waitcnt lgkmcnt(6)
  v_mfma_f32_16x16x32_bf16 v[112:115], v[224:227], v[12:15], v[112:115]
  ds_read_b64_tr_b16 v[28:29], v6 offset:8192
  v_mfma_f32_16x16x32_bf16 v[116:119], v[228:231], v[12:15], v[116:119]
  ds_read_b64_tr_b16 v[30:31], v6 offset:9216
  s_add_u32 s62, s18, 12288
  buffer_load_dwordx4 v[180:183], v2, s[24:27], s62 offen offset:1024 sc1
  s_waitcnt lgkmcnt(6)
  v_mfma_f32_16x16x32_bf16 v[120:123], v[224:227], v[16:19], v[120:123]
  ds_read_b64_tr_b16 v[12:13], v7 offset:8192
  v_mfma_f32_16x16x32_bf16 v[124:127], v[228:231], v[16:19], v[124:127]
  ds_read_b64_tr_b16 v[14:15], v7 offset:9216
  s_waitcnt lgkmcnt(6)
  v_mfma_f32_16x16x32_bf16 v[64:67], v[232:235], v[20:23], v[64:67]
  ds_read_b64_tr_b16 v[16:17], v8 offset:8192
  v_mfma_f32_16x16x32_bf16 v[68:71], v[236:239], v[20:23], v[68:71]
  ds_read_b64_tr_b16 v[18:19], v8 offset:9216
  s_waitcnt lgkmcnt(6)
  v_mfma_f32_16x16x32_bf16 v[72:75], v[232:235], v[24:27], v[72:75]
  ds_read_b64_tr_b16 v[20:21], v9 offset:8192
  v_mfma_f32_16x16x32_bf16 v[76:79], v[236:239], v[24:27], v[76:79]
  ds_read_b64_tr_b16 v[22:23], v9 offset:9216
  s_waitcnt lgkmcnt(6)
  v_mfma_f32_16x16x32_bf16 v[80:83], v[232:235], v[28:31], v[80:83]
  ds_read_b64_tr_b16 v[24:25], v10 offset:8192
  v_mfma_f32_16x16x32_bf16 v[84:87], v[236:239], v[28:31], v[84:87]
  ds_read_b64_tr_b16 v[26:27], v10 offset:9216
  s_add_u32 m0, s46, 98304
  s_add_u32 s47, s45, 3145728
  buffer_load_dwordx4 v1, s[52:55], s47 offen offset:0 lds
  s_add_u32 s62, s18, 14336
  buffer_load_dwordx4 v[184:187], v2, s[24:27], s62 offen offset:0 sc1
  s_waitcnt lgkmcnt(6)
  v_mfma_f32_16x16x32_bf16 v[88:91], v[232:235], v[12:15], v[88:91]
  ds_read_b64_tr_b16 v[28:29], v11 offset:8192
  v_mfma_f32_16x16x32_bf16 v[92:95], v[236:239], v[12:15], v[92:95]
  ds_read_b64_tr_b16 v[30:31], v11 offset:9216
  s_cmp_eq_u32 s12, 7
  s_cbranch_scc0 kvattn_kernel_st15
  buffer_store_dwordx4 v[56:59], v2, s[32:35], s44 offen offset:2048 sc1
kvattn_kernel_st15:
  s_waitcnt lgkmcnt(6)
  v_mfma_f32_16x16x32_bf16 v[96:99], v[232:235], v[16:19], v[96:99]
  s_waitcnt vmcnt(29)
  s_barrier
  ds_read_b64_tr_b16 v[12:13], v4 offset:16384
  v_mfma_f32_16x16x32_bf16 v[100:103], v[236:239], v[16:19], v[100:103]
  ds_read_b64_tr_b16 v[14:15], v4 offset:17408
  s_add_u32 m0, s46, 98304
  s_add_u32 s47, s45, 3177472
  buffer_load_dwordx4 v1, s[52:55], s47 offen offset:1024 lds
  s_add_u32 s62, s18, 14336
  buffer_load_dwordx4 v[188:191], v2, s[24:27], s62 offen offset:1024 sc1
  s_waitcnt lgkmcnt(6)
  v_mfma_f32_16x16x32_bf16 v[104:107], v[232:235], v[20:23], v[104:107]
  ds_read_b64_tr_b16 v[16:17], v5 offset:16384
  v_mfma_f32_16x16x32_bf16 v[108:111], v[236:239], v[20:23], v[108:111]
  ds_read_b64_tr_b16 v[18:19], v5 offset:17408
  s_waitcnt lgkmcnt(6)
  v_mfma_f32_16x16x32_bf16 v[112:115], v[232:235], v[24:27], v[112:115]
  ds_read_b64_tr_b16 v[20:21], v6 offset:16384
  v_mfma_f32_16x16x32_bf16 v[116:119], v[236:239], v[24:27], v[116:119]
  ds_read_b64_tr_b16 v[22:23], v6 offset:17408
  s_waitcnt lgkmcnt(6)
  v_mfma_f32_16x16x32_bf16 v[120:123], v[232:235], v[28:31], v[120:123]
  ds_read_b64_tr_b16 v[24:25], v7 offset:16384
  v_mfma_f32_16x16x32_bf16 v[124:127], v[236:239], v[28:31], v[124:127]
  ds_read_b64_tr_b16 v[26:27], v7 offset:17408
  s_waitcnt lgkmcnt(6)
  v_mfma_f32_16x16x32_bf16 v[64:67], v[240:243], v[12:15], v[64:67]
  ds_read_b64_tr_b16 v[28:29], v8 offset:16384
  v_mfma_f32_16x16x32_bf16 v[68:71], v[244:247], v[12:15], v[68:71]
  ds_read_b64_tr_b16 v[30:31], v8 offset:17408
  s_waitcnt lgkmcnt(6)
  v_mfma_f32_16x16x32_bf16 v[72:75], v[240:243], v[16:19], v[72:75]
  ds_read_b64_tr_b16 v[12:13], v9 offset:16384
  v_mfma_f32_16x16x32_bf16 v[76:79], v[244:247], v[16:19], v[76:79]
  ds_read_b64_tr_b16 v[14:15], v9 offset:17408
  s_add_u32 s62, s18, 16384
  buffer_load_dwordx4 v[192:195], v2, s[24:27], s62 offen offset:0 sc1
  s_waitcnt lgkmcnt(6)
  v_mfma_f32_16x16x32_bf16 v[80:83], v[240:243], v[20:23], v[80:83]
  ds_read_b64_tr_b16 v[16:17], v10 offset:16384
  v_mfma_f32_16x16x32_bf16 v[84:87], v[244:247], v[20:23], v[84:87]
  ds_read_b64_tr_b16 v[18:19], v10 offset:17408
  s_add_u32 m0, s46, 114688
  s_add_u32 s47, s45, 3670016
  buffer_load_dwordx4 v1, s[52:55], s47 offen offset:0 lds
  s_cmp_eq_u32 s12, 7
  s_cbranch_scc0 kvattn_kernel_st16
  buffer_store_dwordx4 v[60:63], v2, s[32:35], s44 offen offset:3072 sc1
kvattn_kernel_st16:
  s_waitcnt lgkmcnt(6)
  v_mfma_f32_16x16x32_bf16 v[88:91], v[240:243], v[24:27], v[88:91]
  ds_read_b64_tr_b16 v[20:21], v11 offset:16384
  v_mfma_f32_16x16x32_bf16 v[92:95], v[244:247], v[24:27], v[92:95]
  ds_read_b64_tr_b16 v[22:23], v11 offset:17408
  s_add_u32 s62, s18, 16384
  buffer_load_dwordx4 v[196:199], v2, s[24:27], s62 offen offset:1024 sc1
  s_waitcnt lgkmcnt(6)
  v_mfma_f32_16x16x32_bf16 v[96:99], v[240:243], v[28:31], v[96:99]
  ds_read_b64_tr_b16 v[24:25], v4 offset:24576
  v_mfma_f32_16x16x32_bf16 v[100:103], v[244:247], v[28:31], v[100:103]
  ds_read_b64_tr_b16 v[26:27], v4 offset:25600
  s_add_u32 m0, s46, 114688
  s_add_u32 s47, s45, 3701760
  buffer_load_dwordx4 v1, s[52:55], s47 offen offset:1024 lds
  s_waitcnt lgkmcnt(6)
  v_mfma_f32_16x16x32_bf16 v[104:107], v[240:243], v[12:15], v[104:107]
  ds_read_b64_tr_b16 v[28:29], v5 offset:24576
  v_mfma_f32_16x16x32_bf16 v[108:111], v[244:247], v[12:15], v[108:111]
  ds_read_b64_tr_b16 v[30:31], v5 offset:25600
  s_waitcnt lgkmcnt(6)
  v_mfma_f32_16x16x32_bf16 v[112:115], v[240:243], v[16:19], v[112:115]
  ds_read_b64_tr_b16 v[12:13], v6 offset:24576
  v_mfma_f32_16x16x32_bf16 v[116:119], v[244:247], v[16:19], v[116:119]
  ds_read_b64_tr_b16 v[14:15], v6 offset:25600
  s_waitcnt lgkmcnt(6)
  v_mfma_f32_16x16x32_bf16 v[120:123], v[240:243], v[20:23], v[120:123]
  ds_read_b64_tr_b16 v[16:17], v7 offset:24576
  v_mfma_f32_16x16x32_bf16 v[124:127], v[244:247], v[20:23], v[124:127]
  ds_read_b64_tr_b16 v[18:19], v7 offset:25600
  s_add_u32 s62, s18, 18432
  buffer_load_dwordx4 v[200:203], v2, s[24:27], s62 offen offset:0 sc1
  s_waitcnt lgkmcnt(6)
  v_mfma_f32_16x16x32_bf16 v[64:67], v[248:251], v[24:27], v[64:67]
  ds_read_b64_tr_b16 v[20:21], v8 offset:24576
  v_mfma_f32_16x16x32_bf16 v[68:71], v[252:255], v[24:27], v[68:71]
  ds_read_b64_tr_b16 v[22:23], v8 offset:25600
  s_waitcnt lgkmcnt(6)
  v_mfma_f32_16x16x32_bf16 v[72:75], v[248:251], v[28:31], v[72:75]
  ds_read_b64_tr_b16 v[24:25], v9 offset:24576
  v_mfma_f32_16x16x32_bf16 v[76:79], v[252:255], v[28:31], v[76:79]
  ds_read_b64_tr_b16 v[26:27], v9 offset:25600
  s_add_u32 s62, s18, 18432
  buffer_load_dwordx4 v[204:207], v2, s[24:27], s62 offen offset:1024 sc1
  s_waitcnt lgkmcnt(6)
  v_mfma_f32_16x16x32_bf16 v[80:83], v[248:251], v[12:15], v[80:83]
  ds_read_b64_tr_b16 v[28:29], v10 offset:24576
  v_mfma_f32_16x16x32_bf16 v[84:87], v[252:255], v[12:15], v[84:87]
  ds_read_b64_tr_b16 v[30:31], v10 offset:25600
  s_waitcnt lgkmcnt(6)
  v_mfma_f32_16x16x32_bf16 v[88:91], v[248:251], v[16:19], v[88:91]
  ds_read_b64_tr_b16 v[12:13], v11 offset:24576
  v_mfma_f32_16x16x32_bf16 v[92:95], v[252:255], v[16:19], v[92:95]
  ds_read_b64_tr_b16 v[14:15], v11 offset:25600
  s_waitcnt lgkmcnt(6)
  v_mfma_f32_16x16x32_bf16 v[96:99], v[248:251], v[20:23], v[96:99]
  s_waitcnt vmcnt(35)
  s_barrier
  v_xor_b32 v4, 0x20000, v4
  v_xor_b32 v5, 0x20000, v5
  v_xor_b32 v6, 0x20000, v6
  v_xor_b32 v7, 0x20000, v7
  v_xor_b32 v8, 0x20000, v8
  v_xor_b32 v9, 0x20000, v9
  v_xor_b32 v10, 0x20000, v10
  v_xor_b32 v11, 0x20000, v11
  ds_read_b64_tr_b16 v[16:17], v4 offset:16384
  v_mfma_f32_16x16x32_bf16 v[100:103], v[252:255], v[20:23], v[100:103]
  ds_read_b64_tr_b16 v[18:19], v4 offset:17408
  s_waitcnt lgkmcnt(6)
  v_mfma_f32_16x16x32_bf16 v[104:107], v[248:251], v[24:27], v[104:107]
  ds_read_b64_tr_b16 v[20:21], v5 offset:16384
  v_mfma_f32_16x16x32_bf16 v[108:111], v[252:255], v[24:27], v[108:111]
  ds_read_b64_tr_b16 v[22:23], v5 offset:17408
  s_waitcnt lgkmcnt(6)
  v_mfma_f32_16x16x32_bf16 v[112:115], v[248:251], v[28:31], v[112:115]
  ds_read_b64_tr_b16 v[24:25], v6 offset:16384
  v_mfma_f32_16x16x32_bf16 v[116:119], v[252:255], v[28:31], v[116:119]
  ds_read_b64_tr_b16 v[26:27], v6 offset:17408
  s_waitcnt lgkmcnt(6)
  v_mfma_f32_16x16x32_bf16 v[120:123], v[248:251], v[12:15], v[120:123]
  ds_read_b64_tr_b16 v[28:29], v7 offset:16384
  v_mfma_f32_16x16x32_bf16 v[124:127], v[252:255], v[12:15], v[124:127]
  ds_read_b64_tr_b16 v[30:31], v7 offset:17408
  s_waitcnt vmcnt(25)
  v_cvt_pk_bf16_f32 v32, v64, v65
  v_cvt_pk_bf16_f32 v33, v66, v67
  v_cvt_pk_bf16_f32 v34, v68, v69
  v_cvt_pk_bf16_f32 v35, v70, v71
  s_waitcnt lgkmcnt(6)
  v_mfma_f32_16x16x32_bf16 v[64:67], v[16:19], v[128:131], 0
  ds_read_b64_tr_b16 v[12:13], v8 offset:16384
  v_mfma_f32_16x16x32_bf16 v[68:71], v[16:19], v[132:135], 0
  ds_read_b64_tr_b16 v[14:15], v8 offset:17408
  v_cvt_pk_bf16_f32 v36, v72, v73
  v_cvt_pk_bf16_f32 v37, v74, v75
  v_cvt_pk_bf16_f32 v38, v76, v77
  v_cvt_pk_bf16_f32 v39, v78, v79
  s_waitcnt lgkmcnt(6)
  v_mfma_f32_16x16x32_bf16 v[72:75], v[20:23], v[128:131], 0
  ds_read_b64_tr_b16 v[16:17], v9 offset:16384
  v_mfma_f32_16x16x32_bf16 v[76:79], v[20:23], v[132:135], 0
  ds_read_b64_tr_b16 v[18:19], v9 offset:17408
  buffer_store_dwordx4 v[32:35], v2, s[36:39], s43 offen offset:0 sc1
  v_cvt_pk_bf16_f32 v40, v80, v81
  v_cvt_pk_bf16_f32 v41, v82, v83
  v_cvt_pk_bf16_f32 v42, v84, v85
  v_cvt_pk_bf16_f32 v43, v86, v87
  s_waitcnt lgkmcnt(6)
  v_mfma_f32_16x16x32_bf16 v[80:83], v[24:27], v[128:131], 0
  ds_read_b64_tr_b16 v[20:21], v10 offset:16384
  v_mfma_f32_16x16x32_bf16 v[84:87], v[24:27], v[132:135], 0
  ds_read_b64_tr_b16 v[22:23], v10 offset:17408
  v_cvt_pk_bf16_f32 v44, v88, v89
  v_cvt_pk_bf16_f32 v45, v90, v91
  v_cvt_pk_bf16_f32 v46, v92, v93
  v_cvt_pk_bf16_f32 v47, v94, v95
  s_waitcnt lgkmcnt(6)
  v_mfma_f32_16x16x32_bf16 v[88:91], v[28:31], v[128:131], 0
  ds_read_b64_tr_b16 v[24:25], v11 offset:16384
  v_mfma_f32_16x16x32_bf16 v[92:95], v[28:31], v[132:135], 0
  ds_read_b64_tr_b16 v[26:27], v11 offset:17408
  v_cvt_pk_bf16_f32 v48, v96, v97
  v_cvt_pk_bf16_f32 v49, v98, v99
  v_cvt_pk_bf16_f32 v50, v100, v101
  v_cvt_pk_bf16_f32 v51, v102, v103
  s_waitcnt lgkmcnt(6)
  v_mfma_f32_16x16x32_bf16 v[96:99], v[12:15], v[128:131], 0
  ds_read_b64_tr_b16 v[28:29], v4 offset:24576
  v_mfma_f32_16x16x32_bf16 v[100:103], v[12:15], v[132:135], 0
  ds_read_b64_tr_b16 v[30:31], v4 offset:25600
  buffer_store_dwordx4 v[36:39], v2, s[36:39], s43 offen offset:1024 sc1
  v_cvt_pk_bf16_f32 v52, v104, v105
  v_cvt_pk_bf16_f32 v53, v106, v107
  v_cvt_pk_bf16_f32 v54, v108, v109
  v_cvt_pk_bf16_f32 v55, v110, v111
  s_waitcnt lgkmcnt(6)
  v_mfma_f32_16x16x32_bf16 v[104:107], v[16:19], v[128:131], 0
  ds_read_b64_tr_b16 v[12:13], v5 offset:24576
  v_mfma_f32_16x16x32_bf16 v[108:111], v[16:19], v[132:135], 0
  ds_read_b64_tr_b16 v[14:15], v5 offset:25600
  v_cvt_pk_bf16_f32 v56, v112, v113
  v_cvt_pk_bf16_f32 v57, v114, v115
  v_cvt_pk_bf16_f32 v58, v116, v117
  v_cvt_pk_bf16_f32 v59, v118, v119
  s_waitcnt lgkmcnt(6)
  v_mfma_f32_16x16x32_bf16 v[112:115], v[20:23], v[128:131], 0
  ds_read_b64_tr_b16 v[16:17], v6 offset:24576
  v_mfma_f32_16x16x32_bf16 v[116:119], v[20:23], v[132:135], 0
  ds_read_b64_tr_b16 v[18:19], v6 offset:25600
  v_cvt_pk_bf16_f32 v60, v120, v121
  v_cvt_pk_bf16_f32 v61, v122, v123
  v_cvt_pk_bf16_f32 v62, v124, v125
  v_cvt_pk_bf16_f32 v63, v126, v127
  s_waitcnt lgkmcnt(6)
  v_mfma_f32_16x16x32_bf16 v[120:123], v[24:27], v[128:131], 0
  ds_read_b64_tr_b16 v[20:21], v7 offset:24576
  v_mfma_f32_16x16x32_bf16 v[124:127], v[24:27], v[132:135], 0
  ds_read_b64_tr_b16 v[22:23], v7 offset:25600
  buffer_store_dwordx4 v[40:43], v2, s[36:39], s43 offen offset:2048 sc1
  s_waitcnt vmcnt(25)
  s_waitcnt lgkmcnt(6)
  v_mfma_f32_16x16x32_bf16 v[64:67], v[28:31], v[136:139], v[64:67]
  ds_read_b64_tr_b16 v[24:25], v8 offset:24576
  v_mfma_f32_16x16x32_bf16 v[68:71], v[28:31], v[140:143], v[68:71]
  ds_read_b64_tr_b16 v[26:27], v8 offset:25600
  s_waitcnt lgkmcnt(6)
  v_mfma_f32_16x16x32_bf16 v[72:75], v[12:15], v[136:139], v[72:75]
  ds_read_b64_tr_b16 v[28:29], v9 offset:24576
  v_mfma_f32_16x16x32_bf16 v[76:79], v[12:15], v[140:143], v[76:79]
  ds_read_b64_tr_b16 v[30:31], v9 offset:25600
  s_waitcnt lgkmcnt(6)
  v_mfma_f32_16x16x32_bf16 v[80:83], v[16:19], v[136:139], v[80:83]
  ds_read_b64_tr_b16 v[12:13], v10 offset:24576
  v_mfma_f32_16x16x32_bf16 v[84:87], v[16:19], v[140:143], v[84:87]
  ds_read_b64_tr_b16 v[14:15], v10 offset:25600
  buffer_store_dwordx4 v[44:47], v2, s[36:39], s43 offen offset:3072 sc1
  s_waitcnt lgkmcnt(6)
  v_mfma_f32_16x16x32_bf16 v[88:91], v[20:23], v[136:139], v[88:91]
  ds_read_b64_tr_b16 v[16:17], v11 offset:24576
  v_mfma_f32_16x16x32_bf16 v[92:95], v[20:23], v[140:143], v[92:95]
  ds_read_b64_tr_b16 v[18:19], v11 offset:25600
  s_waitcnt lgkmcnt(6)
  v_mfma_f32_16x16x32_bf16 v[96:99], v[24:27], v[136:139], v[96:99]
  s_waitcnt vmcnt(8)
  s_barrier
  v_mov_b32 v3, s85
  s_mov_b64 exec, 1
  buffer_store_dword v3, off, s[96:99], s100 offset:0 sc1
  s_mov_b64 exec, -1
  ds_read_b64_tr_b16 v[20:21], v4 offset:32768
  v_mfma_f32_16x16x32_bf16 v[100:103], v[24:27], v[140:143], v[100:103]
  ds_read_b64_tr_b16 v[22:23], v4 offset:33792
  s_waitcnt lgkmcnt(6)
  v_mfma_f32_16x16x32_bf16 v[104:107], v[28:31], v[136:139], v[104:107]
  ds_read_b64_tr_b16 v[24:25], v5 offset:32768
  v_mfma_f32_16x16x32_bf16 v[108:111], v[28:31], v[140:143], v[108:111]
  ds_read_b64_tr_b16 v[26:27], v5 offset:33792
  buffer_store_dwordx4 v[48:51], v2, s[36:39], s44 offen offset:0 sc1
  s_waitcnt lgkmcnt(6)
  v_mfma_f32_16x16x32_bf16 v[112:115], v[12:15], v[136:139], v[112:115]
  ds_read_b64_tr_b16 v[28:29], v6 offset:32768
  v_mfma_f32_16x16x32_bf16 v[116:119], v[12:15], v[140:143], v[116:119]
  ds_read_b64_tr_b16 v[30:31], v6 offset:33792
  s_waitcnt lgkmcnt(6)
  v_mfma_f32_16x16x32_bf16 v[120:123], v[16:19], v[136:139], v[120:123]
  ds_read_b64_tr_b16 v[12:13], v7 offset:32768
  v_mfma_f32_16x16x32_bf16 v[124:127], v[16:19], v[140:143], v[124:127]
  ds_read_b64_tr_b16 v[14:15], v7 offset:33792
  s_waitcnt vmcnt(26)
  s_waitcnt lgkmcnt(6)
  v_mfma_f32_16x16x32_bf16 v[64:67], v[20:23], v[144:147], v[64:67]
  ds_read_b64_tr_b16 v[16:17], v8 offset:32768
  v_mfma_f32_16x16x32_bf16 v[68:71], v[20:23], v[148:151], v[68:71]
  ds_read_b64_tr_b16 v[18:19], v8 offset:33792
  buffer_store_dwordx4 v[52:55], v2, s[36:39], s44 offen offset:1024 sc1
  s_waitcnt lgkmcnt(6)
  v_mfma_f32_16x16x32_bf16 v[72:75], v[24:27], v[144:147], v[72:75]
  ds_read_b64_tr_b16 v[20:21], v9 offset:32768
  v_mfma_f32_16x16x32_bf16 v[76:79], v[24:27], v[148:151], v[76:79]
  ds_read_b64_tr_b16 v[22:23], v9 offset:33792
  s_waitcnt lgkmcnt(6)
  v_mfma_f32_16x16x32_bf16 v[80:83], v[28:31], v[144:147], v[80:83]
  ds_read_b64_tr_b16 v[24:25], v10 offset:32768
  v_mfma_f32_16x16x32_bf16 v[84:87], v[28:31], v[148:151], v[84:87]
  ds_read_b64_tr_b16 v[26:27], v10 offset:33792
  s_waitcnt lgkmcnt(6)
  v_mfma_f32_16x16x32_bf16 v[88:91], v[12:15], v[144:147], v[88:91]
  ds_read_b64_tr_b16 v[28:29], v11 offset:32768
  v_mfma_f32_16x16x32_bf16 v[92:95], v[12:15], v[148:151], v[92:95]
  ds_read_b64_tr_b16 v[30:31], v11 offset:33792
  buffer_store_dwordx4 v[56:59], v2, s[36:39], s44 offen offset:2048 sc1
  s_waitcnt lgkmcnt(6)
  v_mfma_f32_16x16x32_bf16 v[96:99], v[16:19], v[144:147], v[96:99]
  ds_read_b64_tr_b16 v[12:13], v4 offset:40960
  v_mfma_f32_16x16x32_bf16 v[100:103], v[16:19], v[148:151], v[100:103]
  ds_read_b64_tr_b16 v[14:15], v4 offset:41984
  s_waitcnt lgkmcnt(6)
  v_mfma_f32_16x16x32_bf16 v[104:107], v[20:23], v[144:147], v[104:107]
  ds_read_b64_tr_b16 v[16:17], v5 offset:40960
  v_mfma_f32_16x16x32_bf16 v[108:111], v[20:23], v[148:151], v[108:111]
  ds_read_b64_tr_b16 v[18:19], v5 offset:41984
  s_waitcnt lgkmcnt(6)
  v_mfma_f32_16x16x32_bf16 v[112:115], v[24:27], v[144:147], v[112:115]
  ds_read_b64_tr_b16 v[20:21], v6 offset:40960
  v_mfma_f32_16x16x32_bf16 v[116:119], v[24:27], v[148:151], v[116:119]
  ds_read_b64_tr_b16 v[22:23], v6 offset:41984
  buffer_store_dwordx4 v[60:63], v2, s[36:39], s44 offen offset:3072 sc1
  s_waitcnt lgkmcnt(6)
  v_mfma_f32_16x16x32_bf16 v[120:123], v[28:31], v[144:147], v[120:123]
  ds_read_b64_tr_b16 v[24:25], v7 offset:40960
  v_mfma_f32_16x16x32_bf16 v[124:127], v[28:31], v[148:151], v[124:127]
  ds_read_b64_tr_b16 v[26:27], v7 offset:41984
  s_waitcnt vmcnt(27)
  s_waitcnt lgkmcnt(6)
  v_mfma_f32_16x16x32_bf16 v[64:67], v[12:15], v[152:155], v[64:67]
  ds_read_b64_tr_b16 v[28:29], v8 offset:40960
  v_mfma_f32_16x16x32_bf16 v[68:71], v[12:15], v[156:159], v[68:71]
  ds_read_b64_tr_b16 v[30:31], v8 offset:41984
  s_waitcnt lgkmcnt(6)
  v_mfma_f32_16x16x32_bf16 v[72:75], v[16:19], v[152:155], v[72:75]
  ds_read_b64_tr_b16 v[12:13], v9 offset:40960
  v_mfma_f32_16x16x32_bf16 v[76:79], v[16:19], v[156:159], v[76:79]
  ds_read_b64_tr_b16 v[14:15], v9 offset:41984
  s_waitcnt lgkmcnt(6)
  v_mfma_f32_16x16x32_bf16 v[80:83], v[20:23], v[152:155], v[80:83]
  ds_read_b64_tr_b16 v[16:17], v10 offset:40960
  v_mfma_f32_16x16x32_bf16 v[84:87], v[20:23], v[156:159], v[84:87]
  ds_read_b64_tr_b16 v[18:19], v10 offset:41984
  s_sub_u32 s45, s40, 2
  s_waitcnt lgkmcnt(6)
  v_mfma_f32_16x16x32_bf16 v[88:91], v[24:27], v[152:155], v[88:91]
  ds_read_b64_tr_b16 v[20:21], v11 offset:40960
  v_mfma_f32_16x16x32_bf16 v[92:95], v[24:27], v[156:159], v[92:95]
  ds_read_b64_tr_b16 v[22:23], v11 offset:41984
  s_lshl_b32 s51, s40, 18
  s_waitcnt lgkmcnt(6)
  v_mfma_f32_16x16x32_bf16 v[96:99], v[28:31], v[152:155], v[96:99]
  s_barrier
  ds_read_b64_tr_b16 v[24:25], v4 offset:49152
  v_mfma_f32_16x16x32_bf16 v[100:103], v[28:31], v[156:159], v[100:103]
  ds_read_b64_tr_b16 v[26:27], v4 offset:50176
  s_lshl_b32 s49, s13, 13
  s_waitcnt lgkmcnt(6)
  v_mfma_f32_16x16x32_bf16 v[104:107], v[12:15], v[152:155], v[104:107]
  ds_read_b64_tr_b16 v[28:29], v5 offset:49152
  v_mfma_f32_16x16x32_bf16 v[108:111], v[12:15], v[156:159], v[108:111]
  ds_read_b64_tr_b16 v[30:31], v5 offset:50176
  s_add_u32 s51, s51, s49
  s_waitcnt lgkmcnt(6)
  v_mfma_f32_16x16x32_bf16 v[112:115], v[16:19], v[152:155], v[112:115]
  ds_read_b64_tr_b16 v[12:13], v6 offset:49152
  v_mfma_f32_16x16x32_bf16 v[116:119], v[16:19], v[156:159], v[116:119]
  ds_read_b64_tr_b16 v[14:15], v6 offset:50176
  s_lshr_b32 s52, s12, 2
  s_waitcnt lgkmcnt(6)
  v_mfma_f32_16x16x32_bf16 v[120:123], v[20:23], v[152:155], v[120:123]
  ds_read_b64_tr_b16 v[16:17], v7 offset:49152
  v_mfma_f32_16x16x32_bf16 v[124:127], v[20:23], v[156:159], v[124:127]
  ds_read_b64_tr_b16 v[18:19], v7 offset:50176
  s_sub_u32 s42, 16, s14
  s_waitcnt vmcnt(25)
  s_waitcnt lgkmcnt(6)
  v_mfma_f32_16x16x32_bf16 v[64:67], v[24:27], v[160:163], v[64:67]
  ds_read_b64_tr_b16 v[20:21], v8 offset:49152
  v_mfma_f32_16x16x32_bf16 v[68:71], v[24:27], v[164:167], v[68:71]
  ds_read_b64_tr_b16 v[22:23], v8 offset:50176
  s_lshl_b32 s42, s42, 15
  s_waitcnt lgkmcnt(6)
  v_mfma_f32_16x16x32_bf16 v[72:75], v[28:31], v[160:163], v[72:75]
  ds_read_b64_tr_b16 v[24:25], v9 offset:49152
  v_mfma_f32_16x16x32_bf16 v[76:79], v[28:31], v[164:167], v[76:79]
  ds_read_b64_tr_b16 v[26:27], v9 offset:50176
  s_add_u32 s42, s42, s15
  s_waitcnt lgkmcnt(6)
  v_mfma_f32_16x16x32_bf16 v[80:83], v[12:15], v[160:163], v[80:83]
  ds_read_b64_tr_b16 v[28:29], v10 offset:49152
  v_mfma_f32_16x16x32_bf16 v[84:87], v[12:15], v[164:167], v[84:87]
  ds_read_b64_tr_b16 v[30:31], v10 offset:50176
  s_lshl_b32 s44, s16, 12
  s_waitcnt lgkmcnt(6)
  v_mfma_f32_16x16x32_bf16 v[88:91], v[16:19], v[160:163], v[88:91]
  ds_read_b64_tr_b16 v[12:13], v11 offset:49152
  v_mfma_f32_16x16x32_bf16 v[92:95], v[16:19], v[164:167], v[92:95]
  ds_read_b64_tr_b16 v[14:15], v11 offset:50176
  s_add_u32 s43, s44, 98304
  s_waitcnt lgkmcnt(6)
  v_mfma_f32_16x16x32_bf16 v[96:99], v[20:23], v[160:163], v[96:99]
  ds_read_b64_tr_b16 v[16:17], v4 offset:57344
  v_mfma_f32_16x16x32_bf16 v[100:103], v[20:23], v[164:167], v[100:103]
  ds_read_b64_tr_b16 v[18:19], v4 offset:58368
  s_add_u32 s40, s15, 49152
  s_waitcnt lgkmcnt(6)
  v_mfma_f32_16x16x32_bf16 v[104:107], v[24:27], v[160:163], v[104:107]
  ds_read_b64_tr_b16 v[20:21], v5 offset:57344
  v_mfma_f32_16x16x32_bf16 v[108:111], v[24:27], v[164:167], v[108:111]
  ds_read_b64_tr_b16 v[22:23], v5 offset:58368
  s_add_u32 s41, s15, 32768
  s_waitcnt lgkmcnt(6)
  v_mfma_f32_16x16x32_bf16 v[112:115], v[28:31], v[160:163], v[112:115]
  ds_read_b64_tr_b16 v[24:25], v6 offset:57344
  v_mfma_f32_16x16x32_bf16 v[116:119], v[28:31], v[164:167], v[116:119]
  ds_read_b64_tr_b16 v[26:27], v6 offset:58368
  s_add_u32 s28, s10, 0x3000000
  s_addc_u32 s29, s11, 0
  s_waitcnt lgkmcnt(6)
  v_mfma_f32_16x16x32_bf16 v[120:123], v[12:15], v[160:163], v[120:123]
  ds_read_b64_tr_b16 v[28:29], v7 offset:57344
  v_mfma_f32_16x16x32_bf16 v[124:127], v[12:15], v[164:167], v[124:127]
  ds_read_b64_tr_b16 v[30:31], v7 offset:58368
  s_mov_b32 s30, 0x1000000
  s_waitcnt vmcnt(23)
  s_waitcnt lgkmcnt(6)
  v_mfma_f32_16x16x32_bf16 v[64:67], v[16:19], v[168:171], v[64:67]
  ds_read_b64_tr_b16 v[12:13], v8 offset:57344
  v_mfma_f32_16x16x32_bf16 v[68:71], v[16:19], v[172:175], v[68:71]
  ds_read_b64_tr_b16 v[14:15], v8 offset:58368
  s_add_u32 s62, s18, 20480
  buffer_load_dwordx4 v[208:211], v2, s[24:27], s62 offen offset:0 sc1
  s_mov_b32 s31, 0x20000
  s_waitcnt lgkmcnt(6)
  v_mfma_f32_16x16x32_bf16 v[72:75], v[20:23], v[168:171], v[72:75]
  ds_read_b64_tr_b16 v[16:17], v9 offset:57344
  v_mfma_f32_16x16x32_bf16 v[76:79], v[20:23], v[172:175], v[76:79]
  ds_read_b64_tr_b16 v[18:19], v9 offset:58368
  s_waitcnt lgkmcnt(6)
  v_mfma_f32_16x16x32_bf16 v[80:83], v[24:27], v[168:171], v[80:83]
  ds_read_b64_tr_b16 v[20:21], v10 offset:57344
  v_mfma_f32_16x16x32_bf16 v[84:87], v[24:27], v[172:175], v[84:87]
  ds_read_b64_tr_b16 v[22:23], v10 offset:58368
  s_add_u32 s62, s18, 20480
  buffer_load_dwordx4 v[212:215], v2, s[24:27], s62 offen offset:1024 sc1
  s_waitcnt lgkmcnt(6)
  v_mfma_f32_16x16x32_bf16 v[88:91], v[28:31], v[168:171], v[88:91]
  ds_read_b64_tr_b16 v[24:25], v11 offset:57344
  v_mfma_f32_16x16x32_bf16 v[92:95], v[28:31], v[172:175], v[92:95]
  ds_read_b64_tr_b16 v[26:27], v11 offset:58368
  s_waitcnt lgkmcnt(6)
  v_mfma_f32_16x16x32_bf16 v[96:99], v[12:15], v[168:171], v[96:99]
  s_barrier
  v_xor_b32 v4, 0x10000, v4
  v_xor_b32 v5, 0x10000, v5
  v_xor_b32 v6, 0x10000, v6
  v_xor_b32 v7, 0x10000, v7
  v_xor_b32 v8, 0x10000, v8
  v_xor_b32 v9, 0x10000, v9
  v_xor_b32 v10, 0x10000, v10
  v_xor_b32 v11, 0x10000, v11
  ds_read_b64_tr_b16 v[28:29], v4 offset:0
  v_mfma_f32_16x16x32_bf16 v[100:103], v[12:15], v[172:175], v[100:103]
  ds_read_b64_tr_b16 v[30:31], v4 offset:1024
  s_lshl_b32 s60, s2, 13
  s_waitcnt lgkmcnt(6)
  v_mfma_f32_16x16x32_bf16 v[104:107], v[16:19], v[168:171], v[104:107]
  ds_read_b64_tr_b16 v[12:13], v5 offset:0
  v_mfma_f32_16x16x32_bf16 v[108:111], v[16:19], v[172:175], v[108:111]
  ds_read_b64_tr_b16 v[14:15], v5 offset:1024
  s_add_u32 s61, s60, 0x200000
  s_waitcnt lgkmcnt(6)
  v_mfma_f32_16x16x32_bf16 v[112:115], v[20:23], v[168:171], v[112:115]
  ds_read_b64_tr_b16 v[16:17], v6 offset:0
  v_mfma_f32_16x16x32_bf16 v[116:119], v[20:23], v[172:175], v[116:119]
  ds_read_b64_tr_b16 v[18:19], v6 offset:1024
  s_lshr_b32 s49, s13, 2
  s_waitcnt lgkmcnt(6)
  v_mfma_f32_16x16x32_bf16 v[120:123], v[24:27], v[168:171], v[120:123]
  ds_read_b64_tr_b16 v[20:21], v7 offset:0
  v_mfma_f32_16x16x32_bf16 v[124:127], v[24:27], v[172:175], v[124:127]
  ds_read_b64_tr_b16 v[22:23], v7 offset:1024
  s_lshl_b32 s49, s49, 19
  s_waitcnt vmcnt(21)
  s_waitcnt lgkmcnt(6)
  v_mfma_f32_16x16x32_bf16 v[64:67], v[28:31], v[176:179], v[64:67]
  ds_read_b64_tr_b16 v[24:25], v8 offset:0
  v_mfma_f32_16x16x32_bf16 v[68:71], v[28:31], v[180:183], v[68:71]
  ds_read_b64_tr_b16 v[26:27], v8 offset:1024
  s_add_u32 s62, s18, 22528
  buffer_load_dwordx4 v[216:219], v2, s[24:27], s62 offen offset:0 sc1
  s_lshr_b32 s50, s2, 3
  s_waitcnt lgkmcnt(6)
  v_mfma_f32_16x16x32_bf16 v[72:75], v[12:15], v[176:179], v[72:75]
  ds_read_b64_tr_b16 v[28:29], v9 offset:0
  v_mfma_f32_16x16x32_bf16 v[76:79], v[12:15], v[180:183], v[76:79]
  ds_read_b64_tr_b16 v[30:31], v9 offset:1024
  s_lshl_b32 s50, s50, 14
  s_waitcnt lgkmcnt(6)
  v_mfma_f32_16x16x32_bf16 v[80:83], v[16:19], v[176:179], v[80:83]
  ds_read_b64_tr_b16 v[12:13], v10 offset:0
  v_mfma_f32_16x16x32_bf16 v[84:87], v[16:19], v[180:183], v[84:87]
  ds_read_b64_tr_b16 v[14:15], v10 offset:1024
  s_add_u32 s62, s18, 22528
  buffer_load_dwordx4 v[220:223], v2, s[24:27], s62 offen offset:1024 sc1
  s_add_u32 s49, s49, s50
  s_waitcnt lgkmcnt(6)
  v_mfma_f32_16x16x32_bf16 v[88:91], v[20:23], v[176:179], v[88:91]
  ds_read_b64_tr_b16 v[16:17], v11 offset:0
  v_mfma_f32_16x16x32_bf16 v[92:95], v[20:23], v[180:183], v[92:95]
  ds_read_b64_tr_b16 v[18:19], v11 offset:1024
  s_add_u32 s50, s49, 8192
  s_waitcnt lgkmcnt(6)
  v_mfma_f32_16x16x32_bf16 v[96:99], v[24:27], v[176:179], v[96:99]
  ds_read_b64_tr_b16 v[20:21], v4 offset:8192
  v_mfma_f32_16x16x32_bf16 v[100:103], v[24:27], v[180:183], v[100:103]
  ds_read_b64_tr_b16 v[22:23], v4 offset:9216
  s_mov_b32 s58, 0x1c0000
  s_waitcnt lgkmcnt(6)
  v_mfma_f32_16x16x32_bf16 v[104:107], v[28:31], v[176:179], v[104:107]
  ds_read_b64_tr_b16 v[24:25], v5 offset:8192
  v_mfma_f32_16x16x32_bf16 v[108:111], v[28:31], v[180:183], v[108:111]
  ds_read_b64_tr_b16 v[26:27], v5 offset:9216
  s_mov_b32 s59, 0x20000
  s_waitcnt lgkmcnt(6)
  v_mfma_f32_16x16x32_bf16 v[112:115], v[12:15], v[176:179], v[112:115]
  ds_read_b64_tr_b16 v[28:29], v6 offset:8192
  v_mfma_f32_16x16x32_bf16 v[116:119], v[12:15], v[180:183], v[116:119]
  ds_read_b64_tr_b16 v[30:31], v6 offset:9216
  s_cmp_eq_u32 s16, 0
  s_cselect_b32 s60, s49, s60
  s_cselect_b32 s61, s50, s61
  s_cselect_b32 s58, 0x400000, s58
  s_waitcnt lgkmcnt(6)
  v_mfma_f32_16x16x32_bf16 v[120:123], v[16:19], v[176:179], v[120:123]
  ds_read_b64_tr_b16 v[12:13], v7 offset:8192
  v_mfma_f32_16x16x32_bf16 v[124:127], v[16:19], v[180:183], v[124:127]
  ds_read_b64_tr_b16 v[14:15], v7 offset:9216
  s_waitcnt vmcnt(19)
  s_waitcnt lgkmcnt(6)
  v_mfma_f32_16x16x32_bf16 v[64:67], v[20:23], v[184:187], v[64:67]
  ds_read_b64_tr_b16 v[16:17], v8 offset:8192
  v_mfma_f32_16x16x32_bf16 v[68:71], v[20:23], v[188:191], v[68:71]
  ds_read_b64_tr_b16 v[18:19], v8 offset:9216
  s_add_u32 s62, s18, 24576
  buffer_load_dwordx4 v[224:227], v2, s[24:27], s62 offen offset:0 sc1
  s_waitcnt lgkmcnt(6)
  v_mfma_f32_16x16x32_bf16 v[72:75], v[24:27], v[184:187], v[72:75]
  ds_read_b64_tr_b16 v[20:21], v9 offset:8192
  v_mfma_f32_16x16x32_bf16 v[76:79], v[24:27], v[188:191], v[76:79]
  ds_read_b64_tr_b16 v[22:23], v9 offset:9216
  s_waitcnt lgkmcnt(6)
  v_mfma_f32_16x16x32_bf16 v[80:83], v[28:31], v[184:187], v[80:83]
  ds_read_b64_tr_b16 v[24:25], v10 offset:8192
  v_mfma_f32_16x16x32_bf16 v[84:87], v[28:31], v[188:191], v[84:87]
  ds_read_b64_tr_b16 v[26:27], v10 offset:9216
  s_add_u32 s62, s18, 24576
  buffer_load_dwordx4 v[228:231], v2, s[24:27], s62 offen offset:1024 sc1
  s_waitcnt lgkmcnt(6)
  v_mfma_f32_16x16x32_bf16 v[88:91], v[12:15], v[184:187], v[88:91]
  ds_read_b64_tr_b16 v[28:29], v11 offset:8192
  v_mfma_f32_16x16x32_bf16 v[92:95], v[12:15], v[188:191], v[92:95]
  ds_read_b64_tr_b16 v[30:31], v11 offset:9216
  s_waitcnt lgkmcnt(6)
  v_mfma_f32_16x16x32_bf16 v[96:99], v[16:19], v[184:187], v[96:99]
  s_barrier
  v_xor_b32 v4, 0x10000, v4
  v_xor_b32 v5, 0x10000, v5
  v_xor_b32 v6, 0x10000, v6
  v_xor_b32 v7, 0x10000, v7
  v_xor_b32 v8, 0x10000, v8
  v_xor_b32 v9, 0x10000, v9
  v_xor_b32 v10, 0x10000, v10
  v_xor_b32 v11, 0x10000, v11
  ds_read_b64_tr_b16 v[12:13], v4 offset:0
  v_mfma_f32_16x16x32_bf16 v[100:103], v[16:19], v[188:191], v[100:103]
  ds_read_b64_tr_b16 v[14:15], v4 offset:1024
  s_waitcnt lgkmcnt(6)
  v_mfma_f32_16x16x32_bf16 v[104:107], v[20:23], v[184:187], v[104:107]
  ds_read_b64_tr_b16 v[16:17], v5 offset:0
  v_mfma_f32_16x16x32_bf16 v[108:111], v[20:23], v[188:191], v[108:111]
  ds_read_b64_tr_b16 v[18:19], v5 offset:1024
  s_waitcnt lgkmcnt(6)
  v_mfma_f32_16x16x32_bf16 v[112:115], v[24:27], v[184:187], v[112:115]
  ds_read_b64_tr_b16 v[20:21], v6 offset:0
  v_mfma_f32_16x16x32_bf16 v[116:119], v[24:27], v[188:191], v[116:119]
  ds_read_b64_tr_b16 v[22:23], v6 offset:1024
  s_cmp_eq_u32 s12, 0
  s_cbranch_scc0 kvattn_kernel_p1k
  v_and_b32 v3, 7, v0
  v_lshlrev_b32 v3, 7, v3
  buffer_load_dword v3, v3, s[96:99], s17 offen sc1
kvattn_kernel_p1k:
  s_waitcnt lgkmcnt(6)
  v_mfma_f32_16x16x32_bf16 v[120:123], v[28:31], v[184:187], v[120:123]
  ds_read_b64_tr_b16 v[24:25], v7 offset:0
  v_mfma_f32_16x16x32_bf16 v[124:127], v[28:31], v[188:191], v[124:127]
  ds_read_b64_tr_b16 v[26:27], v7 offset:1024
  s_waitcnt vmcnt(18)
  s_waitcnt lgkmcnt(6)
  v_mfma_f32_16x16x32_bf16 v[64:67], v[12:15], v[192:195], v[64:67]
  ds_read_b64_tr_b16 v[28:29], v8 offset:0
  v_mfma_f32_16x16x32_bf16 v[68:71], v[12:15], v[196:199], v[68:71]
  ds_read_b64_tr_b16 v[30:31], v8 offset:1024
  s_add_u32 s62, s18, 26624
  buffer_load_dwordx4 v[232:235], v2, s[24:27], s62 offen offset:0 sc1
  s_waitcnt lgkmcnt(6)
  v_mfma_f32_16x16x32_bf16 v[72:75], v[16:19], v[192:195], v[72:75]
  ds_read_b64_tr_b16 v[12:13], v9 offset:0
  v_mfma_f32_16x16x32_bf16 v[76:79], v[16:19], v[196:199], v[76:79]
  ds_read_b64_tr_b16 v[14:15], v9 offset:1024
  s_waitcnt lgkmcnt(6)
  v_mfma_f32_16x16x32_bf16 v[80:83], v[20:23], v[192:195], v[80:83]
  ds_read_b64_tr_b16 v[16:17], v10 offset:0
  v_mfma_f32_16x16x32_bf16 v[84:87], v[20:23], v[196:199], v[84:87]
  ds_read_b64_tr_b16 v[18:19], v10 offset:1024
  s_add_u32 s62, s18, 26624
  buffer_load_dwordx4 v[236:239], v2, s[24:27], s62 offen offset:1024 sc1
  s_waitcnt lgkmcnt(6)
  v_mfma_f32_16x16x32_bf16 v[88:91], v[24:27], v[192:195], v[88:91]
  ds_read_b64_tr_b16 v[20:21], v11 offset:0
  v_mfma_f32_16x16x32_bf16 v[92:95], v[24:27], v[196:199], v[92:95]
  ds_read_b64_tr_b16 v[22:23], v11 offset:1024
  s_waitcnt lgkmcnt(6)
  v_mfma_f32_16x16x32_bf16 v[96:99], v[28:31], v[192:195], v[96:99]
  ds_read_b64_tr_b16 v[24:25], v4 offset:8192
  v_mfma_f32_16x16x32_bf16 v[100:103], v[28:31], v[196:199], v[100:103]
  ds_read_b64_tr_b16 v[26:27], v4 offset:9216
  s_waitcnt lgkmcnt(6)
  v_mfma_f32_16x16x32_bf16 v[104:107], v[12:15], v[192:195], v[104:107]
  ds_read_b64_tr_b16 v[28:29], v5 offset:8192
  v_mfma_f32_16x16x32_bf16 v[108:111], v[12:15], v[196:199], v[108:111]
  ds_read_b64_tr_b16 v[30:31], v5 offset:9216
  s_waitcnt lgkmcnt(6)
  v_mfma_f32_16x16x32_bf16 v[112:115], v[16:19], v[192:195], v[112:115]
  ds_read_b64_tr_b16 v[12:13], v6 offset:8192
  v_mfma_f32_16x16x32_bf16 v[116:119], v[16:19], v[196:199], v[116:119]
  ds_read_b64_tr_b16 v[14:15], v6 offset:9216
  s_load_dwordx2 s[20:21], s[0:1], 40
  s_waitcnt lgkmcnt(6)
  v_mfma_f32_16x16x32_bf16 v[120:123], v[20:23], v[192:195], v[120:123]
  ds_read_b64_tr_b16 v[16:17], v7 offset:8192
  v_mfma_f32_16x16x32_bf16 v[124:127], v[20:23], v[196:199], v[124:127]
  ds_read_b64_tr_b16 v[18:19], v7 offset:9216
  s_waitcnt vmcnt(17)
  s_waitcnt lgkmcnt(6)
  v_mfma_f32_16x16x32_bf16 v[64:67], v[24:27], v[200:203], v[64:67]
  ds_read_b64_tr_b16 v[20:21], v8 offset:8192
  v_mfma_f32_16x16x32_bf16 v[68:71], v[24:27], v[204:207], v[68:71]
  ds_read_b64_tr_b16 v[22:23], v8 offset:9216
  s_add_u32 s62, s18, 28672
  buffer_load_dwordx4 v[240:243], v2, s[24:27], s62 offen offset:0 sc1
  v_add_u32 v1, s46, v2
  s_waitcnt lgkmcnt(6)
  v_mfma_f32_16x16x32_bf16 v[72:75], v[28:31], v[200:203], v[72:75]
  ds_read_b64_tr_b16 v[24:25], v9 offset:8192
  v_mfma_f32_16x16x32_bf16 v[76:79], v[28:31], v[204:207], v[76:79]
  ds_read_b64_tr_b16 v[26:27], v9 offset:9216
  v_mov_b32 v192, 0
  s_waitcnt lgkmcnt(6)
  v_mfma_f32_16x16x32_bf16 v[80:83], v[12:15], v[200:203], v[80:83]
  ds_read_b64_tr_b16 v[28:29], v10 offset:8192
  v_mfma_f32_16x16x32_bf16 v[84:87], v[12:15], v[204:207], v[84:87]
  ds_read_b64_tr_b16 v[30:31], v10 offset:9216
  s_add_u32 s62, s18, 28672
  buffer_load_dwordx4 v[244:247], v2, s[24:27], s62 offen offset:1024 sc1
  s_cmp_eq_u32 s12, 0
  s_cbranch_scc0 kvattn_kernel_p2k
  s_waitcnt vmcnt(4)
  v_cmp_ne_u32 vcc, s85, v3
  s_cbranch_vccnz kvattn_kernel_spink
kvattn_kernel_readyk:
kvattn_kernel_p2k:
  v_mov_b32 v193, 0
  s_waitcnt lgkmcnt(6)
  v_mfma_f32_16x16x32_bf16 v[88:91], v[16:19], v[200:203], v[88:91]
  ds_read_b64_tr_b16 v[12:13], v11 offset:8192
  v_mfma_f32_16x16x32_bf16 v[92:95], v[16:19], v[204:207], v[92:95]
  ds_read_b64_tr_b16 v[14:15], v11 offset:9216
  v_mov_b32 v194, 0
  s_waitcnt lgkmcnt(6)
  v_mfma_f32_16x16x32_bf16 v[96:99], v[20:23], v[200:203], v[96:99]
  s_waitcnt vmcnt(10)
  s_barrier
  v_mov_b32 v3, s85
  s_mov_b64 exec, 1
  buffer_store_dword v3, off, s[96:99], s100 offset:8 sc1
  s_mov_b64 exec, -1
  v_xor_b32 v4, 0x10000, v4
  v_xor_b32 v5, 0x10000, v5
  v_xor_b32 v6, 0x10000, v6
  v_xor_b32 v7, 0x10000, v7
  v_xor_b32 v8, 0x10000, v8
  v_xor_b32 v9, 0x10000, v9
  v_xor_b32 v10, 0x10000, v10
  v_xor_b32 v11, 0x10000, v11
  ds_read_b64_tr_b16 v[16:17], v4 offset:16384
  v_mfma_f32_16x16x32_bf16 v[100:103], v[20:23], v[204:207], v[100:103]
  ds_read_b64_tr_b16 v[18:19], v4 offset:17408
  v_mov_b32 v195, 0
  s_waitcnt lgkmcnt(6)
  v_mfma_f32_16x16x32_bf16 v[104:107], v[24:27], v[200:203], v[104:107]
  ds_read_b64_tr_b16 v[20:21], v5 offset:16384
  v_mfma_f32_16x16x32_bf16 v[108:111], v[24:27], v[204:207], v[108:111]
  ds_read_b64_tr_b16 v[22:23], v5 offset:17408
  s_add_u32 m0, s46, 131072
  s_add_u32 s47, s15, 0
  buffer_load_dwordx4 v1, s[32:35], s47 offen offset:0 sc1 lds
  v_mov_b32 v196, 0
  s_waitcnt lgkmcnt(6)
  v_mfma_f32_16x16x32_bf16 v[112:115], v[28:31], v[200:203], v[112:115]
  ds_read_b64_tr_b16 v[24:25], v6 offset:16384
  v_mfma_f32_16x16x32_bf16 v[116:119], v[28:31], v[204:207], v[116:119]
  ds_read_b64_tr_b16 v[26:27], v6 offset:17408
  v_mov_b32 v197, 0
  s_waitcnt lgkmcnt(6)
  v_mfma_f32_16x16x32_bf16 v[120:123], v[12:15], v[200:203], v[120:123]
  ds_read_b64_tr_b16 v[28:29], v7 offset:16384
  v_mfma_f32_16x16x32_bf16 v[124:127], v[12:15], v[204:207], v[124:127]
  ds_read_b64_tr_b16 v[30:31], v7 offset:17408
  v_mov_b32 v198, 0
  s_waitcnt vmcnt(10)
  s_waitcnt lgkmcnt(6)
  v_mfma_f32_16x16x32_bf16 v[64:67], v[16:19], v[208:211], v[64:67]
  ds_read_b64_tr_b16 v[12:13], v8 offset:16384
  v_mfma_f32_16x16x32_bf16 v[68:71], v[16:19], v[212:215], v[68:71]
  ds_read_b64_tr_b16 v[14:15], v8 offset:17408
  s_add_u32 s62, s18, 30720
  buffer_load_dwordx4 v[248:251], v2, s[24:27], s62 offen offset:0 sc1
  s_add_u32 m0, s46, 131072
  s_add_u32 s47, s15, 0
  buffer_load_dwordx4 v1, s[32:35], s47 offen offset:1024 sc1 lds
  v_mov_b32 v199, 0
  s_waitcnt lgkmcnt(6)
  v_mfma_f32_16x16x32_bf16 v[72:75], v[20:23], v[208:211], v[72:75]
  ds_read_b64_tr_b16 v[16:17], v9 offset:16384
  v_mfma_f32_16x16x32_bf16 v[76:79], v[20:23], v[212:215], v[76:79]
  ds_read_b64_tr_b16 v[18:19], v9 offset:17408
  v_mov_b32 v200, 0
  s_waitcnt lgkmcnt(6)
  v_mfma_f32_16x16x32_bf16 v[80:83], v[24:27], v[208:211], v[80:83]
  ds_read_b64_tr_b16 v[20:21], v10 offset:16384
  v_mfma_f32_16x16x32_bf16 v[84:87], v[24:27], v[212:215], v[84:87]
  ds_read_b64_tr_b16 v[22:23], v10 offset:17408
  s_add_u32 s62, s18, 30720
  buffer_load_dwordx4 v[252:255], v2, s[24:27], s62 offen offset:1024 sc1
  v_mov_b32 v201, 0
  s_waitcnt lgkmcnt(6)
  v_mfma_f32_16x16x32_bf16 v[88:91], v[28:31], v[208:211], v[88:91]
  ds_read_b64_tr_b16 v[24:25], v11 offset:16384
  v_mfma_f32_16x16x32_bf16 v[92:95], v[28:31], v[212:215], v[92:95]
  ds_read_b64_tr_b16 v[26:27], v11 offset:17408
  s_add_u32 m0, s46, 147456
  s_add_u32 s47, s15, 16384
  buffer_load_dwordx4 v1, s[32:35], s47 offen offset:0 sc1 lds
  v_mov_b32 v202, 0
  s_waitcnt lgkmcnt(6)
  v_mfma_f32_16x16x32_bf16 v[96:99], v[12:15], v[208:211], v[96:99]
  ds_read_b64_tr_b16 v[28:29], v4 offset:24576
  v_mfma_f32_16x16x32_bf16 v[100:103], v[12:15], v[212:215], v[100:103]
  ds_read_b64_tr_b16 v[30:31], v4 offset:25600
  v_mov_b32 v203, 0
  s_waitcnt lgkmcnt(6)
  v_mfma_f32_16x16x32_bf16 v[104:107], v[16:19], v[208:211], v[104:107]
  ds_read_b64_tr_b16 v[12:13], v5 offset:24576
  v_mfma_f32_16x16x32_bf16 v[108:111], v[16:19], v[212:215], v[108:111]
  ds_read_b64_tr_b16 v[14:15], v5 offset:25600
  s_and_b32 s18, s13, 3
  s_andn2_b32 s19, s13, 3
  v_mov_b32 v204, 0
  s_waitcnt lgkmcnt(6)
  v_mfma_f32_16x16x32_bf16 v[112:115], v[20:23], v[208:211], v[112:115]
  ds_read_b64_tr_b16 v[16:17], v6 offset:24576
  v_mfma_f32_16x16x32_bf16 v[116:119], v[20:23], v[212:215], v[116:119]
  ds_read_b64_tr_b16 v[18:19], v6 offset:25600
  s_add_u32 m0, s46, 147456
  s_add_u32 s47, s15, 16384
  buffer_load_dwordx4 v1, s[32:35], s47 offen offset:1024 sc1 lds
  s_lshl_b32 s4, s19, 17
  s_lshl_b32 s49, s18, 8
  v_mov_b32 v205, 0
  s_waitcnt lgkmcnt(6)
  v_mfma_f32_16x16x32_bf16 v[120:123], v[24:27], v[208:211], v[120:123]
  ds_read_b64_tr_b16 v[20:21], v7 offset:24576
  v_mfma_f32_16x16x32_bf16 v[124:127], v[24:27], v[212:215], v[124:127]
  ds_read_b64_tr_b16 v[22:23], v7 offset:25600
  s_add_u32 s4, s4, s49
  s_lshl_b32 s49, s16, 14
  v_mov_b32 v206, 0
  s_waitcnt vmcnt(13)
  s_waitcnt lgkmcnt(6)
  v_mfma_f32_16x16x32_bf16 v[64:67], v[28:31], v[216:219], v[64:67]
  ds_read_b64_tr_b16 v[24:25], v8 offset:24576
  v_mfma_f32_16x16x32_bf16 v[68:71], v[28:31], v[220:223], v[68:71]
  ds_read_b64_tr_b16 v[26:27], v8 offset:25600
  s_add_u32 s4, s4, s49
  s_and_b32 s5, s51, 0xffff9fff
  v_mov_b32 v207, 0
  s_waitcnt lgkmcnt(6)
  v_mfma_f32_16x16x32_bf16 v[72:75], v[12:15], v[216:219], v[72:75]
  ds_read_b64_tr_b16 v[28:29], v9 offset:24576
  v_mfma_f32_16x16x32_bf16 v[76:79], v[12:15], v[220:223], v[76:79]
  ds_read_b64_tr_b16 v[30:31], v9 offset:25600
  s_mov_b32 s6, s51
  s_add_u32 s7, s51, 4096
  v_mov_b32 v208, 0
  s_waitcnt lgkmcnt(6)
  v_mfma_f32_16x16x32_bf16 v[80:83], v[16:19], v[216:219], v[80:83]
  ds_read_b64_tr_b16 v[12:13], v10 offset:24576
  v_mfma_f32_16x16x32_bf16 v[84:87], v[16:19], v[220:223], v[84:87]
  ds_read_b64_tr_b16 v[14:15], v10 offset:25600
  s_and_b32 s8, s101, 0xffff9fff
  s_add_u32 s9, s42, 16384
  v_mov_b32 v209, 0
  s_waitcnt lgkmcnt(6)
  v_mfma_f32_16x16x32_bf16 v[88:91], v[20:23], v[216:219], v[88:91]
  ds_read_b64_tr_b16 v[16:17], v11 offset:24576
  v_mfma_f32_16x16x32_bf16 v[92:95], v[20:23], v[220:223], v[92:95]
  ds_read_b64_tr_b16 v[18:19], v11 offset:25600
  s_and_b32 s9, s9, 0xc000
  s_add_u32 s9, s9, 98304
  v_mov_b32 v210, 0
  s_waitcnt lgkmcnt(6)
  v_mfma_f32_16x16x32_bf16 v[96:99], v[24:27], v[216:219], v[96:99]
  s_barrier
  ds_read_b64_tr_b16 v[20:21], v4 offset:32768
  v_mfma_f32_16x16x32_bf16 v[100:103], v[24:27], v[220:223], v[100:103]
  ds_read_b64_tr_b16 v[22:23], v4 offset:33792
  s_add_u32 s24, s10, 0x4000000
  s_addc_u32 s25, s11, 0
  s_mov_b32 s26, 0x1000000
  v_mov_b32 v211, 0
  s_waitcnt lgkmcnt(6)
  v_mfma_f32_16x16x32_bf16 v[104:107], v[28:31], v[216:219], v[104:107]
  ds_read_b64_tr_b16 v[24:25], v5 offset:32768
  v_mfma_f32_16x16x32_bf16 v[108:111], v[28:31], v[220:223], v[108:111]
  ds_read_b64_tr_b16 v[26:27], v5 offset:33792
  s_mov_b32 s27, 0x20000
  s_mov_b32 s22, 0x400000
  v_mov_b32 v212, 0
  s_waitcnt lgkmcnt(6)
  v_mfma_f32_16x16x32_bf16 v[112:115], v[12:15], v[216:219], v[112:115]
  ds_read_b64_tr_b16 v[28:29], v6 offset:32768
  v_mfma_f32_16x16x32_bf16 v[116:119], v[12:15], v[220:223], v[116:119]
  ds_read_b64_tr_b16 v[30:31], v6 offset:33792
  s_cmp_eq_u32 s12, 0
  s_cbranch_scc0 kvattn_kernel_p1v
  v_and_b32 v3, 7, v0
  v_lshl_or_b32 v3, v3, 7, 8
  buffer_load_dword v3, v3, s[96:99], s17 offen sc1
kvattn_kernel_p1v:
  s_mov_b32 s23, 0x20000
  v_mov_b32 v213, 0
  s_waitcnt lgkmcnt(6)
  v_mfma_f32_16x16x32_bf16 v[120:123], v[16:19], v[216:219], v[120:123]
  ds_read_b64_tr_b16 v[12:13], v7 offset:32768
  v_mfma_f32_16x16x32_bf16 v[124:127], v[16:19], v[220:223], v[124:127]
  ds_read_b64_tr_b16 v[14:15], v7 offset:33792
  v_mov_b32 v214, 0
  s_waitcnt vmcnt(11)
  s_waitcnt lgkmcnt(6)
  v_mfma_f32_16x16x32_bf16 v[64:67], v[20:23], v[224:227], v[64:67]
  ds_read_b64_tr_b16 v[16:17], v8 offset:32768
  v_mfma_f32_16x16x32_bf16 v[68:71], v[20:23], v[228:231], v[68:71]
  ds_read_b64_tr_b16 v[18:19], v8 offset:33792
  v_mov_b32 v215, 0
  s_waitcnt lgkmcnt(6)
  v_mfma_f32_16x16x32_bf16 v[72:75], v[24:27], v[224:227], v[72:75]
  ds_read_b64_tr_b16 v[20:21], v9 offset:32768
  v_mfma_f32_16x16x32_bf16 v[76:79], v[24:27], v[228:231], v[76:79]
  ds_read_b64_tr_b16 v[22:23], v9 offset:33792
  v_mov_b32 v216, 0
  s_waitcnt lgkmcnt(6)
  v_mfma_f32_16x16x32_bf16 v[80:83], v[28:31], v[224:227], v[80:83]
  ds_read_b64_tr_b16 v[24:25], v10 offset:32768
  v_mfma_f32_16x16x32_bf16 v[84:87], v[28:31], v[228:231], v[84:87]
  ds_read_b64_tr_b16 v[26:27], v10 offset:33792
  v_mov_b32 v217, 0
  s_waitcnt lgkmcnt(6)
  v_mfma_f32_16x16x32_bf16 v[88:91], v[12:15], v[224:227], v[88:91]
  ds_read_b64_tr_b16 v[28:29], v11 offset:32768
  v_mfma_f32_16x16x32_bf16 v[92:95], v[12:15], v[228:231], v[92:95]
  ds_read_b64_tr_b16 v[30:31], v11 offset:33792
  v_mov_b32 v218, 0
  s_waitcnt lgkmcnt(6)
  v_mfma_f32_16x16x32_bf16 v[96:99], v[16:19], v[224:227], v[96:99]
  ds_read_b64_tr_b16 v[12:13], v4 offset:40960
  v_mfma_f32_16x16x32_bf16 v[100:103], v[16:19], v[228:231], v[100:103]
  ds_read_b64_tr_b16 v[14:15], v4 offset:41984
  v_mov_b32 v219, 0
  s_waitcnt lgkmcnt(6)
  v_mfma_f32_16x16x32_bf16 v[104:107], v[20:23], v[224:227], v[104:107]
  ds_read_b64_tr_b16 v[16:17], v5 offset:40960
  v_mfma_f32_16x16x32_bf16 v[108:111], v[20:23], v[228:231], v[108:111]
  ds_read_b64_tr_b16 v[18:19], v5 offset:41984
  v_mov_b32 v220, 0
  s_waitcnt lgkmcnt(6)
  v_mfma_f32_16x16x32_bf16 v[112:115], v[24:27], v[224:227], v[112:115]
  ds_read_b64_tr_b16 v[20:21], v6 offset:40960
  v_mfma_f32_16x16x32_bf16 v[116:119], v[24:27], v[228:231], v[116:119]
  ds_read_b64_tr_b16 v[22:23], v6 offset:41984
  v_mov_b32 v221, 0
  s_waitcnt lgkmcnt(6)
  v_mfma_f32_16x16x32_bf16 v[120:123], v[28:31], v[224:227], v[120:123]
  ds_read_b64_tr_b16 v[24:25], v7 offset:40960
  v_mfma_f32_16x16x32_bf16 v[124:127], v[28:31], v[228:231], v[124:127]
  ds_read_b64_tr_b16 v[26:27], v7 offset:41984
  v_mov_b32 v222, 0
  s_waitcnt vmcnt(9)
  s_waitcnt lgkmcnt(6)
  v_mfma_f32_16x16x32_bf16 v[64:67], v[12:15], v[232:235], v[64:67]
  ds_read_b64_tr_b16 v[28:29], v8 offset:40960
  v_mfma_f32_16x16x32_bf16 v[68:71], v[12:15], v[236:239], v[68:71]
  ds_read_b64_tr_b16 v[30:31], v8 offset:41984
  v_mov_b32 v223, 0
  s_waitcnt lgkmcnt(6)
  v_mfma_f32_16x16x32_bf16 v[72:75], v[16:19], v[232:235], v[72:75]
  ds_read_b64_tr_b16 v[12:13], v9 offset:40960
  v_mfma_f32_16x16x32_bf16 v[76:79], v[16:19], v[236:239], v[76:79]
  ds_read_b64_tr_b16 v[14:15], v9 offset:41984
  v_mov_b32 v224, 0
  s_waitcnt lgkmcnt(6)
  v_mfma_f32_16x16x32_bf16 v[80:83], v[20:23], v[232:235], v[80:83]
  ds_read_b64_tr_b16 v[16:17], v10 offset:40960
  v_mfma_f32_16x16x32_bf16 v[84:87], v[20:23], v[236:239], v[84:87]
  ds_read_b64_tr_b16 v[18:19], v10 offset:41984
  s_cmp_eq_u32 s12, 0
  s_cbranch_scc0 kvattn_kernel_p2v
  s_waitcnt vmcnt(0)
  v_cmp_ne_u32 vcc, s85, v3
  s_cbranch_vccnz kvattn_kernel_spinv
kvattn_kernel_readyv:
kvattn_kernel_p2v:
  v_mov_b32 v225, 0
  s_waitcnt lgkmcnt(6)
  v_mfma_f32_16x16x32_bf16 v[88:91], v[24:27], v[232:235], v[88:91]
  ds_read_b64_tr_b16 v[20:21], v11 offset:40960
  v_mfma_f32_16x16x32_bf16 v[92:95], v[24:27], v[236:239], v[92:95]
  ds_read_b64_tr_b16 v[22:23], v11 offset:41984
  v_add_u32 v3, 98304, v2
  v_mov_b32 v226, 0
  s_waitcnt lgkmcnt(6)
  v_mfma_f32_16x16x32_bf16 v[96:99], v[28:31], v[232:235], v[96:99]
  s_waitcnt vmcnt(0) lgkmcnt(0)
  s_barrier
  ds_read_b64_tr_b16 v[24:25], v4 offset:49152
  v_mfma_f32_16x16x32_bf16 v[100:103], v[28:31], v[236:239], v[100:103]
  ds_read_b64_tr_b16 v[26:27], v4 offset:50176
  ds_read_b128 v[128:131], v3 offset:32768
  v_mov_b32 v227, 0
  v_mfma_f32_16x16x32_bf16 v[104:107], v[12:15], v[232:235], v[104:107]
  ds_read_b64_tr_b16 v[28:29], v5 offset:49152
  v_mfma_f32_16x16x32_bf16 v[108:111], v[12:15], v[236:239], v[108:111]
  ds_read_b64_tr_b16 v[30:31], v5 offset:50176
  s_add_u32 m0, s46, 0
  s_add_u32 s47, s15, 0
  buffer_load_dwordx4 v1, s[36:39], s47 offen offset:0 sc1 lds
  ds_read_b128 v[132:135], v3 offset:33792
  v_mov_b32 v228, 0
  v_mfma_f32_16x16x32_bf16 v[112:115], v[16:19], v[232:235], v[112:115]
  ds_read_b64_tr_b16 v[12:13], v6 offset:49152
  v_mfma_f32_16x16x32_bf16 v[116:119], v[16:19], v[236:239], v[116:119]
  ds_read_b64_tr_b16 v[14:15], v6 offset:50176
  s_mov_b32 s56, s20
  ds_read_b128 v[136:139], v3 offset:34816
  v_mov_b32 v229, 0
  v_mfma_f32_16x16x32_bf16 v[120:123], v[20:23], v[232:235], v[120:123]
  ds_read_b64_tr_b16 v[16:17], v7 offset:49152
  v_mfma_f32_16x16x32_bf16 v[124:127], v[20:23], v[236:239], v[124:127]
  ds_read_b64_tr_b16 v[18:19], v7 offset:50176
  s_add_u32 m0, s46, 0
  s_add_u32 s47, s15, 0
  buffer_load_dwordx4 v1, s[36:39], s47 offen offset:1024 sc1 lds
  s_mov_b32 s57, s21
  ds_read_b128 v[140:143], v3 offset:35840
  v_mov_b32 v230, 0
  s_waitcnt lgkmcnt(10)
  v_mfma_f32_16x16x32_bf16 v[64:67], v[24:27], v[240:243], v[64:67]
  ds_read_b64_tr_b16 v[20:21], v8 offset:49152
  v_mfma_f32_16x16x32_bf16 v[68:71], v[24:27], v[244:247], v[68:71]
  ds_read_b64_tr_b16 v[22:23], v8 offset:50176
  s_cmp_ge_u32 s16, 1
  s_cselect_b32 s56, s88, s56
  s_cselect_b32 s57, s89, s57
  ds_read_b128 v[144:147], v3 offset:36864
  v_mov_b32 v231, 0
  s_waitcnt lgkmcnt(10)
  v_mfma_f32_16x16x32_bf16 v[72:75], v[28:31], v[240:243], v[72:75]
  ds_read_b64_tr_b16 v[24:25], v9 offset:49152
  v_mfma_f32_16x16x32_bf16 v[76:79], v[28:31], v[244:247], v[76:79]
  ds_read_b64_tr_b16 v[26:27], v9 offset:50176
  s_add_u32 m0, s46, 16384
  s_add_u32 s47, s15, 16384
  buffer_load_dwordx4 v1, s[36:39], s47 offen offset:0 sc1 lds
  s_cmp_ge_u32 s16, 2
  s_cselect_b32 s56, s90, s56
  s_cselect_b32 s57, s91, s57
  ds_read_b128 v[148:151], v3 offset:37888
  v_mov_b32 v232, 0
  s_waitcnt lgkmcnt(10)
  v_mfma_f32_16x16x32_bf16 v[80:83], v[12:15], v[240:243], v[80:83]
  ds_read_b64_tr_b16 v[28:29], v10 offset:49152
  v_mfma_f32_16x16x32_bf16 v[84:87], v[12:15], v[244:247], v[84:87]
  ds_read_b64_tr_b16 v[30:31], v10 offset:50176
  s_cmp_ge_u32 s16, 3
  s_cselect_b32 s56, s86, s56
  s_cselect_b32 s57, s87, s57
  ds_read_b128 v[152:155], v3 offset:38912
  v_mov_b32 v233, 0
  s_waitcnt lgkmcnt(10)
  v_mfma_f32_16x16x32_bf16 v[88:91], v[16:19], v[240:243], v[88:91]
  ds_read_b64_tr_b16 v[12:13], v11 offset:49152
  v_mfma_f32_16x16x32_bf16 v[92:95], v[16:19], v[244:247], v[92:95]
  ds_read_b64_tr_b16 v[14:15], v11 offset:50176
  s_add_u32 m0, s46, 16384
  s_add_u32 s47, s15, 16384
  buffer_load_dwordx4 v1, s[36:39], s47 offen offset:1024 sc1 lds
  ds_read_b128 v[156:159], v3 offset:39936
  v_mov_b32 v234, 0
  s_waitcnt lgkmcnt(10)
  v_mfma_f32_16x16x32_bf16 v[96:99], v[20:23], v[240:243], v[96:99]
  ds_read_b64_tr_b16 v[16:17], v4 offset:57344
  v_mfma_f32_16x16x32_bf16 v[100:103], v[20:23], v[244:247], v[100:103]
  ds_read_b64_tr_b16 v[18:19], v4 offset:58368
  ds_read_b128 v[160:163], v3 offset:40960
  v_mov_b32 v235, 0
  s_waitcnt lgkmcnt(10)
  v_mfma_f32_16x16x32_bf16 v[104:107], v[24:27], v[240:243], v[104:107]
  ds_read_b64_tr_b16 v[20:21], v5 offset:57344
  v_mfma_f32_16x16x32_bf16 v[108:111], v[24:27], v[244:247], v[108:111]
  ds_read_b64_tr_b16 v[22:23], v5 offset:58368
  s_add_u32 m0, s46, 98304
  s_add_u32 s47, s15, 32768
  buffer_load_dwordx4 v1, s[32:35], s47 offen offset:0 sc1 lds
  ds_read_b128 v[164:167], v3 offset:41984
  v_mov_b32 v236, 0
  s_waitcnt lgkmcnt(10)
  v_mfma_f32_16x16x32_bf16 v[112:115], v[28:31], v[240:243], v[112:115]
  ds_read_b64_tr_b16 v[24:25], v6 offset:57344
  v_mfma_f32_16x16x32_bf16 v[116:119], v[28:31], v[244:247], v[116:119]
  ds_read_b64_tr_b16 v[26:27], v6 offset:58368
  ds_read_b128 v[168:171], v3 offset:43008
  v_mov_b32 v237, 0
  s_waitcnt lgkmcnt(10)
  v_mfma_f32_16x16x32_bf16 v[120:123], v[12:15], v[240:243], v[120:123]
  ds_read_b64_tr_b16 v[28:29], v7 offset:57344
  v_mfma_f32_16x16x32_bf16 v[124:127], v[12:15], v[244:247], v[124:127]
  ds_read_b64_tr_b16 v[30:31], v7 offset:58368
  s_add_u32 m0, s46, 98304
  s_add_u32 s47, s15, 32768
  buffer_load_dwordx4 v1, s[32:35], s47 offen offset:1024 sc1 lds
  ds_read_b128 v[172:175], v3 offset:44032
  v_mov_b32 v238, 0
  s_waitcnt lgkmcnt(10)
  v_mfma_f32_16x16x32_bf16 v[64:67], v[16:19], v[248:251], v[64:67]
  ds_read_b64_tr_b16 v[12:13], v8 offset:57344
  v_mfma_f32_16x16x32_bf16 v[68:71], v[16:19], v[252:255], v[68:71]
  ds_read_b64_tr_b16 v[14:15], v8 offset:58368
  s_cmp_gt_i32 s45, -1
  s_cselect_b32 s46, 2.0, -1.0
  s_cselect_b32 s47, 0, 1
  v_add_u32 v1, s44, v2
  ds_read_b128 v[176:179], v3 offset:45056
  v_mov_b32 v239, 0
  s_waitcnt lgkmcnt(10)
  v_mfma_f32_16x16x32_bf16 v[72:75], v[20:23], v[248:251], v[72:75]
  ds_read_b64_tr_b16 v[16:17], v9 offset:57344
  v_mfma_f32_16x16x32_bf16 v[76:79], v[20:23], v[252:255], v[76:79]
  ds_read_b64_tr_b16 v[18:19], v9 offset:58368
  ds_read_b128 v[180:183], v3 offset:46080
  v_mov_b32 v240, 0
  s_waitcnt lgkmcnt(10)
  v_mfma_f32_16x16x32_bf16 v[80:83], v[24:27], v[248:251], v[80:83]
  ds_read_b64_tr_b16 v[20:21], v10 offset:57344
  v_mfma_f32_16x16x32_bf16 v[84:87], v[24:27], v[252:255], v[84:87]
  ds_read_b64_tr_b16 v[22:23], v10 offset:58368
  ds_read_b128 v[184:187], v3 offset:47104
  v_cvt_pk_bf16_f32 v32, v64, v65
  v_cvt_pk_bf16_f32 v33, v66, v67
  v_cvt_pk_bf16_f32 v48, v68, v69
  v_cvt_pk_bf16_f32 v49, v70, v71
  s_waitcnt lgkmcnt(10)
  v_mfma_f32_16x16x32_bf16 v[88:91], v[28:31], v[248:251], v[88:91]
  ds_read_b64_tr_b16 v[24:25], v11 offset:57344
  v_mfma_f32_16x16x32_bf16 v[92:95], v[28:31], v[252:255], v[92:95]
  ds_read_b64_tr_b16 v[26:27], v11 offset:58368
  ds_read_b128 v[188:191], v3 offset:48128
  v_cvt_pk_bf16_f32 v34, v72, v73
  v_cvt_pk_bf16_f32 v35, v74, v75
  v_cvt_pk_bf16_f32 v50, v76, v77
  v_cvt_pk_bf16_f32 v51, v78, v79
  s_waitcnt lgkmcnt(10)
  v_mfma_f32_16x16x32_bf16 v[96:99], v[12:15], v[248:251], v[96:99]
  v_mfma_f32_16x16x32_bf16 v[100:103], v[12:15], v[252:255], v[100:103]
  v_cvt_pk_bf16_f32 v36, v80, v81
  v_cvt_pk_bf16_f32 v37, v82, v83
  v_cvt_pk_bf16_f32 v52, v84, v85
  v_cvt_pk_bf16_f32 v53, v86, v87
  v_mov_b32 v5, v2
  v_lshrrev_b32 v8, 4, v0
  s_waitcnt lgkmcnt(7)
  v_mfma_f32_16x16x32_bf16 v[104:107], v[16:19], v[248:251], v[104:107]
  v_mfma_f32_16x16x32_bf16 v[108:111], v[16:19], v[252:255], v[108:111]
  v_cvt_pk_bf16_f32 v38, v88, v89
  v_cvt_pk_bf16_f32 v39, v90, v91
  v_cvt_pk_bf16_f32 v54, v92, v93
  v_cvt_pk_bf16_f32 v55, v94, v95
  v_and_b32 v4, 15, v0
  v_lshlrev_b32 v8, 2, v8
  s_waitcnt lgkmcnt(4)
  v_mfma_f32_16x16x32_bf16 v[112:115], v[20:23], v[248:251], v[112:115]
  v_mfma_f32_16x16x32_bf16 v[116:119], v[20:23], v[252:255], v[116:119]
  v_cvt_pk_bf16_f32 v40, v96, v97
  v_cvt_pk_bf16_f32 v41, v98, v99
  v_cvt_pk_bf16_f32 v56, v100, v101
  v_cvt_pk_bf16_f32 v57, v102, v103
  v_sub_u32 v4, v4, v8
  s_waitcnt lgkmcnt(1)
  v_mfma_f32_16x16x32_bf16 v[120:123], v[24:27], v[248:251], v[120:123]
  v_mfma_f32_16x16x32_bf16 v[124:127], v[24:27], v[252:255], v[124:127]
  v_cvt_pk_bf16_f32 v42, v104, v105
  v_cvt_pk_bf16_f32 v43, v106, v107
  v_cvt_pk_bf16_f32 v58, v108, v109
  v_cvt_pk_bf16_f32 v59, v110, v111
  s_cmp_lt_u32 s12, 4
  s_cbranch_scc1 kvattn_kernel_apr
  s_setprio 1
kvattn_kernel_apr:
  v_mfma_f32_16x16x32_bf16 v[80:83], v[128:131], v[32:35], 0
  v_cvt_pk_bf16_f32 v44, v112, v113
  v_cvt_pk_bf16_f32 v45, v114, v115
  v_mfma_f32_16x16x32_bf16 v[84:87], v[128:131], v[48:51], 0
  v_cvt_pk_bf16_f32 v60, v116, v117
  v_cvt_pk_bf16_f32 v61, v118, v119
  v_mfma_f32_16x16x32_bf16 v[80:83], v[132:135], v[36:39], v[80:83]
  v_cvt_pk_bf16_f32 v46, v120, v121
  v_cvt_pk_bf16_f32 v47, v122, v123
  v_mfma_f32_16x16x32_bf16 v[84:87], v[132:135], v[52:55], v[84:87]
  v_cvt_pk_bf16_f32 v62, v124, v125
  v_cvt_pk_bf16_f32 v63, v126, v127
  v_mfma_f32_16x16x32_bf16 v[80:83], v[136:139], v[40:43], v[80:83]
  v_mov_b32 v12, 0x3f803f80
  v_mov_b32 v241, 0
  v_mfma_f32_16x16x32_bf16 v[84:87], v[136:139], v[56:59], v[84:87]
  v_mov_b32 v13, 0x3f803f80
  v_mov_b32 v242, 0
  v_mfma_f32_16x16x32_bf16 v[80:83], v[140:143], v[44:47], v[80:83]
  v_mov_b32 v14, 0x3f803f80
  v_mov_b32 v243, 0
  v_mfma_f32_16x16x32_bf16 v[84:87], v[140:143], v[60:63], v[84:87]
  v_mov_b32 v15, 0x3f803f80
  v_mov_b32 v244, 0
  v_mfma_f32_16x16x32_bf16 v[88:91], v[144:147], v[32:35], 0
  v_lshlrev_b32 v124, 7, v0
  v_mov_b32 v245, 0
  v_mfma_f32_16x16x32_bf16 v[92:95], v[144:147], v[48:51], 0
  v_mov_b32 v246, 0
  v_mov_b32 v247, 0
  v_mfma_f32_16x16x32_bf16 v[88:91], v[148:151], v[36:39], v[88:91]
  v_mfma_f32_16x16x32_bf16 v[92:95], v[148:151], v[52:55], v[92:95]
  v_mfma_f32_16x16x32_bf16 v[88:91], v[152:155], v[40:43], v[88:91]
  v_max3_f32 v6, v80, v81, v82
  v_mfma_f32_16x16x32_bf16 v[92:95], v[152:155], v[56:59], v[92:95]
  v_max3_f32 v7, v84, v85, v86
  v_mfma_f32_16x16x32_bf16 v[88:91], v[156:159], v[44:47], v[88:91]
  v_max_f32 v6, v6, v83
  v_mfma_f32_16x16x32_bf16 v[92:95], v[156:159], v[60:63], v[92:95]
  v_max_f32 v7, v7, v87
  s_cmp_eq_i32 s45, -2
  s_cbranch_scc1 kvattn_kernel_pm0
kvattn_kernel_pm0r:
  v_mov_b32 v248, 0
  v_mov_b32 v249, 0
  v_mov_b32 v250, 0
  v_mov_b32 v251, 0
  v_max3_f32 v6, v6, v88, v89
  v_max3_f32 v7, v7, v92, v93
  v_max3_f32 v6, v6, v90, v91
  v_max3_f32 v7, v7, v94, v95
  v_mov_b32 v121, v6
  v_mov_b32 v122, v7
  v_mov_b32 v252, 0
  v_permlane16_swap_b32 v121, v6
  v_permlane16_swap_b32 v122, v7
  v_mov_b32 v253, 0
  v_max_f32 v6, v6, v121
  v_max_f32 v7, v7, v122
  v_mov_b32 v121, v6
  v_mov_b32 v122, v7
  v_mov_b32 v254, 0
  v_permlane32_swap_b32 v121, v6
  v_permlane32_swap_b32 v122, v7
  v_mov_b32 v255, 0
  v_max_f32 v6, v6, v121
  v_max_f32 v7, v7, v122
  v_sub_f32 v16, 0xc2200000, v6
  v_sub_f32 v17, 0xc2200000, v6
  v_sub_f32 v18, 0xc2200000, v6
  v_sub_f32 v19, 0xc2200000, v6
  v_sub_f32 v20, 0xc2200000, v7
  v_sub_f32 v21, 0xc2200000, v7
  v_sub_f32 v22, 0xc2200000, v7
  v_sub_f32 v23, 0xc2200000, v7
  v_add_f32 v80, v80, v16
  v_add_f32 v81, v81, v16
  s_waitcnt vmcnt(4)
  s_barrier
  v_mfma_f32_16x16x32_bf16 v[96:99], v[160:163], v[32:35], v[16:19]
  ds_read_b128 v[128:131], v5 offset:0
  v_add_f32 v82, v82, v16
  v_add_f32 v83, v83, v16
  v_exp_f32 v80, v80
  v_mfma_f32_16x16x32_bf16 v[100:103], v[160:163], v[48:51], v[20:23]
  ds_read_b128 v[132:135], v5 offset:1024
  v_add_f32 v84, v84, v20
  v_exp_f32 v81, v81
  v_mfma_f32_16x16x32_bf16 v[96:99], v[164:167], v[36:39], v[96:99]
  ds_read_b128 v[136:139], v5 offset:2048
  v_add_f32 v85, v85, v20
  v_exp_f32 v82, v82
  v_exp_f32 v83, v83
  v_cvt_pk_bf16_f32 v64, v80, v81
  v_mfma_f32_16x16x32_bf16 v[100:103], v[164:167], v[52:55], v[100:103]
  ds_read_b128 v[140:143], v5 offset:3072
  v_add_f32 v86, v86, v20
  v_add_f32 v87, v87, v20
  v_exp_f32 v84, v84
  v_cvt_pk_bf16_f32 v65, v82, v83
  v_mfma_f32_16x16x32_bf16 v[96:99], v[168:171], v[40:43], v[96:99]
  ds_read_b128 v[144:147], v5 offset:4096
  v_add_f32 v88, v88, v16
  v_exp_f32 v85, v85
  v_mfma_f32_16x16x32_bf16 v[100:103], v[168:171], v[56:59], v[100:103]
  ds_read_b128 v[148:151], v5 offset:5120
  ds_read_b128 v[160:163], v3 offset:49152
  v_add_f32 v89, v89, v16
  v_exp_f32 v86, v86
  v_exp_f32 v87, v87
  v_cvt_pk_bf16_f32 v68, v84, v85
  v_mfma_f32_16x16x32_bf16 v[96:99], v[172:175], v[44:47], v[96:99]
  ds_read_b128 v[152:155], v5 offset:6144
  v_add_f32 v90, v90, v16
  v_add_f32 v91, v91, v16
  v_exp_f32 v88, v88
  v_cvt_pk_bf16_f32 v69, v86, v87
  v_mfma_f32_16x16x32_bf16 v[100:103], v[172:175], v[60:63], v[100:103]
  ds_read_b128 v[156:159], v5 offset:7168
  ds_read_b128 v[164:167], v3 offset:50176
  v_add_f32 v92, v92, v20
  v_exp_f32 v89, v89
  v_mfma_f32_16x16x32_bf16 v[104:107], v[176:179], v[32:35], v[16:19]
  v_add_f32 v93, v93, v20
  v_exp_f32 v90, v90
  v_exp_f32 v91, v91
  v_cvt_pk_bf16_f32 v66, v88, v89
  v_mfma_f32_16x16x32_bf16 v[108:111], v[176:179], v[48:51], v[20:23]
  ds_read_b128 v[168:171], v3 offset:51200
  v_add_f32 v94, v94, v20
  v_add_f32 v95, v95, v20
  v_exp_f32 v92, v92
  v_cvt_pk_bf16_f32 v67, v90, v91
  v_mfma_f32_16x16x32_bf16 v[104:107], v[180:183], v[36:39], v[104:107]
  v_exp_f32 v93, v93
  v_mfma_f32_16x16x32_bf16 v[108:111], v[180:183], v[52:55], v[108:111]
  ds_read_b128 v[172:175], v3 offset:52224
  v_exp_f32 v94, v94
  v_exp_f32 v95, v95
  v_cvt_pk_bf16_f32 v70, v92, v93
  v_mfma_f32_16x16x32_bf16 v[104:107], v[184:187], v[40:43], v[104:107]
  v_cvt_pk_bf16_f32 v71, v94, v95
  v_exp_f32 v8, v96
  v_mfma_f32_16x16x32_bf16 v[108:111], v[184:187], v[56:59], v[108:111]
  ds_read_b128 v[176:179], v3 offset:53248
  v_exp_f32 v9, v97
  s_waitcnt lgkmcnt(13)
  v_mfma_f32_16x16x32_bf16 v[104:107], v[188:191], v[44:47], v[104:107]
  v_exp_f32 v10, v98
  v_mfma_f32_16x16x32_bf16 v[108:111], v[188:191], v[60:63], v[108:111]
  ds_read_b128 v[180:183], v3 offset:54272
  v_exp_f32 v11, v99
  v_mfma_f32_16x16x32_bf16 v[24:27], v[12:15], v[64:67], 0
  v_mfma_f32_16x16x32_bf16 v[28:31], v[12:15], v[68:71], 0
  s_cmp_lt_i32 s45, 0
  s_cbranch_scc1 kvattn_kernel_pm1
kvattn_kernel_pm1r:
  s_waitcnt lgkmcnt(5)
  s_cmp_eq_u32 s52, 0
  s_cbranch_scc0 kvattn_kernel_loopA
  s_waitcnt vmcnt(0)
  buffer_load_dword v125, v124, s[56:59], s60 offen
  buffer_load_dword v126, v124, s[56:59], s61 offen
kvattn_kernel_loopB:
  v_mfma_f32_16x16x32_bf16 v[192:195], v[128:131], v[64:67], v[192:195]
  ds_read_b128 v[184:187], v3 offset:55296
  v_cvt_pk_bf16_f32 v72, v8, v9
  v_mfma_f32_16x16x32_bf16 v[196:199], v[128:131], v[68:71], v[196:199]
  v_exp_f32 v8, v100
  v_mfma_f32_16x16x32_bf16 v[200:203], v[132:135], v[64:67], v[200:203]
  ds_read_b128 v[188:191], v3 offset:56320
  v_cvt_pk_bf16_f32 v73, v10, v11
  v_mfma_f32_16x16x32_bf16 v[204:207], v[132:135], v[68:71], v[204:207]
  v_exp_f32 v9, v101
  v_mfma_f32_16x16x32_bf16 v[208:211], v[136:139], v[64:67], v[208:211]
  ds_read_b128 v[128:131], v5 offset:8192
  v_cvt_pk_bf16_f32 v76, v8, v9
  v_mfma_f32_16x16x32_bf16 v[212:215], v[136:139], v[68:71], v[212:215]
  v_exp_f32 v10, v102
  v_mfma_f32_16x16x32_bf16 v[216:219], v[140:143], v[64:67], v[216:219]
  ds_read_b128 v[132:135], v5 offset:9216
  v_mfma_f32_16x16x32_bf16 v[220:223], v[140:143], v[68:71], v[220:223]
  v_exp_f32 v11, v103
  v_mfma_f32_16x16x32_bf16 v[224:227], v[144:147], v[64:67], v[224:227]
  ds_read_b128 v[136:139], v5 offset:10240
  v_cvt_pk_bf16_f32 v77, v10, v11
  v_mfma_f32_16x16x32_bf16 v[228:231], v[144:147], v[68:71], v[228:231]
  v_exp_f32 v8, v104
  v_mfma_f32_16x16x32_bf16 v[232:235], v[148:151], v[64:67], v[232:235]
  ds_read_b128 v[140:143], v5 offset:11264
  v_mfma_f32_16x16x32_bf16 v[236:239], v[148:151], v[68:71], v[236:239]
  v_exp_f32 v9, v105
  v_mfma_f32_16x16x32_bf16 v[240:243], v[152:155], v[64:67], v[240:243]
  ds_read_b128 v[144:147], v5 offset:12288
  v_cvt_pk_bf16_f32 v74, v8, v9
  v_mfma_f32_16x16x32_bf16 v[244:247], v[152:155], v[68:71], v[244:247]
  v_exp_f32 v10, v106
  v_mfma_f32_16x16x32_bf16 v[248:251], v[156:159], v[64:67], v[248:251]
  ds_read_b128 v[148:151], v5 offset:13312
  s_waitcnt lgkmcnt(6)
  v_mfma_f32_16x16x32_bf16 v[252:255], v[156:159], v[68:71], v[252:255]
  v_exp_f32 v11, v107
  v_mfma_f32_16x16x32_bf16 v[80:83], v[160:163], v[32:35], v[16:19]
  ds_read_b128 v[152:155], v5 offset:14336
  v_cvt_pk_bf16_f32 v75, v10, v11
  v_mfma_f32_16x16x32_bf16 v[84:87], v[160:163], v[48:51], v[20:23]
  v_exp_f32 v8, v108
  v_mfma_f32_16x16x32_bf16 v[80:83], v[164:167], v[36:39], v[80:83]
  ds_read_b128 v[156:159], v5 offset:15360
  v_mfma_f32_16x16x32_bf16 v[84:87], v[164:167], v[52:55], v[84:87]
  v_exp_f32 v9, v109
  v_mfma_f32_16x16x32_bf16 v[80:83], v[168:171], v[40:43], v[80:83]
  ds_read_b128 v[160:163], v3 offset:57344
  v_cvt_pk_bf16_f32 v78, v8, v9
  v_mfma_f32_16x16x32_bf16 v[84:87], v[168:171], v[56:59], v[84:87]
  v_exp_f32 v10, v110
  v_mfma_f32_16x16x32_bf16 v[80:83], v[172:175], v[44:47], v[80:83]
  ds_read_b128 v[164:167], v3 offset:58368
  v_mfma_f32_16x16x32_bf16 v[84:87], v[172:175], v[60:63], v[84:87]
  v_exp_f32 v11, v111
  v_mfma_f32_16x16x32_bf16 v[88:91], v[176:179], v[32:35], v[16:19]
  ds_read_b128 v[168:171], v3 offset:59392
  v_cvt_pk_bf16_f32 v79, v10, v11
  v_mfma_f32_16x16x32_bf16 v[112:115], v[12:15], v[72:75], v[24:27]
  s_sub_u32 s45, s45, 1
  s_cselect_b32 s46, -1.0, s46
  v_mfma_f32_16x16x32_bf16 v[116:119], v[12:15], v[76:79], v[28:31]
  ds_read_b128 v[172:175], v3 offset:60416
  s_barrier
  v_mfma_f32_16x16x32_bf16 v[92:95], v[176:179], v[48:51], v[20:23]
  v_exp_f32 v8, v80
  v_mfma_f32_16x16x32_bf16 v[88:91], v[180:183], v[36:39], v[88:91]
  ds_read_b128 v[176:179], v3 offset:61440
  s_waitcnt lgkmcnt(5)
  v_mfma_f32_16x16x32_bf16 v[92:95], v[180:183], v[52:55], v[92:95]
  v_exp_f32 v9, v81
  v_mfma_f32_16x16x32_bf16 v[88:91], v[184:187], v[40:43], v[88:91]
  v_max_f32 v120, v112, v116
  v_cmp_ngt_f32 vcc, s46, v120
  v_mfma_f32_16x16x32_bf16 v[92:95], v[184:187], v[56:59], v[92:95]
  v_exp_f32 v10, v82
  v_mfma_f32_16x16x32_bf16 v[88:91], v[188:191], v[44:47], v[88:91]
  ds_read_b128 v[180:183], v3 offset:62464
  s_cbranch_vccnz kvattn_kernel_stubB0
kvattn_kernel_retB0:
  v_mfma_f32_16x16x32_bf16 v[92:95], v[188:191], v[60:63], v[92:95]
  v_exp_f32 v11, v83
  v_mfma_f32_16x16x32_bf16 v[192:195], v[128:131], v[72:75], v[192:195]
  ds_read_b128 v[184:187], v3 offset:63488
  v_cvt_pk_bf16_f32 v64, v8, v9
  v_mfma_f32_16x16x32_bf16 v[196:199], v[128:131], v[76:79], v[196:199]
  v_exp_f32 v8, v84
  v_mfma_f32_16x16x32_bf16 v[200:203], v[132:135], v[72:75], v[200:203]
  ds_read_b128 v[188:191], v3 offset:64512
  v_cvt_pk_bf16_f32 v65, v10, v11
  v_mfma_f32_16x16x32_bf16 v[204:207], v[132:135], v[76:79], v[204:207]
  v_exp_f32 v9, v85
  v_mfma_f32_16x16x32_bf16 v[208:211], v[136:139], v[72:75], v[208:211]
  ds_read_b128 v[128:131], v5 offset:16384
  v_cvt_pk_bf16_f32 v68, v8, v9
  v_mfma_f32_16x16x32_bf16 v[212:215], v[136:139], v[76:79], v[212:215]
  v_exp_f32 v10, v86
  v_mfma_f32_16x16x32_bf16 v[216:219], v[140:143], v[72:75], v[216:219]
  ds_read_b128 v[132:135], v5 offset:17408
  v_mfma_f32_16x16x32_bf16 v[220:223], v[140:143], v[76:79], v[220:223]
  v_exp_f32 v11, v87
  v_mfma_f32_16x16x32_bf16 v[224:227], v[144:147], v[72:75], v[224:227]
  ds_read_b128 v[136:139], v5 offset:18432
  v_cvt_pk_bf16_f32 v69, v10, v11
  v_mfma_f32_16x16x32_bf16 v[228:231], v[144:147], v[76:79], v[228:231]
  v_exp_f32 v8, v88
  v_mfma_f32_16x16x32_bf16 v[232:235], v[148:151], v[72:75], v[232:235]
  ds_read_b128 v[140:143], v5 offset:19456
  v_mfma_f32_16x16x32_bf16 v[236:239], v[148:151], v[76:79], v[236:239]
  v_exp_f32 v9, v89
  v_mfma_f32_16x16x32_bf16 v[240:243], v[152:155], v[72:75], v[240:243]
  ds_read_b128 v[144:147], v5 offset:20480
  v_cvt_pk_bf16_f32 v66, v8, v9
  v_mfma_f32_16x16x32_bf16 v[244:247], v[152:155], v[76:79], v[244:247]
  v_exp_f32 v10, v90
  v_mfma_f32_16x16x32_bf16 v[248:251], v[156:159], v[72:75], v[248:251]
  ds_read_b128 v[148:151], v5 offset:21504
  s_waitcnt lgkmcnt(6)
  v_mfma_f32_16x16x32_bf16 v[252:255], v[156:159], v[76:79], v[252:255]
  v_exp_f32 v11, v91
  v_mfma_f32_16x16x32_bf16 v[96:99], v[160:163], v[32:35], v[16:19]
  ds_read_b128 v[152:155], v5 offset:22528
  v_cvt_pk_bf16_f32 v67, v10, v11
  v_mfma_f32_16x16x32_bf16 v[100:103], v[160:163], v[48:51], v[20:23]
  v_exp_f32 v8, v92
  v_mfma_f32_16x16x32_bf16 v[96:99], v[164:167], v[36:39], v[96:99]
  ds_read_b128 v[156:159], v5 offset:23552
  v_mfma_f32_16x16x32_bf16 v[100:103], v[164:167], v[52:55], v[100:103]
  v_exp_f32 v9, v93
  v_mfma_f32_16x16x32_bf16 v[96:99], v[168:171], v[40:43], v[96:99]
  ds_read_b128 v[160:163], v3 offset:0
  v_cvt_pk_bf16_f32 v70, v8, v9
  v_mfma_f32_16x16x32_bf16 v[100:103], v[168:171], v[56:59], v[100:103]
  v_exp_f32 v10, v94
  v_mfma_f32_16x16x32_bf16 v[96:99], v[172:175], v[44:47], v[96:99]
  ds_read_b128 v[164:167], v3 offset:1024
  v_mfma_f32_16x16x32_bf16 v[100:103], v[172:175], v[60:63], v[100:103]
  v_exp_f32 v11, v95
  v_mfma_f32_16x16x32_bf16 v[104:107], v[176:179], v[32:35], v[16:19]
  ds_read_b128 v[168:171], v3 offset:2048
  v_cvt_pk_bf16_f32 v71, v10, v11
  v_mfma_f32_16x16x32_bf16 v[24:27], v[12:15], v[64:67], v[112:115]
  s_sub_u32 s45, s45, 1
  s_cselect_b32 s46, -1.0, s46
  v_mfma_f32_16x16x32_bf16 v[28:31], v[12:15], v[68:71], v[116:119]
  ds_read_b128 v[172:175], v3 offset:3072
  v_mfma_f32_16x16x32_bf16 v[108:111], v[176:179], v[48:51], v[20:23]
  v_exp_f32 v8, v96
  v_mfma_f32_16x16x32_bf16 v[104:107], v[180:183], v[36:39], v[104:107]
  ds_read_b128 v[176:179], v3 offset:4096
  s_waitcnt lgkmcnt(5)
  v_mfma_f32_16x16x32_bf16 v[108:111], v[180:183], v[52:55], v[108:111]
  v_exp_f32 v9, v97
  v_mfma_f32_16x16x32_bf16 v[104:107], v[184:187], v[40:43], v[104:107]
  v_max_f32 v120, v24, v28
  v_cmp_ngt_f32 vcc, s46, v120
  v_mfma_f32_16x16x32_bf16 v[108:111], v[184:187], v[56:59], v[108:111]
  v_exp_f32 v10, v98
  v_mfma_f32_16x16x32_bf16 v[104:107], v[188:191], v[44:47], v[104:107]
  ds_read_b128 v[180:183], v3 offset:5120
  s_cbranch_vccnz kvattn_kernel_stubB1
kvattn_kernel_retB1:
  v_mfma_f32_16x16x32_bf16 v[108:111], v[188:191], v[60:63], v[108:111]
  v_exp_f32 v11, v99
  v_mfma_f32_16x16x32_bf16 v[192:195], v[128:131], v[64:67], v[192:195]
  ds_read_b128 v[184:187], v3 offset:6144
  v_cvt_pk_bf16_f32 v72, v8, v9
  v_mfma_f32_16x16x32_bf16 v[196:199], v[128:131], v[68:71], v[196:199]
  v_exp_f32 v8, v100
  v_mfma_f32_16x16x32_bf16 v[200:203], v[132:135], v[64:67], v[200:203]
  ds_read_b128 v[188:191], v3 offset:7168
  v_cvt_pk_bf16_f32 v73, v10, v11
  v_mfma_f32_16x16x32_bf16 v[204:207], v[132:135], v[68:71], v[204:207]
  v_exp_f32 v9, v101
  v_mfma_f32_16x16x32_bf16 v[208:211], v[136:139], v[64:67], v[208:211]
  ds_read_b128 v[128:131], v5 offset:24576
  v_cvt_pk_bf16_f32 v76, v8, v9
  v_mfma_f32_16x16x32_bf16 v[212:215], v[136:139], v[68:71], v[212:215]
  v_exp_f32 v10, v102
  v_mfma_f32_16x16x32_bf16 v[216:219], v[140:143], v[64:67], v[216:219]
  ds_read_b128 v[132:135], v5 offset:25600
  v_mfma_f32_16x16x32_bf16 v[220:223], v[140:143], v[68:71], v[220:223]
  v_exp_f32 v11, v103
  v_mfma_f32_16x16x32_bf16 v[224:227], v[144:147], v[64:67], v[224:227]
  ds_read_b128 v[136:139], v5 offset:26624
  v_cvt_pk_bf16_f32 v77, v10, v11
  v_mfma_f32_16x16x32_bf16 v[228:231], v[144:147], v[68:71], v[228:231]
  v_exp_f32 v8, v104
  v_mfma_f32_16x16x32_bf16 v[232:235], v[148:151], v[64:67], v[232:235]
  ds_read_b128 v[140:143], v5 offset:27648
  v_mfma_f32_16x16x32_bf16 v[236:239], v[148:151], v[68:71], v[236:239]
  v_exp_f32 v9, v105
  v_mfma_f32_16x16x32_bf16 v[240:243], v[152:155], v[64:67], v[240:243]
  ds_read_b128 v[144:147], v5 offset:28672
  v_cvt_pk_bf16_f32 v74, v8, v9
  v_mfma_f32_16x16x32_bf16 v[244:247], v[152:155], v[68:71], v[244:247]
  v_exp_f32 v10, v106
  v_mfma_f32_16x16x32_bf16 v[248:251], v[156:159], v[64:67], v[248:251]
  ds_read_b128 v[148:151], v5 offset:29696
  s_waitcnt lgkmcnt(6)
  v_mfma_f32_16x16x32_bf16 v[252:255], v[156:159], v[68:71], v[252:255]
  v_exp_f32 v11, v107
  v_mfma_f32_16x16x32_bf16 v[80:83], v[160:163], v[32:35], v[16:19]
  ds_read_b128 v[152:155], v5 offset:30720
  v_cvt_pk_bf16_f32 v75, v10, v11
  v_mfma_f32_16x16x32_bf16 v[84:87], v[160:163], v[48:51], v[20:23]
  v_exp_f32 v8, v108
  v_mfma_f32_16x16x32_bf16 v[80:83], v[164:167], v[36:39], v[80:83]
  ds_read_b128 v[156:159], v5 offset:31744
  v_mfma_f32_16x16x32_bf16 v[84:87], v[164:167], v[52:55], v[84:87]
  v_exp_f32 v9, v109
  v_mfma_f32_16x16x32_bf16 v[80:83], v[168:171], v[40:43], v[80:83]
  ds_read_b128 v[160:163], v3 offset:8192
  v_cvt_pk_bf16_f32 v78, v8, v9
  v_mfma_f32_16x16x32_bf16 v[84:87], v[168:171], v[56:59], v[84:87]
  v_exp_f32 v10, v110
  v_mfma_f32_16x16x32_bf16 v[80:83], v[172:175], v[44:47], v[80:83]
  ds_read_b128 v[164:167], v3 offset:9216
  v_mfma_f32_16x16x32_bf16 v[84:87], v[172:175], v[60:63], v[84:87]
  v_exp_f32 v11, v111
  v_mfma_f32_16x16x32_bf16 v[88:91], v[176:179], v[32:35], v[16:19]
  ds_read_b128 v[168:171], v3 offset:10240
  v_cvt_pk_bf16_f32 v79, v10, v11
  v_mfma_f32_16x16x32_bf16 v[112:115], v[12:15], v[72:75], v[24:27]
  s_sub_u32 s45, s45, 1
  s_cselect_b32 s46, -1.0, s46
  v_mfma_f32_16x16x32_bf16 v[116:119], v[12:15], v[76:79], v[28:31]
  ds_read_b128 v[172:175], v3 offset:11264
  s_barrier
  v_mfma_f32_16x16x32_bf16 v[92:95], v[176:179], v[48:51], v[20:23]
  v_exp_f32 v8, v80
  v_mfma_f32_16x16x32_bf16 v[88:91], v[180:183], v[36:39], v[88:91]
  ds_read_b128 v[176:179], v3 offset:12288
  s_waitcnt lgkmcnt(5)
  v_mfma_f32_16x16x32_bf16 v[92:95], v[180:183], v[52:55], v[92:95]
  v_exp_f32 v9, v81
  v_mfma_f32_16x16x32_bf16 v[88:91], v[184:187], v[40:43], v[88:91]
  v_max_f32 v120, v112, v116
  v_cmp_ngt_f32 vcc, s46, v120
  v_mfma_f32_16x16x32_bf16 v[92:95], v[184:187], v[56:59], v[92:95]
  v_exp_f32 v10, v82
  v_mfma_f32_16x16x32_bf16 v[88:91], v[188:191], v[44:47], v[88:91]
  ds_read_b128 v[180:183], v3 offset:13312
  s_cbranch_vccnz kvattn_kernel_stubB2
kvattn_kernel_retB2:
  v_mfma_f32_16x16x32_bf16 v[92:95], v[188:191], v[60:63], v[92:95]
  v_exp_f32 v11, v83
  v_mfma_f32_16x16x32_bf16 v[192:195], v[128:131], v[72:75], v[192:195]
  ds_read_b128 v[184:187], v3 offset:14336
  v_cvt_pk_bf16_f32 v64, v8, v9
  v_mfma_f32_16x16x32_bf16 v[196:199], v[128:131], v[76:79], v[196:199]
  v_exp_f32 v8, v84
  v_mfma_f32_16x16x32_bf16 v[200:203], v[132:135], v[72:75], v[200:203]
  ds_read_b128 v[188:191], v3 offset:15360
  v_cvt_pk_bf16_f32 v65, v10, v11
  v_mfma_f32_16x16x32_bf16 v[204:207], v[132:135], v[76:79], v[204:207]
  v_exp_f32 v9, v85
  v_mfma_f32_16x16x32_bf16 v[208:211], v[136:139], v[72:75], v[208:211]
  ds_read_b128 v[128:131], v5 offset:32768
  v_cvt_pk_bf16_f32 v68, v8, v9
  v_mfma_f32_16x16x32_bf16 v[212:215], v[136:139], v[76:79], v[212:215]
  v_exp_f32 v10, v86
  v_mfma_f32_16x16x32_bf16 v[216:219], v[140:143], v[72:75], v[216:219]
  ds_read_b128 v[132:135], v5 offset:33792
  v_mfma_f32_16x16x32_bf16 v[220:223], v[140:143], v[76:79], v[220:223]
  v_exp_f32 v11, v87
  v_mfma_f32_16x16x32_bf16 v[224:227], v[144:147], v[72:75], v[224:227]
  ds_read_b128 v[136:139], v5 offset:34816
  v_cvt_pk_bf16_f32 v69, v10, v11
  v_mfma_f32_16x16x32_bf16 v[228:231], v[144:147], v[76:79], v[228:231]
  v_exp_f32 v8, v88
  v_mfma_f32_16x16x32_bf16 v[232:235], v[148:151], v[72:75], v[232:235]
  ds_read_b128 v[140:143], v5 offset:35840
  v_mfma_f32_16x16x32_bf16 v[236:239], v[148:151], v[76:79], v[236:239]
  v_exp_f32 v9, v89
  v_mfma_f32_16x16x32_bf16 v[240:243], v[152:155], v[72:75], v[240:243]
  ds_read_b128 v[144:147], v5 offset:36864
  v_cvt_pk_bf16_f32 v66, v8, v9
  v_mfma_f32_16x16x32_bf16 v[244:247], v[152:155], v[76:79], v[244:247]
  v_exp_f32 v10, v90
  v_mfma_f32_16x16x32_bf16 v[248:251], v[156:159], v[72:75], v[248:251]
  ds_read_b128 v[148:151], v5 offset:37888
  s_waitcnt lgkmcnt(6)
  v_mfma_f32_16x16x32_bf16 v[252:255], v[156:159], v[76:79], v[252:255]
  v_exp_f32 v11, v91
  v_mfma_f32_16x16x32_bf16 v[96:99], v[160:163], v[32:35], v[16:19]
  ds_read_b128 v[152:155], v5 offset:38912
  v_cvt_pk_bf16_f32 v67, v10, v11
  v_mfma_f32_16x16x32_bf16 v[100:103], v[160:163], v[48:51], v[20:23]
  v_exp_f32 v8, v92
  v_mfma_f32_16x16x32_bf16 v[96:99], v[164:167], v[36:39], v[96:99]
  ds_read_b128 v[156:159], v5 offset:39936
  v_mfma_f32_16x16x32_bf16 v[100:103], v[164:167], v[52:55], v[100:103]
  v_exp_f32 v9, v93
  v_mfma_f32_16x16x32_bf16 v[96:99], v[168:171], v[40:43], v[96:99]
  ds_read_b128 v[160:163], v3 offset:16384
  v_cvt_pk_bf16_f32 v70, v8, v9
  v_mfma_f32_16x16x32_bf16 v[100:103], v[168:171], v[56:59], v[100:103]
  v_exp_f32 v10, v94
  v_mfma_f32_16x16x32_bf16 v[96:99], v[172:175], v[44:47], v[96:99]
  ds_read_b128 v[164:167], v3 offset:17408
  v_mfma_f32_16x16x32_bf16 v[100:103], v[172:175], v[60:63], v[100:103]
  v_exp_f32 v11, v95
  v_mfma_f32_16x16x32_bf16 v[104:107], v[176:179], v[32:35], v[16:19]
  ds_read_b128 v[168:171], v3 offset:18432
  v_cvt_pk_bf16_f32 v71, v10, v11
  v_mfma_f32_16x16x32_bf16 v[24:27], v[12:15], v[64:67], v[112:115]
  s_sub_u32 s45, s45, 1
  s_cselect_b32 s46, -1.0, s46
  v_mfma_f32_16x16x32_bf16 v[28:31], v[12:15], v[68:71], v[116:119]
  ds_read_b128 v[172:175], v3 offset:19456
  v_mfma_f32_16x16x32_bf16 v[108:111], v[176:179], v[48:51], v[20:23]
  v_exp_f32 v8, v96
  v_mfma_f32_16x16x32_bf16 v[104:107], v[180:183], v[36:39], v[104:107]
  ds_read_b128 v[176:179], v3 offset:20480
  s_waitcnt lgkmcnt(5)
  v_mfma_f32_16x16x32_bf16 v[108:111], v[180:183], v[52:55], v[108:111]
  v_exp_f32 v9, v97
  v_mfma_f32_16x16x32_bf16 v[104:107], v[184:187], v[40:43], v[104:107]
  v_max_f32 v120, v24, v28
  v_cmp_ngt_f32 vcc, s46, v120
  v_mfma_f32_16x16x32_bf16 v[108:111], v[184:187], v[56:59], v[108:111]
  v_exp_f32 v10, v98
  v_mfma_f32_16x16x32_bf16 v[104:107], v[188:191], v[44:47], v[104:107]
  ds_read_b128 v[180:183], v3 offset:21504
  s_cbranch_vccnz kvattn_kernel_stubB3
kvattn_kernel_retB3:
  v_mfma_f32_16x16x32_bf16 v[108:111], v[188:191], v[60:63], v[108:111]
  v_exp_f32 v11, v99
  v_mfma_f32_16x16x32_bf16 v[192:195], v[128:131], v[64:67], v[192:195]
  ds_read_b128 v[184:187], v3 offset:22528
  v_cvt_pk_bf16_f32 v72, v8, v9
  v_mfma_f32_16x16x32_bf16 v[196:199], v[128:131], v[68:71], v[196:199]
  v_exp_f32 v8, v100
  v_mfma_f32_16x16x32_bf16 v[200:203], v[132:135], v[64:67], v[200:203]
  ds_read_b128 v[188:191], v3 offset:23552
  v_cvt_pk_bf16_f32 v73, v10, v11
  v_mfma_f32_16x16x32_bf16 v[204:207], v[132:135], v[68:71], v[204:207]
  v_exp_f32 v9, v101
  v_mfma_f32_16x16x32_bf16 v[208:211], v[136:139], v[64:67], v[208:211]
  ds_read_b128 v[128:131], v5 offset:40960
  v_cvt_pk_bf16_f32 v76, v8, v9
  v_mfma_f32_16x16x32_bf16 v[212:215], v[136:139], v[68:71], v[212:215]
  v_exp_f32 v10, v102
  v_mfma_f32_16x16x32_bf16 v[216:219], v[140:143], v[64:67], v[216:219]
  ds_read_b128 v[132:135], v5 offset:41984
  v_mfma_f32_16x16x32_bf16 v[220:223], v[140:143], v[68:71], v[220:223]
  v_exp_f32 v11, v103
  v_mfma_f32_16x16x32_bf16 v[224:227], v[144:147], v[64:67], v[224:227]
  ds_read_b128 v[136:139], v5 offset:43008
  v_cvt_pk_bf16_f32 v77, v10, v11
  v_mfma_f32_16x16x32_bf16 v[228:231], v[144:147], v[68:71], v[228:231]
  v_exp_f32 v8, v104
  v_mfma_f32_16x16x32_bf16 v[232:235], v[148:151], v[64:67], v[232:235]
  ds_read_b128 v[140:143], v5 offset:44032
  v_mfma_f32_16x16x32_bf16 v[236:239], v[148:151], v[68:71], v[236:239]
  v_exp_f32 v9, v105
  v_mfma_f32_16x16x32_bf16 v[240:243], v[152:155], v[64:67], v[240:243]
  ds_read_b128 v[144:147], v5 offset:45056
  v_cvt_pk_bf16_f32 v74, v8, v9
  v_mfma_f32_16x16x32_bf16 v[244:247], v[152:155], v[68:71], v[244:247]
  v_exp_f32 v10, v106
  v_mfma_f32_16x16x32_bf16 v[248:251], v[156:159], v[64:67], v[248:251]
  ds_read_b128 v[148:151], v5 offset:46080
  s_waitcnt lgkmcnt(6)
  v_mfma_f32_16x16x32_bf16 v[252:255], v[156:159], v[68:71], v[252:255]
  v_exp_f32 v11, v107
  v_mfma_f32_16x16x32_bf16 v[80:83], v[160:163], v[32:35], v[16:19]
  ds_read_b128 v[152:155], v5 offset:47104
  v_cvt_pk_bf16_f32 v75, v10, v11
  v_mfma_f32_16x16x32_bf16 v[84:87], v[160:163], v[48:51], v[20:23]
  v_exp_f32 v8, v108
  v_mfma_f32_16x16x32_bf16 v[80:83], v[164:167], v[36:39], v[80:83]
  ds_read_b128 v[156:159], v5 offset:48128
  v_mfma_f32_16x16x32_bf16 v[84:87], v[164:167], v[52:55], v[84:87]
  v_exp_f32 v9, v109
  v_mfma_f32_16x16x32_bf16 v[80:83], v[168:171], v[40:43], v[80:83]
  ds_read_b128 v[160:163], v3 offset:24576
  v_cvt_pk_bf16_f32 v78, v8, v9
  v_mfma_f32_16x16x32_bf16 v[84:87], v[168:171], v[56:59], v[84:87]
  v_exp_f32 v10, v110
  v_mfma_f32_16x16x32_bf16 v[80:83], v[172:175], v[44:47], v[80:83]
  ds_read_b128 v[164:167], v3 offset:25600
  v_mfma_f32_16x16x32_bf16 v[84:87], v[172:175], v[60:63], v[84:87]
  v_exp_f32 v11, v111
  v_mfma_f32_16x16x32_bf16 v[88:91], v[176:179], v[32:35], v[16:19]
  ds_read_b128 v[168:171], v3 offset:26624
  v_cvt_pk_bf16_f32 v79, v10, v11
  v_mfma_f32_16x16x32_bf16 v[112:115], v[12:15], v[72:75], v[24:27]
  s_sub_u32 s45, s45, 1
  s_cselect_b32 s46, -1.0, s46
  v_mfma_f32_16x16x32_bf16 v[116:119], v[12:15], v[76:79], v[28:31]
  ds_read_b128 v[172:175], v3 offset:27648
  s_barrier
  v_mfma_f32_16x16x32_bf16 v[92:95], v[176:179], v[48:51], v[20:23]
  v_exp_f32 v8, v80
  v_mfma_f32_16x16x32_bf16 v[88:91], v[180:183], v[36:39], v[88:91]
  ds_read_b128 v[176:179], v3 offset:28672
  s_waitcnt lgkmcnt(5)
  v_mfma_f32_16x16x32_bf16 v[92:95], v[180:183], v[52:55], v[92:95]
  v_exp_f32 v9, v81
  v_mfma_f32_16x16x32_bf16 v[88:91], v[184:187], v[40:43], v[88:91]
  v_max_f32 v120, v112, v116
  v_cmp_ngt_f32 vcc, s46, v120
  v_mfma_f32_16x16x32_bf16 v[92:95], v[184:187], v[56:59], v[92:95]
  v_exp_f32 v10, v82
  v_mfma_f32_16x16x32_bf16 v[88:91], v[188:191], v[44:47], v[88:91]
  ds_read_b128 v[180:183], v3 offset:29696
  s_cbranch_vccnz kvattn_kernel_stubB4
kvattn_kernel_retB4:
  v_mfma_f32_16x16x32_bf16 v[92:95], v[188:191], v[60:63], v[92:95]
  v_exp_f32 v11, v83
  v_mfma_f32_16x16x32_bf16 v[192:195], v[128:131], v[72:75], v[192:195]
  ds_read_b128 v[184:187], v3 offset:30720
  v_cvt_pk_bf16_f32 v64, v8, v9
  v_mfma_f32_16x16x32_bf16 v[196:199], v[128:131], v[76:79], v[196:199]
  v_exp_f32 v8, v84
  v_mfma_f32_16x16x32_bf16 v[200:203], v[132:135], v[72:75], v[200:203]
  ds_read_b128 v[188:191], v3 offset:31744
  v_cvt_pk_bf16_f32 v65, v10, v11
  v_mfma_f32_16x16x32_bf16 v[204:207], v[132:135], v[76:79], v[204:207]
  v_exp_f32 v9, v85
  v_mfma_f32_16x16x32_bf16 v[208:211], v[136:139], v[72:75], v[208:211]
  ds_read_b128 v[128:131], v5 offset:49152
  v_cvt_pk_bf16_f32 v68, v8, v9
  v_mfma_f32_16x16x32_bf16 v[212:215], v[136:139], v[76:79], v[212:215]
  v_exp_f32 v10, v86
  v_mfma_f32_16x16x32_bf16 v[216:219], v[140:143], v[72:75], v[216:219]
  ds_read_b128 v[132:135], v5 offset:50176
  v_mfma_f32_16x16x32_bf16 v[220:223], v[140:143], v[76:79], v[220:223]
  v_exp_f32 v11, v87
  v_mfma_f32_16x16x32_bf16 v[224:227], v[144:147], v[72:75], v[224:227]
  ds_read_b128 v[136:139], v5 offset:51200
  v_cvt_pk_bf16_f32 v69, v10, v11
  v_mfma_f32_16x16x32_bf16 v[228:231], v[144:147], v[76:79], v[228:231]
  v_exp_f32 v8, v88
  v_mfma_f32_16x16x32_bf16 v[232:235], v[148:151], v[72:75], v[232:235]
  ds_read_b128 v[140:143], v5 offset:52224
  v_mfma_f32_16x16x32_bf16 v[236:239], v[148:151], v[76:79], v[236:239]
  v_exp_f32 v9, v89
  v_mfma_f32_16x16x32_bf16 v[240:243], v[152:155], v[72:75], v[240:243]
  ds_read_b128 v[144:147], v5 offset:53248
  v_cvt_pk_bf16_f32 v66, v8, v9
  v_mfma_f32_16x16x32_bf16 v[244:247], v[152:155], v[76:79], v[244:247]
  v_exp_f32 v10, v90
  v_mfma_f32_16x16x32_bf16 v[248:251], v[156:159], v[72:75], v[248:251]
  ds_read_b128 v[148:151], v5 offset:54272
  s_waitcnt lgkmcnt(6)
  v_mfma_f32_16x16x32_bf16 v[252:255], v[156:159], v[76:79], v[252:255]
  v_exp_f32 v11, v91
  v_mfma_f32_16x16x32_bf16 v[96:99], v[160:163], v[32:35], v[16:19]
  ds_read_b128 v[152:155], v5 offset:55296
  v_cvt_pk_bf16_f32 v67, v10, v11
  v_mfma_f32_16x16x32_bf16 v[100:103], v[160:163], v[48:51], v[20:23]
  v_exp_f32 v8, v92
  v_mfma_f32_16x16x32_bf16 v[96:99], v[164:167], v[36:39], v[96:99]
  ds_read_b128 v[156:159], v5 offset:56320
  v_mfma_f32_16x16x32_bf16 v[100:103], v[164:167], v[52:55], v[100:103]
  v_exp_f32 v9, v93
  v_mfma_f32_16x16x32_bf16 v[96:99], v[168:171], v[40:43], v[96:99]
  ds_read_b128 v[160:163], v3 offset:32768
  v_cvt_pk_bf16_f32 v70, v8, v9
  v_mfma_f32_16x16x32_bf16 v[100:103], v[168:171], v[56:59], v[100:103]
  v_exp_f32 v10, v94
  v_mfma_f32_16x16x32_bf16 v[96:99], v[172:175], v[44:47], v[96:99]
  ds_read_b128 v[164:167], v3 offset:33792
  v_mfma_f32_16x16x32_bf16 v[100:103], v[172:175], v[60:63], v[100:103]
  v_exp_f32 v11, v95
  v_mfma_f32_16x16x32_bf16 v[104:107], v[176:179], v[32:35], v[16:19]
  ds_read_b128 v[168:171], v3 offset:34816
  v_cvt_pk_bf16_f32 v71, v10, v11
  v_mfma_f32_16x16x32_bf16 v[24:27], v[12:15], v[64:67], v[112:115]
  s_sub_u32 s45, s45, 1
  s_cselect_b32 s46, -1.0, s46
  v_mfma_f32_16x16x32_bf16 v[28:31], v[12:15], v[68:71], v[116:119]
  ds_read_b128 v[172:175], v3 offset:35840
  v_mfma_f32_16x16x32_bf16 v[108:111], v[176:179], v[48:51], v[20:23]
  v_exp_f32 v8, v96
  v_mfma_f32_16x16x32_bf16 v[104:107], v[180:183], v[36:39], v[104:107]
  ds_read_b128 v[176:179], v3 offset:36864
  s_waitcnt lgkmcnt(5)
  v_mfma_f32_16x16x32_bf16 v[108:111], v[180:183], v[52:55], v[108:111]
  v_exp_f32 v9, v97
  v_mfma_f32_16x16x32_bf16 v[104:107], v[184:187], v[40:43], v[104:107]
  v_max_f32 v120, v24, v28
  v_cmp_ngt_f32 vcc, s46, v120
  v_mfma_f32_16x16x32_bf16 v[108:111], v[184:187], v[56:59], v[108:111]
  v_exp_f32 v10, v98
  v_mfma_f32_16x16x32_bf16 v[104:107], v[188:191], v[44:47], v[104:107]
  ds_read_b128 v[180:183], v3 offset:37888
  s_cbranch_vccnz kvattn_kernel_stubB5
kvattn_kernel_retB5:
  v_mfma_f32_16x16x32_bf16 v[108:111], v[188:191], v[60:63], v[108:111]
  v_exp_f32 v11, v99
  v_mfma_f32_16x16x32_bf16 v[192:195], v[128:131], v[64:67], v[192:195]
  ds_read_b128 v[184:187], v3 offset:38912
  v_cvt_pk_bf16_f32 v72, v8, v9
  v_mfma_f32_16x16x32_bf16 v[196:199], v[128:131], v[68:71], v[196:199]
  v_exp_f32 v8, v100
  v_mfma_f32_16x16x32_bf16 v[200:203], v[132:135], v[64:67], v[200:203]
  ds_read_b128 v[188:191], v3 offset:39936
  v_cvt_pk_bf16_f32 v73, v10, v11
  v_mfma_f32_16x16x32_bf16 v[204:207], v[132:135], v[68:71], v[204:207]
  v_exp_f32 v9, v101
  v_mfma_f32_16x16x32_bf16 v[208:211], v[136:139], v[64:67], v[208:211]
  ds_read_b128 v[128:131], v5 offset:57344
  v_cvt_pk_bf16_f32 v76, v8, v9
  v_mfma_f32_16x16x32_bf16 v[212:215], v[136:139], v[68:71], v[212:215]
  v_exp_f32 v10, v102
  v_mfma_f32_16x16x32_bf16 v[216:219], v[140:143], v[64:67], v[216:219]
  ds_read_b128 v[132:135], v5 offset:58368
  v_mfma_f32_16x16x32_bf16 v[220:223], v[140:143], v[68:71], v[220:223]
  v_exp_f32 v11, v103
  v_mfma_f32_16x16x32_bf16 v[224:227], v[144:147], v[64:67], v[224:227]
  ds_read_b128 v[136:139], v5 offset:59392
  v_cvt_pk_bf16_f32 v77, v10, v11
  v_mfma_f32_16x16x32_bf16 v[228:231], v[144:147], v[68:71], v[228:231]
  v_exp_f32 v8, v104
  v_mfma_f32_16x16x32_bf16 v[232:235], v[148:151], v[64:67], v[232:235]
  ds_read_b128 v[140:143], v5 offset:60416
  v_mfma_f32_16x16x32_bf16 v[236:239], v[148:151], v[68:71], v[236:239]
  v_exp_f32 v9, v105
  v_mfma_f32_16x16x32_bf16 v[240:243], v[152:155], v[64:67], v[240:243]
  ds_read_b128 v[144:147], v5 offset:61440
  v_cvt_pk_bf16_f32 v74, v8, v9
  v_mfma_f32_16x16x32_bf16 v[244:247], v[152:155], v[68:71], v[244:247]
  v_exp_f32 v10, v106
  v_mfma_f32_16x16x32_bf16 v[248:251], v[156:159], v[64:67], v[248:251]
  ds_read_b128 v[148:151], v5 offset:62464
  s_waitcnt lgkmcnt(6)
  v_mfma_f32_16x16x32_bf16 v[252:255], v[156:159], v[68:71], v[252:255]
  v_exp_f32 v11, v107
  v_mfma_f32_16x16x32_bf16 v[80:83], v[160:163], v[32:35], v[16:19]
  ds_read_b128 v[152:155], v5 offset:63488
  v_cvt_pk_bf16_f32 v75, v10, v11
  v_mfma_f32_16x16x32_bf16 v[84:87], v[160:163], v[48:51], v[20:23]
  v_exp_f32 v8, v108
  v_mfma_f32_16x16x32_bf16 v[80:83], v[164:167], v[36:39], v[80:83]
  ds_read_b128 v[156:159], v5 offset:64512
  v_mfma_f32_16x16x32_bf16 v[84:87], v[164:167], v[52:55], v[84:87]
  v_exp_f32 v9, v109
  v_mfma_f32_16x16x32_bf16 v[80:83], v[168:171], v[40:43], v[80:83]
  ds_read_b128 v[160:163], v3 offset:40960
  v_cvt_pk_bf16_f32 v78, v8, v9
  v_mfma_f32_16x16x32_bf16 v[84:87], v[168:171], v[56:59], v[84:87]
  v_exp_f32 v10, v110
  v_mfma_f32_16x16x32_bf16 v[80:83], v[172:175], v[44:47], v[80:83]
  ds_read_b128 v[164:167], v3 offset:41984
  v_mfma_f32_16x16x32_bf16 v[84:87], v[172:175], v[60:63], v[84:87]
  v_exp_f32 v11, v111
  v_mfma_f32_16x16x32_bf16 v[88:91], v[176:179], v[32:35], v[16:19]
  ds_read_b128 v[168:171], v3 offset:43008
  v_cvt_pk_bf16_f32 v79, v10, v11
  v_mfma_f32_16x16x32_bf16 v[112:115], v[12:15], v[72:75], v[24:27]
  s_sub_u32 s45, s45, 1
  s_cselect_b32 s46, -1.0, s46
  v_mfma_f32_16x16x32_bf16 v[116:119], v[12:15], v[76:79], v[28:31]
  ds_read_b128 v[172:175], v3 offset:44032
  s_barrier
  v_mfma_f32_16x16x32_bf16 v[92:95], v[176:179], v[48:51], v[20:23]
  v_exp_f32 v8, v80
  v_mfma_f32_16x16x32_bf16 v[88:91], v[180:183], v[36:39], v[88:91]
  ds_read_b128 v[176:179], v3 offset:45056
  s_waitcnt lgkmcnt(5)
  v_mfma_f32_16x16x32_bf16 v[92:95], v[180:183], v[52:55], v[92:95]
  v_exp_f32 v9, v81
  v_mfma_f32_16x16x32_bf16 v[88:91], v[184:187], v[40:43], v[88:91]
  v_max_f32 v120, v112, v116
  v_cmp_ngt_f32 vcc, s46, v120
  v_mfma_f32_16x16x32_bf16 v[92:95], v[184:187], v[56:59], v[92:95]
  v_exp_f32 v10, v82
  v_mfma_f32_16x16x32_bf16 v[88:91], v[188:191], v[44:47], v[88:91]
  ds_read_b128 v[180:183], v3 offset:46080
  s_cbranch_vccnz kvattn_kernel_stubB6
kvattn_kernel_retB6:
  v_mfma_f32_16x16x32_bf16 v[92:95], v[188:191], v[60:63], v[92:95]
  v_exp_f32 v11, v83
  v_mfma_f32_16x16x32_bf16 v[192:195], v[128:131], v[72:75], v[192:195]
  ds_read_b128 v[184:187], v3 offset:47104
  v_cvt_pk_bf16_f32 v64, v8, v9
  v_mfma_f32_16x16x32_bf16 v[196:199], v[128:131], v[76:79], v[196:199]
  v_exp_f32 v8, v84
  v_mfma_f32_16x16x32_bf16 v[200:203], v[132:135], v[72:75], v[200:203]
  ds_read_b128 v[188:191], v3 offset:48128
  v_cvt_pk_bf16_f32 v65, v10, v11
  v_mfma_f32_16x16x32_bf16 v[204:207], v[132:135], v[76:79], v[204:207]
  v_exp_f32 v9, v85
  v_mfma_f32_16x16x32_bf16 v[208:211], v[136:139], v[72:75], v[208:211]
  ds_read_b128 v[128:131], v5 offset:0
  v_cvt_pk_bf16_f32 v68, v8, v9
  v_mfma_f32_16x16x32_bf16 v[212:215], v[136:139], v[76:79], v[212:215]
  v_exp_f32 v10, v86
  v_mfma_f32_16x16x32_bf16 v[216:219], v[140:143], v[72:75], v[216:219]
  ds_read_b128 v[132:135], v5 offset:1024
  v_mfma_f32_16x16x32_bf16 v[220:223], v[140:143], v[76:79], v[220:223]
  v_exp_f32 v11, v87
  v_mfma_f32_16x16x32_bf16 v[224:227], v[144:147], v[72:75], v[224:227]
  ds_read_b128 v[136:139], v5 offset:2048
  v_cvt_pk_bf16_f32 v69, v10, v11
  v_mfma_f32_16x16x32_bf16 v[228:231], v[144:147], v[76:79], v[228:231]
  v_exp_f32 v8, v88
  v_mfma_f32_16x16x32_bf16 v[232:235], v[148:151], v[72:75], v[232:235]
  ds_read_b128 v[140:143], v5 offset:3072
  v_mfma_f32_16x16x32_bf16 v[236:239], v[148:151], v[76:79], v[236:239]
  v_exp_f32 v9, v89
  v_mfma_f32_16x16x32_bf16 v[240:243], v[152:155], v[72:75], v[240:243]
  ds_read_b128 v[144:147], v5 offset:4096
  v_cvt_pk_bf16_f32 v66, v8, v9
  v_mfma_f32_16x16x32_bf16 v[244:247], v[152:155], v[76:79], v[244:247]
  v_exp_f32 v10, v90
  v_mfma_f32_16x16x32_bf16 v[248:251], v[156:159], v[72:75], v[248:251]
  ds_read_b128 v[148:151], v5 offset:5120
  s_waitcnt lgkmcnt(6)
  v_mfma_f32_16x16x32_bf16 v[252:255], v[156:159], v[76:79], v[252:255]
  v_exp_f32 v11, v91
  v_mfma_f32_16x16x32_bf16 v[96:99], v[160:163], v[32:35], v[16:19]
  ds_read_b128 v[152:155], v5 offset:6144
  v_cvt_pk_bf16_f32 v67, v10, v11
  v_mfma_f32_16x16x32_bf16 v[100:103], v[160:163], v[48:51], v[20:23]
  v_exp_f32 v8, v92
  v_mfma_f32_16x16x32_bf16 v[96:99], v[164:167], v[36:39], v[96:99]
  ds_read_b128 v[156:159], v5 offset:7168
  v_mfma_f32_16x16x32_bf16 v[100:103], v[164:167], v[52:55], v[100:103]
  v_exp_f32 v9, v93
  v_mfma_f32_16x16x32_bf16 v[96:99], v[168:171], v[40:43], v[96:99]
  ds_read_b128 v[160:163], v3 offset:49152
  v_cvt_pk_bf16_f32 v70, v8, v9
  v_mfma_f32_16x16x32_bf16 v[100:103], v[168:171], v[56:59], v[100:103]
  v_exp_f32 v10, v94
  v_mfma_f32_16x16x32_bf16 v[96:99], v[172:175], v[44:47], v[96:99]
  ds_read_b128 v[164:167], v3 offset:50176
  v_mfma_f32_16x16x32_bf16 v[100:103], v[172:175], v[60:63], v[100:103]
  v_exp_f32 v11, v95
  v_mfma_f32_16x16x32_bf16 v[104:107], v[176:179], v[32:35], v[16:19]
  ds_read_b128 v[168:171], v3 offset:51200
  v_cvt_pk_bf16_f32 v71, v10, v11
  v_mfma_f32_16x16x32_bf16 v[24:27], v[12:15], v[64:67], v[112:115]
  s_sub_u32 s45, s45, 1
  s_cselect_b32 s46, -1.0, s46
  v_mfma_f32_16x16x32_bf16 v[28:31], v[12:15], v[68:71], v[116:119]
  ds_read_b128 v[172:175], v3 offset:52224
  v_mfma_f32_16x16x32_bf16 v[108:111], v[176:179], v[48:51], v[20:23]
  v_exp_f32 v8, v96
  v_mfma_f32_16x16x32_bf16 v[104:107], v[180:183], v[36:39], v[104:107]
  ds_read_b128 v[176:179], v3 offset:53248
  s_waitcnt lgkmcnt(5)
  v_mfma_f32_16x16x32_bf16 v[108:111], v[180:183], v[52:55], v[108:111]
  v_exp_f32 v9, v97
  v_mfma_f32_16x16x32_bf16 v[104:107], v[184:187], v[40:43], v[104:107]
  v_max_f32 v120, v24, v28
  v_cmp_ngt_f32 vcc, s46, v120
  v_mfma_f32_16x16x32_bf16 v[108:111], v[184:187], v[56:59], v[108:111]
  v_exp_f32 v10, v98
  v_mfma_f32_16x16x32_bf16 v[104:107], v[188:191], v[44:47], v[104:107]
  ds_read_b128 v[180:183], v3 offset:54272
  s_cbranch_vccnz kvattn_kernel_stubB7
kvattn_kernel_retB7:
  v_mfma_f32_16x16x32_bf16 v[108:111], v[188:191], v[60:63], v[108:111]
  v_exp_f32 v11, v99
  s_branch kvattn_kernel_loopB
kvattn_kernel_loopA:
  v_mfma_f32_16x16x32_bf16 v[192:195], v[128:131], v[64:67], v[192:195]
  ds_read_b128 v[184:187], v3 offset:55296
  v_cvt_pk_bf16_f32 v72, v8, v9
  v_mfma_f32_16x16x32_bf16 v[196:199], v[128:131], v[68:71], v[196:199]
  v_exp_f32 v8, v100
  v_mfma_f32_16x16x32_bf16 v[200:203], v[132:135], v[64:67], v[200:203]
  ds_read_b128 v[188:191], v3 offset:56320
  v_cvt_pk_bf16_f32 v73, v10, v11
  v_mfma_f32_16x16x32_bf16 v[204:207], v[132:135], v[68:71], v[204:207]
  v_exp_f32 v9, v101
  v_mfma_f32_16x16x32_bf16 v[208:211], v[136:139], v[64:67], v[208:211]
  s_add_u32 m0, s44, 32768
  ds_read_b128 v[128:131], v5 offset:8192
  v_cvt_pk_bf16_f32 v76, v8, v9
  v_mfma_f32_16x16x32_bf16 v[212:215], v[136:139], v[68:71], v[212:215]
  v_exp_f32 v10, v102
  v_mfma_f32_16x16x32_bf16 v[216:219], v[140:143], v[64:67], v[216:219]
  ds_read_b128 v[132:135], v5 offset:9216
  buffer_load_dwordx4 v1, s[36:39], s41 offen offset:0 sc1 lds
  v_mfma_f32_16x16x32_bf16 v[220:223], v[140:143], v[68:71], v[220:223]
  v_exp_f32 v11, v103
  v_mfma_f32_16x16x32_bf16 v[224:227], v[144:147], v[64:67], v[224:227]
  ds_read_b128 v[136:139], v5 offset:10240
  v_cvt_pk_bf16_f32 v77, v10, v11
  v_mfma_f32_16x16x32_bf16 v[228:231], v[144:147], v[68:71], v[228:231]
  v_exp_f32 v8, v104
  v_mfma_f32_16x16x32_bf16 v[232:235], v[148:151], v[64:67], v[232:235]
  ds_read_b128 v[140:143], v5 offset:11264
  buffer_load_dwordx4 v1, s[36:39], s41 offen offset:1024 sc1 lds
  v_mfma_f32_16x16x32_bf16 v[236:239], v[148:151], v[68:71], v[236:239]
  v_exp_f32 v9, v105
  v_mfma_f32_16x16x32_bf16 v[240:243], v[152:155], v[64:67], v[240:243]
  ds_read_b128 v[144:147], v5 offset:12288
  v_cvt_pk_bf16_f32 v74, v8, v9
  v_mfma_f32_16x16x32_bf16 v[244:247], v[152:155], v[68:71], v[244:247]
  v_exp_f32 v10, v106
  v_mfma_f32_16x16x32_bf16 v[248:251], v[156:159], v[64:67], v[248:251]
  ds_read_b128 v[148:151], v5 offset:13312
  s_waitcnt lgkmcnt(6)
  v_mfma_f32_16x16x32_bf16 v[252:255], v[156:159], v[68:71], v[252:255]
  v_exp_f32 v11, v107
  v_mfma_f32_16x16x32_bf16 v[80:83], v[160:163], v[32:35], v[16:19]
  ds_read_b128 v[152:155], v5 offset:14336
  v_cvt_pk_bf16_f32 v75, v10, v11
  v_mfma_f32_16x16x32_bf16 v[84:87], v[160:163], v[48:51], v[20:23]
  v_exp_f32 v8, v108
  v_mfma_f32_16x16x32_bf16 v[80:83], v[164:167], v[36:39], v[80:83]
  ds_read_b128 v[156:159], v5 offset:15360
  buffer_load_dwordx4 v1, s[36:39], s41 offen offset:2048 sc1 lds
  v_mfma_f32_16x16x32_bf16 v[84:87], v[164:167], v[52:55], v[84:87]
  v_exp_f32 v9, v109
  v_mfma_f32_16x16x32_bf16 v[80:83], v[168:171], v[40:43], v[80:83]
  ds_read_b128 v[160:163], v3 offset:57344
  v_cvt_pk_bf16_f32 v78, v8, v9
  v_mfma_f32_16x16x32_bf16 v[84:87], v[168:171], v[56:59], v[84:87]
  v_exp_f32 v10, v110
  v_mfma_f32_16x16x32_bf16 v[80:83], v[172:175], v[44:47], v[80:83]
  ds_read_b128 v[164:167], v3 offset:58368
  buffer_load_dwordx4 v1, s[36:39], s41 offen offset:3072 sc1 lds
  v_mfma_f32_16x16x32_bf16 v[84:87], v[172:175], v[60:63], v[84:87]
  v_exp_f32 v11, v111
  v_mfma_f32_16x16x32_bf16 v[88:91], v[176:179], v[32:35], v[16:19]
  s_add_u32 s41, s41, 0x4000
  ds_read_b128 v[168:171], v3 offset:59392
  v_cvt_pk_bf16_f32 v79, v10, v11
  v_mfma_f32_16x16x32_bf16 v[112:115], v[12:15], v[72:75], v[24:27]
  s_sub_u32 s45, s45, 1
  s_cselect_b32 s46, -1.0, s46
  v_mfma_f32_16x16x32_bf16 v[116:119], v[12:15], v[76:79], v[28:31]
  ds_read_b128 v[172:175], v3 offset:60416
  s_waitcnt vmcnt(4)
  s_barrier
  v_mfma_f32_16x16x32_bf16 v[92:95], v[176:179], v[48:51], v[20:23]
  v_exp_f32 v8, v80
  v_mfma_f32_16x16x32_bf16 v[88:91], v[180:183], v[36:39], v[88:91]
  ds_read_b128 v[176:179], v3 offset:61440
  s_waitcnt lgkmcnt(5)
  v_mfma_f32_16x16x32_bf16 v[92:95], v[180:183], v[52:55], v[92:95]
  v_exp_f32 v9, v81
  v_mfma_f32_16x16x32_bf16 v[88:91], v[184:187], v[40:43], v[88:91]
  v_max_f32 v120, v112, v116
  v_cmp_ngt_f32 vcc, s46, v120
  v_mfma_f32_16x16x32_bf16 v[92:95], v[184:187], v[56:59], v[92:95]
  v_exp_f32 v10, v82
  v_mfma_f32_16x16x32_bf16 v[88:91], v[188:191], v[44:47], v[88:91]
  ds_read_b128 v[180:183], v3 offset:62464
  s_cbranch_vccnz kvattn_kernel_stubA0
kvattn_kernel_retA0:
  v_mfma_f32_16x16x32_bf16 v[92:95], v[188:191], v[60:63], v[92:95]
  v_exp_f32 v11, v83
  v_mfma_f32_16x16x32_bf16 v[192:195], v[128:131], v[72:75], v[192:195]
  ds_read_b128 v[184:187], v3 offset:63488
  v_cvt_pk_bf16_f32 v64, v8, v9
  v_mfma_f32_16x16x32_bf16 v[196:199], v[128:131], v[76:79], v[196:199]
  v_exp_f32 v8, v84
  v_mfma_f32_16x16x32_bf16 v[200:203], v[132:135], v[72:75], v[200:203]
  ds_read_b128 v[188:191], v3 offset:64512
  v_cvt_pk_bf16_f32 v65, v10, v11
  v_mfma_f32_16x16x32_bf16 v[204:207], v[132:135], v[76:79], v[204:207]
  v_exp_f32 v9, v85
  v_mfma_f32_16x16x32_bf16 v[208:211], v[136:139], v[72:75], v[208:211]
  s_add_u32 m0, s43, 16384
  ds_read_b128 v[128:131], v5 offset:16384
  v_cvt_pk_bf16_f32 v68, v8, v9
  v_mfma_f32_16x16x32_bf16 v[212:215], v[136:139], v[76:79], v[212:215]
  v_exp_f32 v10, v86
  v_mfma_f32_16x16x32_bf16 v[216:219], v[140:143], v[72:75], v[216:219]
  ds_read_b128 v[132:135], v5 offset:17408
  buffer_load_dwordx4 v1, s[32:35], s40 offen offset:0 sc1 lds
  v_mfma_f32_16x16x32_bf16 v[220:223], v[140:143], v[76:79], v[220:223]
  v_exp_f32 v11, v87
  v_mfma_f32_16x16x32_bf16 v[224:227], v[144:147], v[72:75], v[224:227]
  ds_read_b128 v[136:139], v5 offset:18432
  v_cvt_pk_bf16_f32 v69, v10, v11
  v_mfma_f32_16x16x32_bf16 v[228:231], v[144:147], v[76:79], v[228:231]
  v_exp_f32 v8, v88
  v_mfma_f32_16x16x32_bf16 v[232:235], v[148:151], v[72:75], v[232:235]
  ds_read_b128 v[140:143], v5 offset:19456
  buffer_load_dwordx4 v1, s[32:35], s40 offen offset:1024 sc1 lds
  v_mfma_f32_16x16x32_bf16 v[236:239], v[148:151], v[76:79], v[236:239]
  v_exp_f32 v9, v89
  v_mfma_f32_16x16x32_bf16 v[240:243], v[152:155], v[72:75], v[240:243]
  ds_read_b128 v[144:147], v5 offset:20480
  v_cvt_pk_bf16_f32 v66, v8, v9
  v_mfma_f32_16x16x32_bf16 v[244:247], v[152:155], v[76:79], v[244:247]
  v_exp_f32 v10, v90
  v_mfma_f32_16x16x32_bf16 v[248:251], v[156:159], v[72:75], v[248:251]
  ds_read_b128 v[148:151], v5 offset:21504
  s_waitcnt lgkmcnt(6)
  v_mfma_f32_16x16x32_bf16 v[252:255], v[156:159], v[76:79], v[252:255]
  v_exp_f32 v11, v91
  v_mfma_f32_16x16x32_bf16 v[96:99], v[160:163], v[32:35], v[16:19]
  ds_read_b128 v[152:155], v5 offset:22528
  v_cvt_pk_bf16_f32 v67, v10, v11
  v_mfma_f32_16x16x32_bf16 v[100:103], v[160:163], v[48:51], v[20:23]
  v_exp_f32 v8, v92
  v_mfma_f32_16x16x32_bf16 v[96:99], v[164:167], v[36:39], v[96:99]
  ds_read_b128 v[156:159], v5 offset:23552
  buffer_load_dwordx4 v1, s[32:35], s40 offen offset:2048 sc1 lds
  v_mfma_f32_16x16x32_bf16 v[100:103], v[164:167], v[52:55], v[100:103]
  v_exp_f32 v9, v93
  v_mfma_f32_16x16x32_bf16 v[96:99], v[168:171], v[40:43], v[96:99]
  ds_read_b128 v[160:163], v3 offset:0
  v_cvt_pk_bf16_f32 v70, v8, v9
  v_mfma_f32_16x16x32_bf16 v[100:103], v[168:171], v[56:59], v[100:103]
  v_exp_f32 v10, v94
  v_mfma_f32_16x16x32_bf16 v[96:99], v[172:175], v[44:47], v[96:99]
  ds_read_b128 v[164:167], v3 offset:1024
  buffer_load_dwordx4 v1, s[32:35], s40 offen offset:3072 sc1 lds
  v_mfma_f32_16x16x32_bf16 v[100:103], v[172:175], v[60:63], v[100:103]
  v_exp_f32 v11, v95
  v_mfma_f32_16x16x32_bf16 v[104:107], v[176:179], v[32:35], v[16:19]
  s_add_u32 s40, s40, 0x4000
  ds_read_b128 v[168:171], v3 offset:2048
  v_cvt_pk_bf16_f32 v71, v10, v11
  v_mfma_f32_16x16x32_bf16 v[24:27], v[12:15], v[64:67], v[112:115]
  s_sub_u32 s45, s45, 1
  s_cselect_b32 s46, -1.0, s46
  v_mfma_f32_16x16x32_bf16 v[28:31], v[12:15], v[68:71], v[116:119]
  ds_read_b128 v[172:175], v3 offset:3072
  v_mfma_f32_16x16x32_bf16 v[108:111], v[176:179], v[48:51], v[20:23]
  v_exp_f32 v8, v96
  v_mfma_f32_16x16x32_bf16 v[104:107], v[180:183], v[36:39], v[104:107]
  ds_read_b128 v[176:179], v3 offset:4096
  s_waitcnt lgkmcnt(5)
  v_mfma_f32_16x16x32_bf16 v[108:111], v[180:183], v[52:55], v[108:111]
  v_exp_f32 v9, v97
  v_mfma_f32_16x16x32_bf16 v[104:107], v[184:187], v[40:43], v[104:107]
  v_max_f32 v120, v24, v28
  v_cmp_ngt_f32 vcc, s46, v120
  v_mfma_f32_16x16x32_bf16 v[108:111], v[184:187], v[56:59], v[108:111]
  v_exp_f32 v10, v98
  v_mfma_f32_16x16x32_bf16 v[104:107], v[188:191], v[44:47], v[104:107]
  ds_read_b128 v[180:183], v3 offset:5120
  s_cbranch_vccnz kvattn_kernel_stubA1
kvattn_kernel_retA1:
  v_mfma_f32_16x16x32_bf16 v[108:111], v[188:191], v[60:63], v[108:111]
  v_exp_f32 v11, v99
  v_mfma_f32_16x16x32_bf16 v[192:195], v[128:131], v[64:67], v[192:195]
  ds_read_b128 v[184:187], v3 offset:6144
  v_cvt_pk_bf16_f32 v72, v8, v9
  v_mfma_f32_16x16x32_bf16 v[196:199], v[128:131], v[68:71], v[196:199]
  v_exp_f32 v8, v100
  v_mfma_f32_16x16x32_bf16 v[200:203], v[132:135], v[64:67], v[200:203]
  ds_read_b128 v[188:191], v3 offset:7168
  v_cvt_pk_bf16_f32 v73, v10, v11
  v_mfma_f32_16x16x32_bf16 v[204:207], v[132:135], v[68:71], v[204:207]
  v_exp_f32 v9, v101
  v_mfma_f32_16x16x32_bf16 v[208:211], v[136:139], v[64:67], v[208:211]
  s_add_u32 m0, s44, 49152
  ds_read_b128 v[128:131], v5 offset:24576
  v_cvt_pk_bf16_f32 v76, v8, v9
  v_mfma_f32_16x16x32_bf16 v[212:215], v[136:139], v[68:71], v[212:215]
  v_exp_f32 v10, v102
  v_mfma_f32_16x16x32_bf16 v[216:219], v[140:143], v[64:67], v[216:219]
  ds_read_b128 v[132:135], v5 offset:25600
  buffer_load_dwordx4 v1, s[36:39], s41 offen offset:0 sc1 lds
  v_mfma_f32_16x16x32_bf16 v[220:223], v[140:143], v[68:71], v[220:223]
  v_exp_f32 v11, v103
  v_mfma_f32_16x16x32_bf16 v[224:227], v[144:147], v[64:67], v[224:227]
  ds_read_b128 v[136:139], v5 offset:26624
  v_cvt_pk_bf16_f32 v77, v10, v11
  v_mfma_f32_16x16x32_bf16 v[228:231], v[144:147], v[68:71], v[228:231]
  v_exp_f32 v8, v104
  v_mfma_f32_16x16x32_bf16 v[232:235], v[148:151], v[64:67], v[232:235]
  ds_read_b128 v[140:143], v5 offset:27648
  buffer_load_dwordx4 v1, s[36:39], s41 offen offset:1024 sc1 lds
  v_mfma_f32_16x16x32_bf16 v[236:239], v[148:151], v[68:71], v[236:239]
  v_exp_f32 v9, v105
  v_mfma_f32_16x16x32_bf16 v[240:243], v[152:155], v[64:67], v[240:243]
  ds_read_b128 v[144:147], v5 offset:28672
  v_cvt_pk_bf16_f32 v74, v8, v9
  v_mfma_f32_16x16x32_bf16 v[244:247], v[152:155], v[68:71], v[244:247]
  v_exp_f32 v10, v106
  v_mfma_f32_16x16x32_bf16 v[248:251], v[156:159], v[64:67], v[248:251]
  ds_read_b128 v[148:151], v5 offset:29696
  s_waitcnt lgkmcnt(6)
  v_mfma_f32_16x16x32_bf16 v[252:255], v[156:159], v[68:71], v[252:255]
  v_exp_f32 v11, v107
  v_mfma_f32_16x16x32_bf16 v[80:83], v[160:163], v[32:35], v[16:19]
  ds_read_b128 v[152:155], v5 offset:30720
  v_cvt_pk_bf16_f32 v75, v10, v11
  v_mfma_f32_16x16x32_bf16 v[84:87], v[160:163], v[48:51], v[20:23]
  v_exp_f32 v8, v108
  v_mfma_f32_16x16x32_bf16 v[80:83], v[164:167], v[36:39], v[80:83]
  ds_read_b128 v[156:159], v5 offset:31744
  buffer_load_dwordx4 v1, s[36:39], s41 offen offset:2048 sc1 lds
  v_mfma_f32_16x16x32_bf16 v[84:87], v[164:167], v[52:55], v[84:87]
  v_exp_f32 v9, v109
  v_mfma_f32_16x16x32_bf16 v[80:83], v[168:171], v[40:43], v[80:83]
  ds_read_b128 v[160:163], v3 offset:8192
  v_cvt_pk_bf16_f32 v78, v8, v9
  v_mfma_f32_16x16x32_bf16 v[84:87], v[168:171], v[56:59], v[84:87]
  v_exp_f32 v10, v110
  v_mfma_f32_16x16x32_bf16 v[80:83], v[172:175], v[44:47], v[80:83]
  ds_read_b128 v[164:167], v3 offset:9216
  buffer_load_dwordx4 v1, s[36:39], s41 offen offset:3072 sc1 lds
  v_mfma_f32_16x16x32_bf16 v[84:87], v[172:175], v[60:63], v[84:87]
  v_exp_f32 v11, v111
  v_mfma_f32_16x16x32_bf16 v[88:91], v[176:179], v[32:35], v[16:19]
  s_add_u32 s41, s41, 0x4000
  ds_read_b128 v[168:171], v3 offset:10240
  v_cvt_pk_bf16_f32 v79, v10, v11
  v_mfma_f32_16x16x32_bf16 v[112:115], v[12:15], v[72:75], v[24:27]
  s_sub_u32 s45, s45, 1
  s_cselect_b32 s46, -1.0, s46
  v_mfma_f32_16x16x32_bf16 v[116:119], v[12:15], v[76:79], v[28:31]
  ds_read_b128 v[172:175], v3 offset:11264
  s_waitcnt vmcnt(4)
  s_barrier
  v_mfma_f32_16x16x32_bf16 v[92:95], v[176:179], v[48:51], v[20:23]
  v_exp_f32 v8, v80
  v_mfma_f32_16x16x32_bf16 v[88:91], v[180:183], v[36:39], v[88:91]
  ds_read_b128 v[176:179], v3 offset:12288
  s_waitcnt lgkmcnt(5)
  v_mfma_f32_16x16x32_bf16 v[92:95], v[180:183], v[52:55], v[92:95]
  v_exp_f32 v9, v81
  v_mfma_f32_16x16x32_bf16 v[88:91], v[184:187], v[40:43], v[88:91]
  v_max_f32 v120, v112, v116
  v_cmp_ngt_f32 vcc, s46, v120
  v_mfma_f32_16x16x32_bf16 v[92:95], v[184:187], v[56:59], v[92:95]
  v_exp_f32 v10, v82
  v_mfma_f32_16x16x32_bf16 v[88:91], v[188:191], v[44:47], v[88:91]
  ds_read_b128 v[180:183], v3 offset:13312
  s_cbranch_vccnz kvattn_kernel_stubA2
kvattn_kernel_retA2:
  v_mfma_f32_16x16x32_bf16 v[92:95], v[188:191], v[60:63], v[92:95]
  v_exp_f32 v11, v83
  v_mfma_f32_16x16x32_bf16 v[192:195], v[128:131], v[72:75], v[192:195]
  ds_read_b128 v[184:187], v3 offset:14336
  v_cvt_pk_bf16_f32 v64, v8, v9
  v_mfma_f32_16x16x32_bf16 v[196:199], v[128:131], v[76:79], v[196:199]
  v_exp_f32 v8, v84
  v_mfma_f32_16x16x32_bf16 v[200:203], v[132:135], v[72:75], v[200:203]
  ds_read_b128 v[188:191], v3 offset:15360
  v_cvt_pk_bf16_f32 v65, v10, v11
  v_mfma_f32_16x16x32_bf16 v[204:207], v[132:135], v[76:79], v[204:207]
  v_exp_f32 v9, v85
  v_mfma_f32_16x16x32_bf16 v[208:211], v[136:139], v[72:75], v[208:211]
  s_add_u32 m0, s43, 32768
  ds_read_b128 v[128:131], v5 offset:32768
  v_cvt_pk_bf16_f32 v68, v8, v9
  v_mfma_f32_16x16x32_bf16 v[212:215], v[136:139], v[76:79], v[212:215]
  v_exp_f32 v10, v86
  v_mfma_f32_16x16x32_bf16 v[216:219], v[140:143], v[72:75], v[216:219]
  ds_read_b128 v[132:135], v5 offset:33792
  buffer_load_dwordx4 v1, s[32:35], s40 offen offset:0 sc1 lds
  v_mfma_f32_16x16x32_bf16 v[220:223], v[140:143], v[76:79], v[220:223]
  v_exp_f32 v11, v87
  v_mfma_f32_16x16x32_bf16 v[224:227], v[144:147], v[72:75], v[224:227]
  ds_read_b128 v[136:139], v5 offset:34816
  v_cvt_pk_bf16_f32 v69, v10, v11
  v_mfma_f32_16x16x32_bf16 v[228:231], v[144:147], v[76:79], v[228:231]
  v_exp_f32 v8, v88
  v_mfma_f32_16x16x32_bf16 v[232:235], v[148:151], v[72:75], v[232:235]
  ds_read_b128 v[140:143], v5 offset:35840
  buffer_load_dwordx4 v1, s[32:35], s40 offen offset:1024 sc1 lds
  v_mfma_f32_16x16x32_bf16 v[236:239], v[148:151], v[76:79], v[236:239]
  v_exp_f32 v9, v89
  v_mfma_f32_16x16x32_bf16 v[240:243], v[152:155], v[72:75], v[240:243]
  ds_read_b128 v[144:147], v5 offset:36864
  v_cvt_pk_bf16_f32 v66, v8, v9
  v_mfma_f32_16x16x32_bf16 v[244:247], v[152:155], v[76:79], v[244:247]
  v_exp_f32 v10, v90
  v_mfma_f32_16x16x32_bf16 v[248:251], v[156:159], v[72:75], v[248:251]
  ds_read_b128 v[148:151], v5 offset:37888
  s_waitcnt lgkmcnt(6)
  v_mfma_f32_16x16x32_bf16 v[252:255], v[156:159], v[76:79], v[252:255]
  v_exp_f32 v11, v91
  v_mfma_f32_16x16x32_bf16 v[96:99], v[160:163], v[32:35], v[16:19]
  ds_read_b128 v[152:155], v5 offset:38912
  v_cvt_pk_bf16_f32 v67, v10, v11
  v_mfma_f32_16x16x32_bf16 v[100:103], v[160:163], v[48:51], v[20:23]
  v_exp_f32 v8, v92
  v_mfma_f32_16x16x32_bf16 v[96:99], v[164:167], v[36:39], v[96:99]
  ds_read_b128 v[156:159], v5 offset:39936
  buffer_load_dwordx4 v1, s[32:35], s40 offen offset:2048 sc1 lds
  v_mfma_f32_16x16x32_bf16 v[100:103], v[164:167], v[52:55], v[100:103]
  v_exp_f32 v9, v93
  v_mfma_f32_16x16x32_bf16 v[96:99], v[168:171], v[40:43], v[96:99]
  ds_read_b128 v[160:163], v3 offset:16384
  v_cvt_pk_bf16_f32 v70, v8, v9
  v_mfma_f32_16x16x32_bf16 v[100:103], v[168:171], v[56:59], v[100:103]
  v_exp_f32 v10, v94
  v_mfma_f32_16x16x32_bf16 v[96:99], v[172:175], v[44:47], v[96:99]
  ds_read_b128 v[164:167], v3 offset:17408
  buffer_load_dwordx4 v1, s[32:35], s40 offen offset:3072 sc1 lds
  v_mfma_f32_16x16x32_bf16 v[100:103], v[172:175], v[60:63], v[100:103]
  v_exp_f32 v11, v95
  v_mfma_f32_16x16x32_bf16 v[104:107], v[176:179], v[32:35], v[16:19]
  s_add_u32 s40, s40, 0x4000
  ds_read_b128 v[168:171], v3 offset:18432
  v_cvt_pk_bf16_f32 v71, v10, v11
  v_mfma_f32_16x16x32_bf16 v[24:27], v[12:15], v[64:67], v[112:115]
  s_sub_u32 s45, s45, 1
  s_cselect_b32 s46, -1.0, s46
  v_mfma_f32_16x16x32_bf16 v[28:31], v[12:15], v[68:71], v[116:119]
  ds_read_b128 v[172:175], v3 offset:19456
  v_mfma_f32_16x16x32_bf16 v[108:111], v[176:179], v[48:51], v[20:23]
  v_exp_f32 v8, v96
  v_mfma_f32_16x16x32_bf16 v[104:107], v[180:183], v[36:39], v[104:107]
  ds_read_b128 v[176:179], v3 offset:20480
  s_waitcnt lgkmcnt(5)
  v_mfma_f32_16x16x32_bf16 v[108:111], v[180:183], v[52:55], v[108:111]
  v_exp_f32 v9, v97
  v_mfma_f32_16x16x32_bf16 v[104:107], v[184:187], v[40:43], v[104:107]
  v_max_f32 v120, v24, v28
  v_cmp_ngt_f32 vcc, s46, v120
  v_mfma_f32_16x16x32_bf16 v[108:111], v[184:187], v[56:59], v[108:111]
  v_exp_f32 v10, v98
  v_mfma_f32_16x16x32_bf16 v[104:107], v[188:191], v[44:47], v[104:107]
  ds_read_b128 v[180:183], v3 offset:21504
  s_cbranch_vccnz kvattn_kernel_stubA3
kvattn_kernel_retA3:
  v_mfma_f32_16x16x32_bf16 v[108:111], v[188:191], v[60:63], v[108:111]
  v_exp_f32 v11, v99
  v_mfma_f32_16x16x32_bf16 v[192:195], v[128:131], v[64:67], v[192:195]
  ds_read_b128 v[184:187], v3 offset:22528
  v_cvt_pk_bf16_f32 v72, v8, v9
  v_mfma_f32_16x16x32_bf16 v[196:199], v[128:131], v[68:71], v[196:199]
  v_exp_f32 v8, v100
  v_mfma_f32_16x16x32_bf16 v[200:203], v[132:135], v[64:67], v[200:203]
  ds_read_b128 v[188:191], v3 offset:23552
  v_cvt_pk_bf16_f32 v73, v10, v11
  v_mfma_f32_16x16x32_bf16 v[204:207], v[132:135], v[68:71], v[204:207]
  v_exp_f32 v9, v101
  v_mfma_f32_16x16x32_bf16 v[208:211], v[136:139], v[64:67], v[208:211]
  s_add_u32 m0, s44, 0
  ds_read_b128 v[128:131], v5 offset:40960
  v_cvt_pk_bf16_f32 v76, v8, v9
  v_mfma_f32_16x16x32_bf16 v[212:215], v[136:139], v[68:71], v[212:215]
  v_exp_f32 v10, v102
  v_mfma_f32_16x16x32_bf16 v[216:219], v[140:143], v[64:67], v[216:219]
  ds_read_b128 v[132:135], v5 offset:41984
  buffer_load_dwordx4 v1, s[36:39], s41 offen offset:0 sc1 lds
  v_mfma_f32_16x16x32_bf16 v[220:223], v[140:143], v[68:71], v[220:223]
  v_exp_f32 v11, v103
  v_mfma_f32_16x16x32_bf16 v[224:227], v[144:147], v[64:67], v[224:227]
  ds_read_b128 v[136:139], v5 offset:43008
  v_cvt_pk_bf16_f32 v77, v10, v11
  v_mfma_f32_16x16x32_bf16 v[228:231], v[144:147], v[68:71], v[228:231]
  v_exp_f32 v8, v104
  v_mfma_f32_16x16x32_bf16 v[232:235], v[148:151], v[64:67], v[232:235]
  ds_read_b128 v[140:143], v5 offset:44032
  buffer_load_dwordx4 v1, s[36:39], s41 offen offset:1024 sc1 lds
  v_mfma_f32_16x16x32_bf16 v[236:239], v[148:151], v[68:71], v[236:239]
  v_exp_f32 v9, v105
  v_mfma_f32_16x16x32_bf16 v[240:243], v[152:155], v[64:67], v[240:243]
  ds_read_b128 v[144:147], v5 offset:45056
  v_cvt_pk_bf16_f32 v74, v8, v9
  v_mfma_f32_16x16x32_bf16 v[244:247], v[152:155], v[68:71], v[244:247]
  v_exp_f32 v10, v106
  v_mfma_f32_16x16x32_bf16 v[248:251], v[156:159], v[64:67], v[248:251]
  ds_read_b128 v[148:151], v5 offset:46080
  s_waitcnt lgkmcnt(6)
  v_mfma_f32_16x16x32_bf16 v[252:255], v[156:159], v[68:71], v[252:255]
  v_exp_f32 v11, v107
  v_mfma_f32_16x16x32_bf16 v[80:83], v[160:163], v[32:35], v[16:19]
  ds_read_b128 v[152:155], v5 offset:47104
  v_cvt_pk_bf16_f32 v75, v10, v11
  v_mfma_f32_16x16x32_bf16 v[84:87], v[160:163], v[48:51], v[20:23]
  v_exp_f32 v8, v108
  v_mfma_f32_16x16x32_bf16 v[80:83], v[164:167], v[36:39], v[80:83]
  ds_read_b128 v[156:159], v5 offset:48128
  buffer_load_dwordx4 v1, s[36:39], s41 offen offset:2048 sc1 lds
  v_mfma_f32_16x16x32_bf16 v[84:87], v[164:167], v[52:55], v[84:87]
  v_exp_f32 v9, v109
  v_mfma_f32_16x16x32_bf16 v[80:83], v[168:171], v[40:43], v[80:83]
  ds_read_b128 v[160:163], v3 offset:24576
  v_cvt_pk_bf16_f32 v78, v8, v9
  v_mfma_f32_16x16x32_bf16 v[84:87], v[168:171], v[56:59], v[84:87]
  v_exp_f32 v10, v110
  v_mfma_f32_16x16x32_bf16 v[80:83], v[172:175], v[44:47], v[80:83]
  ds_read_b128 v[164:167], v3 offset:25600
  buffer_load_dwordx4 v1, s[36:39], s41 offen offset:3072 sc1 lds
  v_mfma_f32_16x16x32_bf16 v[84:87], v[172:175], v[60:63], v[84:87]
  v_exp_f32 v11, v111
  v_mfma_f32_16x16x32_bf16 v[88:91], v[176:179], v[32:35], v[16:19]
  s_add_u32 s41, s41, 0x4000
  ds_read_b128 v[168:171], v3 offset:26624
  v_cvt_pk_bf16_f32 v79, v10, v11
  v_mfma_f32_16x16x32_bf16 v[112:115], v[12:15], v[72:75], v[24:27]
  s_sub_u32 s45, s45, 1
  s_cselect_b32 s46, -1.0, s46
  v_mfma_f32_16x16x32_bf16 v[116:119], v[12:15], v[76:79], v[28:31]
  ds_read_b128 v[172:175], v3 offset:27648
  s_waitcnt vmcnt(4)
  s_barrier
  v_mfma_f32_16x16x32_bf16 v[92:95], v[176:179], v[48:51], v[20:23]
  v_exp_f32 v8, v80
  v_mfma_f32_16x16x32_bf16 v[88:91], v[180:183], v[36:39], v[88:91]
  ds_read_b128 v[176:179], v3 offset:28672
  s_waitcnt lgkmcnt(5)
  v_mfma_f32_16x16x32_bf16 v[92:95], v[180:183], v[52:55], v[92:95]
  v_exp_f32 v9, v81
  v_mfma_f32_16x16x32_bf16 v[88:91], v[184:187], v[40:43], v[88:91]
  v_max_f32 v120, v112, v116
  v_cmp_ngt_f32 vcc, s46, v120
  v_mfma_f32_16x16x32_bf16 v[92:95], v[184:187], v[56:59], v[92:95]
  v_exp_f32 v10, v82
  v_mfma_f32_16x16x32_bf16 v[88:91], v[188:191], v[44:47], v[88:91]
  ds_read_b128 v[180:183], v3 offset:29696
  s_cbranch_vccnz kvattn_kernel_stubA4
kvattn_kernel_retA4:
  v_mfma_f32_16x16x32_bf16 v[92:95], v[188:191], v[60:63], v[92:95]
  v_exp_f32 v11, v83
  v_mfma_f32_16x16x32_bf16 v[192:195], v[128:131], v[72:75], v[192:195]
  ds_read_b128 v[184:187], v3 offset:30720
  v_cvt_pk_bf16_f32 v64, v8, v9
  v_mfma_f32_16x16x32_bf16 v[196:199], v[128:131], v[76:79], v[196:199]
  v_exp_f32 v8, v84
  v_mfma_f32_16x16x32_bf16 v[200:203], v[132:135], v[72:75], v[200:203]
  ds_read_b128 v[188:191], v3 offset:31744
  v_cvt_pk_bf16_f32 v65, v10, v11
  v_mfma_f32_16x16x32_bf16 v[204:207], v[132:135], v[76:79], v[204:207]
  v_exp_f32 v9, v85
  v_mfma_f32_16x16x32_bf16 v[208:211], v[136:139], v[72:75], v[208:211]
  s_add_u32 m0, s43, 49152
  ds_read_b128 v[128:131], v5 offset:49152
  v_cvt_pk_bf16_f32 v68, v8, v9
  v_mfma_f32_16x16x32_bf16 v[212:215], v[136:139], v[76:79], v[212:215]
  v_exp_f32 v10, v86
  v_mfma_f32_16x16x32_bf16 v[216:219], v[140:143], v[72:75], v[216:219]
  ds_read_b128 v[132:135], v5 offset:50176
  buffer_load_dwordx4 v1, s[32:35], s40 offen offset:0 sc1 lds
  v_mfma_f32_16x16x32_bf16 v[220:223], v[140:143], v[76:79], v[220:223]
  v_exp_f32 v11, v87
  v_mfma_f32_16x16x32_bf16 v[224:227], v[144:147], v[72:75], v[224:227]
  ds_read_b128 v[136:139], v5 offset:51200
  v_cvt_pk_bf16_f32 v69, v10, v11
  v_mfma_f32_16x16x32_bf16 v[228:231], v[144:147], v[76:79], v[228:231]
  v_exp_f32 v8, v88
  v_mfma_f32_16x16x32_bf16 v[232:235], v[148:151], v[72:75], v[232:235]
  ds_read_b128 v[140:143], v5 offset:52224
  buffer_load_dwordx4 v1, s[32:35], s40 offen offset:1024 sc1 lds
  v_mfma_f32_16x16x32_bf16 v[236:239], v[148:151], v[76:79], v[236:239]
  v_exp_f32 v9, v89
  v_mfma_f32_16x16x32_bf16 v[240:243], v[152:155], v[72:75], v[240:243]
  ds_read_b128 v[144:147], v5 offset:53248
  v_cvt_pk_bf16_f32 v66, v8, v9
  v_mfma_f32_16x16x32_bf16 v[244:247], v[152:155], v[76:79], v[244:247]
  v_exp_f32 v10, v90
  v_mfma_f32_16x16x32_bf16 v[248:251], v[156:159], v[72:75], v[248:251]
  ds_read_b128 v[148:151], v5 offset:54272
  s_waitcnt lgkmcnt(6)
  v_mfma_f32_16x16x32_bf16 v[252:255], v[156:159], v[76:79], v[252:255]
  v_exp_f32 v11, v91
  v_mfma_f32_16x16x32_bf16 v[96:99], v[160:163], v[32:35], v[16:19]
  ds_read_b128 v[152:155], v5 offset:55296
  v_cvt_pk_bf16_f32 v67, v10, v11
  v_mfma_f32_16x16x32_bf16 v[100:103], v[160:163], v[48:51], v[20:23]
  v_exp_f32 v8, v92
  v_mfma_f32_16x16x32_bf16 v[96:99], v[164:167], v[36:39], v[96:99]
  ds_read_b128 v[156:159], v5 offset:56320
  buffer_load_dwordx4 v1, s[32:35], s40 offen offset:2048 sc1 lds
  v_mfma_f32_16x16x32_bf16 v[100:103], v[164:167], v[52:55], v[100:103]
  v_exp_f32 v9, v93
  v_mfma_f32_16x16x32_bf16 v[96:99], v[168:171], v[40:43], v[96:99]
  ds_read_b128 v[160:163], v3 offset:32768
  v_cvt_pk_bf16_f32 v70, v8, v9
  v_mfma_f32_16x16x32_bf16 v[100:103], v[168:171], v[56:59], v[100:103]
  v_exp_f32 v10, v94
  v_mfma_f32_16x16x32_bf16 v[96:99], v[172:175], v[44:47], v[96:99]
  ds_read_b128 v[164:167], v3 offset:33792
  buffer_load_dwordx4 v1, s[32:35], s40 offen offset:3072 sc1 lds
  v_mfma_f32_16x16x32_bf16 v[100:103], v[172:175], v[60:63], v[100:103]
  v_exp_f32 v11, v95
  v_mfma_f32_16x16x32_bf16 v[104:107], v[176:179], v[32:35], v[16:19]
  s_add_u32 s40, s40, 0x4000
  ds_read_b128 v[168:171], v3 offset:34816
  v_cvt_pk_bf16_f32 v71, v10, v11
  v_mfma_f32_16x16x32_bf16 v[24:27], v[12:15], v[64:67], v[112:115]
  s_sub_u32 s45, s45, 1
  s_cselect_b32 s46, -1.0, s46
  v_mfma_f32_16x16x32_bf16 v[28:31], v[12:15], v[68:71], v[116:119]
  ds_read_b128 v[172:175], v3 offset:35840
  v_mfma_f32_16x16x32_bf16 v[108:111], v[176:179], v[48:51], v[20:23]
  v_exp_f32 v8, v96
  v_mfma_f32_16x16x32_bf16 v[104:107], v[180:183], v[36:39], v[104:107]
  ds_read_b128 v[176:179], v3 offset:36864
  s_waitcnt lgkmcnt(5)
  v_mfma_f32_16x16x32_bf16 v[108:111], v[180:183], v[52:55], v[108:111]
  v_exp_f32 v9, v97
  v_mfma_f32_16x16x32_bf16 v[104:107], v[184:187], v[40:43], v[104:107]
  v_max_f32 v120, v24, v28
  v_cmp_ngt_f32 vcc, s46, v120
  v_mfma_f32_16x16x32_bf16 v[108:111], v[184:187], v[56:59], v[108:111]
  v_exp_f32 v10, v98
  v_mfma_f32_16x16x32_bf16 v[104:107], v[188:191], v[44:47], v[104:107]
  ds_read_b128 v[180:183], v3 offset:37888
  s_cbranch_vccnz kvattn_kernel_stubA5
kvattn_kernel_retA5:
  v_mfma_f32_16x16x32_bf16 v[108:111], v[188:191], v[60:63], v[108:111]
  v_exp_f32 v11, v99
  v_mfma_f32_16x16x32_bf16 v[192:195], v[128:131], v[64:67], v[192:195]
  ds_read_b128 v[184:187], v3 offset:38912
  v_cvt_pk_bf16_f32 v72, v8, v9
  v_mfma_f32_16x16x32_bf16 v[196:199], v[128:131], v[68:71], v[196:199]
  v_exp_f32 v8, v100
  v_mfma_f32_16x16x32_bf16 v[200:203], v[132:135], v[64:67], v[200:203]
  ds_read_b128 v[188:191], v3 offset:39936
  v_cvt_pk_bf16_f32 v73, v10, v11
  v_mfma_f32_16x16x32_bf16 v[204:207], v[132:135], v[68:71], v[204:207]
  v_exp_f32 v9, v101
  v_mfma_f32_16x16x32_bf16 v[208:211], v[136:139], v[64:67], v[208:211]
  s_add_u32 m0, s44, 16384
  ds_read_b128 v[128:131], v5 offset:57344
  v_cvt_pk_bf16_f32 v76, v8, v9
  v_mfma_f32_16x16x32_bf16 v[212:215], v[136:139], v[68:71], v[212:215]
  v_exp_f32 v10, v102
  v_mfma_f32_16x16x32_bf16 v[216:219], v[140:143], v[64:67], v[216:219]
  ds_read_b128 v[132:135], v5 offset:58368
  buffer_load_dwordx4 v1, s[36:39], s41 offen offset:0 sc1 lds
  v_mfma_f32_16x16x32_bf16 v[220:223], v[140:143], v[68:71], v[220:223]
  v_exp_f32 v11, v103
  v_mfma_f32_16x16x32_bf16 v[224:227], v[144:147], v[64:67], v[224:227]
  ds_read_b128 v[136:139], v5 offset:59392
  v_cvt_pk_bf16_f32 v77, v10, v11
  v_mfma_f32_16x16x32_bf16 v[228:231], v[144:147], v[68:71], v[228:231]
  v_exp_f32 v8, v104
  v_mfma_f32_16x16x32_bf16 v[232:235], v[148:151], v[64:67], v[232:235]
  ds_read_b128 v[140:143], v5 offset:60416
  buffer_load_dwordx4 v1, s[36:39], s41 offen offset:1024 sc1 lds
  v_mfma_f32_16x16x32_bf16 v[236:239], v[148:151], v[68:71], v[236:239]
  v_exp_f32 v9, v105
  v_mfma_f32_16x16x32_bf16 v[240:243], v[152:155], v[64:67], v[240:243]
  ds_read_b128 v[144:147], v5 offset:61440
  v_cvt_pk_bf16_f32 v74, v8, v9
  v_mfma_f32_16x16x32_bf16 v[244:247], v[152:155], v[68:71], v[244:247]
  v_exp_f32 v10, v106
  v_mfma_f32_16x16x32_bf16 v[248:251], v[156:159], v[64:67], v[248:251]
  ds_read_b128 v[148:151], v5 offset:62464
  s_waitcnt lgkmcnt(6)
  v_mfma_f32_16x16x32_bf16 v[252:255], v[156:159], v[68:71], v[252:255]
  v_exp_f32 v11, v107
  v_mfma_f32_16x16x32_bf16 v[80:83], v[160:163], v[32:35], v[16:19]
  ds_read_b128 v[152:155], v5 offset:63488
  v_cvt_pk_bf16_f32 v75, v10, v11
  v_mfma_f32_16x16x32_bf16 v[84:87], v[160:163], v[48:51], v[20:23]
  v_exp_f32 v8, v108
  v_mfma_f32_16x16x32_bf16 v[80:83], v[164:167], v[36:39], v[80:83]
  ds_read_b128 v[156:159], v5 offset:64512
  buffer_load_dwordx4 v1, s[36:39], s41 offen offset:2048 sc1 lds
  v_mfma_f32_16x16x32_bf16 v[84:87], v[164:167], v[52:55], v[84:87]
  v_exp_f32 v9, v109
  v_mfma_f32_16x16x32_bf16 v[80:83], v[168:171], v[40:43], v[80:83]
  ds_read_b128 v[160:163], v3 offset:40960
  v_cvt_pk_bf16_f32 v78, v8, v9
  v_mfma_f32_16x16x32_bf16 v[84:87], v[168:171], v[56:59], v[84:87]
  v_exp_f32 v10, v110
  v_mfma_f32_16x16x32_bf16 v[80:83], v[172:175], v[44:47], v[80:83]
  ds_read_b128 v[164:167], v3 offset:41984
  buffer_load_dwordx4 v1, s[36:39], s41 offen offset:3072 sc1 lds
  v_mfma_f32_16x16x32_bf16 v[84:87], v[172:175], v[60:63], v[84:87]
  v_exp_f32 v11, v111
  v_mfma_f32_16x16x32_bf16 v[88:91], v[176:179], v[32:35], v[16:19]
  s_add_u32 s41, s41, 0x4000
  ds_read_b128 v[168:171], v3 offset:43008
  v_cvt_pk_bf16_f32 v79, v10, v11
  v_mfma_f32_16x16x32_bf16 v[112:115], v[12:15], v[72:75], v[24:27]
  s_sub_u32 s45, s45, 1
  s_cselect_b32 s46, -1.0, s46
  v_mfma_f32_16x16x32_bf16 v[116:119], v[12:15], v[76:79], v[28:31]
  ds_read_b128 v[172:175], v3 offset:44032
  s_waitcnt vmcnt(4)
  s_barrier
  v_mfma_f32_16x16x32_bf16 v[92:95], v[176:179], v[48:51], v[20:23]
  v_exp_f32 v8, v80
  v_mfma_f32_16x16x32_bf16 v[88:91], v[180:183], v[36:39], v[88:91]
  ds_read_b128 v[176:179], v3 offset:45056
  s_waitcnt lgkmcnt(5)
  v_mfma_f32_16x16x32_bf16 v[92:95], v[180:183], v[52:55], v[92:95]
  v_exp_f32 v9, v81
  v_mfma_f32_16x16x32_bf16 v[88:91], v[184:187], v[40:43], v[88:91]
  v_max_f32 v120, v112, v116
  v_cmp_ngt_f32 vcc, s46, v120
  v_mfma_f32_16x16x32_bf16 v[92:95], v[184:187], v[56:59], v[92:95]
  v_exp_f32 v10, v82
  v_mfma_f32_16x16x32_bf16 v[88:91], v[188:191], v[44:47], v[88:91]
  ds_read_b128 v[180:183], v3 offset:46080
  s_cbranch_vccnz kvattn_kernel_stubA6
kvattn_kernel_retA6:
  v_mfma_f32_16x16x32_bf16 v[92:95], v[188:191], v[60:63], v[92:95]
  v_exp_f32 v11, v83
  v_mfma_f32_16x16x32_bf16 v[192:195], v[128:131], v[72:75], v[192:195]
  ds_read_b128 v[184:187], v3 offset:47104
  v_cvt_pk_bf16_f32 v64, v8, v9
  v_mfma_f32_16x16x32_bf16 v[196:199], v[128:131], v[76:79], v[196:199]
  v_exp_f32 v8, v84
  v_mfma_f32_16x16x32_bf16 v[200:203], v[132:135], v[72:75], v[200:203]
  ds_read_b128 v[188:191], v3 offset:48128
  v_cvt_pk_bf16_f32 v65, v10, v11
  v_mfma_f32_16x16x32_bf16 v[204:207], v[132:135], v[76:79], v[204:207]
  v_exp_f32 v9, v85
  v_mfma_f32_16x16x32_bf16 v[208:211], v[136:139], v[72:75], v[208:211]
  s_add_u32 m0, s43, 0
  ds_read_b128 v[128:131], v5 offset:0
  v_cvt_pk_bf16_f32 v68, v8, v9
  v_mfma_f32_16x16x32_bf16 v[212:215], v[136:139], v[76:79], v[212:215]
  v_exp_f32 v10, v86
  v_mfma_f32_16x16x32_bf16 v[216:219], v[140:143], v[72:75], v[216:219]
  ds_read_b128 v[132:135], v5 offset:1024
  buffer_load_dwordx4 v1, s[32:35], s40 offen offset:0 sc1 lds
  v_mfma_f32_16x16x32_bf16 v[220:223], v[140:143], v[76:79], v[220:223]
  v_exp_f32 v11, v87
  v_mfma_f32_16x16x32_bf16 v[224:227], v[144:147], v[72:75], v[224:227]
  ds_read_b128 v[136:139], v5 offset:2048
  v_cvt_pk_bf16_f32 v69, v10, v11
  v_mfma_f32_16x16x32_bf16 v[228:231], v[144:147], v[76:79], v[228:231]
  v_exp_f32 v8, v88
  v_mfma_f32_16x16x32_bf16 v[232:235], v[148:151], v[72:75], v[232:235]
  ds_read_b128 v[140:143], v5 offset:3072
  buffer_load_dwordx4 v1, s[32:35], s40 offen offset:1024 sc1 lds
  v_mfma_f32_16x16x32_bf16 v[236:239], v[148:151], v[76:79], v[236:239]
  v_exp_f32 v9, v89
  v_mfma_f32_16x16x32_bf16 v[240:243], v[152:155], v[72:75], v[240:243]
  ds_read_b128 v[144:147], v5 offset:4096
  v_cvt_pk_bf16_f32 v66, v8, v9
  v_mfma_f32_16x16x32_bf16 v[244:247], v[152:155], v[76:79], v[244:247]
  v_exp_f32 v10, v90
  v_mfma_f32_16x16x32_bf16 v[248:251], v[156:159], v[72:75], v[248:251]
  ds_read_b128 v[148:151], v5 offset:5120
  s_waitcnt lgkmcnt(6)
  v_mfma_f32_16x16x32_bf16 v[252:255], v[156:159], v[76:79], v[252:255]
  v_exp_f32 v11, v91
  v_mfma_f32_16x16x32_bf16 v[96:99], v[160:163], v[32:35], v[16:19]
  ds_read_b128 v[152:155], v5 offset:6144
  v_cvt_pk_bf16_f32 v67, v10, v11
  v_mfma_f32_16x16x32_bf16 v[100:103], v[160:163], v[48:51], v[20:23]
  v_exp_f32 v8, v92
  v_mfma_f32_16x16x32_bf16 v[96:99], v[164:167], v[36:39], v[96:99]
  ds_read_b128 v[156:159], v5 offset:7168
  buffer_load_dwordx4 v1, s[32:35], s40 offen offset:2048 sc1 lds
  v_mfma_f32_16x16x32_bf16 v[100:103], v[164:167], v[52:55], v[100:103]
  v_exp_f32 v9, v93
  v_mfma_f32_16x16x32_bf16 v[96:99], v[168:171], v[40:43], v[96:99]
  ds_read_b128 v[160:163], v3 offset:49152
  v_cvt_pk_bf16_f32 v70, v8, v9
  v_mfma_f32_16x16x32_bf16 v[100:103], v[168:171], v[56:59], v[100:103]
  v_exp_f32 v10, v94
  v_mfma_f32_16x16x32_bf16 v[96:99], v[172:175], v[44:47], v[96:99]
  ds_read_b128 v[164:167], v3 offset:50176
  buffer_load_dwordx4 v1, s[32:35], s40 offen offset:3072 sc1 lds
  v_mfma_f32_16x16x32_bf16 v[100:103], v[172:175], v[60:63], v[100:103]
  v_exp_f32 v11, v95
  v_mfma_f32_16x16x32_bf16 v[104:107], v[176:179], v[32:35], v[16:19]
  s_add_u32 s40, s40, 0x4000
  ds_read_b128 v[168:171], v3 offset:51200
  v_cvt_pk_bf16_f32 v71, v10, v11
  v_mfma_f32_16x16x32_bf16 v[24:27], v[12:15], v[64:67], v[112:115]
  s_sub_u32 s45, s45, 1
  s_cselect_b32 s46, -1.0, s46
  v_mfma_f32_16x16x32_bf16 v[28:31], v[12:15], v[68:71], v[116:119]
  ds_read_b128 v[172:175], v3 offset:52224
  v_mfma_f32_16x16x32_bf16 v[108:111], v[176:179], v[48:51], v[20:23]
  v_exp_f32 v8, v96
  v_mfma_f32_16x16x32_bf16 v[104:107], v[180:183], v[36:39], v[104:107]
  ds_read_b128 v[176:179], v3 offset:53248
  s_waitcnt lgkmcnt(5)
  v_mfma_f32_16x16x32_bf16 v[108:111], v[180:183], v[52:55], v[108:111]
  v_exp_f32 v9, v97
  v_mfma_f32_16x16x32_bf16 v[104:107], v[184:187], v[40:43], v[104:107]
  v_max_f32 v120, v24, v28
  v_cmp_ngt_f32 vcc, s46, v120
  v_mfma_f32_16x16x32_bf16 v[108:111], v[184:187], v[56:59], v[108:111]
  v_exp_f32 v10, v98
  v_mfma_f32_16x16x32_bf16 v[104:107], v[188:191], v[44:47], v[104:107]
  ds_read_b128 v[180:183], v3 offset:54272
  s_cbranch_vccnz kvattn_kernel_stubA7
kvattn_kernel_retA7:
  v_mfma_f32_16x16x32_bf16 v[108:111], v[188:191], v[60:63], v[108:111]
  v_exp_f32 v11, v99
  s_branch kvattn_kernel_loopA
kvattn_kernel_stubB0:
  s_mov_b32 s48, 0
  s_branch kvattn_kernel_h0
kvattn_kernel_stubB1:
  s_mov_b32 s48, 0
  s_branch kvattn_kernel_h1
kvattn_kernel_stubB2:
  s_mov_b32 s48, 1
  s_branch kvattn_kernel_h0
kvattn_kernel_stubB3:
  s_mov_b32 s48, 1
  s_branch kvattn_kernel_h1
kvattn_kernel_stubB4:
  s_mov_b32 s48, 2
  s_branch kvattn_kernel_h0
kvattn_kernel_stubB5:
  s_mov_b32 s48, 2
  s_branch kvattn_kernel_h1
kvattn_kernel_stubB6:
  s_mov_b32 s48, 3
  s_branch kvattn_kernel_h0
kvattn_kernel_stubB7:
  s_mov_b32 s48, 3
  s_branch kvattn_kernel_h1
kvattn_kernel_stubA0:
  s_mov_b32 s48, 4
  s_branch kvattn_kernel_h0
kvattn_kernel_stubA1:
  s_mov_b32 s48, 4
  s_branch kvattn_kernel_h1
kvattn_kernel_stubA2:
  s_mov_b32 s48, 5
  s_branch kvattn_kernel_h0
kvattn_kernel_stubA3:
  s_mov_b32 s48, 5
  s_branch kvattn_kernel_h1
kvattn_kernel_stubA4:
  s_mov_b32 s48, 6
  s_branch kvattn_kernel_h0
kvattn_kernel_stubA5:
  s_mov_b32 s48, 6
  s_branch kvattn_kernel_h1
kvattn_kernel_stubA6:
  s_mov_b32 s48, 7
  s_branch kvattn_kernel_h0
kvattn_kernel_stubA7:
  s_mov_b32 s48, 7
  s_branch kvattn_kernel_h1
kvattn_kernel_pm0:
  s_nop 7
  v_mov_b32 v121, 0xff800000
  v_cmp_gt_i32 vcc, 0, v4
  v_cmp_gt_i32 s[62:63], 1, v4
  s_nop 1
  v_cndmask_b32 v80, v80, v121, vcc
  v_cndmask_b32 v81, v81, v121, s[62:63]
  v_cmp_gt_i32 vcc, 2, v4
  v_cmp_gt_i32 s[62:63], 3, v4
  s_nop 1
  v_cndmask_b32 v82, v82, v121, vcc
  v_cndmask_b32 v83, v83, v121, s[62:63]
  v_cmp_gt_i32 vcc, -16, v4
  v_cmp_gt_i32 s[62:63], -15, v4
  s_nop 1
  v_cndmask_b32 v84, v84, v121, vcc
  v_cndmask_b32 v85, v85, v121, s[62:63]
  v_cmp_gt_i32 vcc, -14, v4
  v_cmp_gt_i32 s[62:63], -13, v4
  s_nop 1
  v_cndmask_b32 v86, v86, v121, vcc
  v_cndmask_b32 v87, v87, v121, s[62:63]
  v_cmp_gt_i32 vcc, 16, v4
  v_cmp_gt_i32 s[62:63], 17, v4
  s_nop 1
  v_cndmask_b32 v88, v88, v121, vcc
  v_cndmask_b32 v89, v89, v121, s[62:63]
  v_cmp_gt_i32 vcc, 18, v4
  v_cmp_gt_i32 s[62:63], 19, v4
  s_nop 1
  v_cndmask_b32 v90, v90, v121, vcc
  v_cndmask_b32 v91, v91, v121, s[62:63]
  v_cmp_gt_i32 vcc, 0, v4
  v_cmp_gt_i32 s[62:63], 1, v4
  s_nop 1
  v_cndmask_b32 v92, v92, v121, vcc
  v_cndmask_b32 v93, v93, v121, s[62:63]
  v_cmp_gt_i32 vcc, 2, v4
  v_cmp_gt_i32 s[62:63], 3, v4
  s_nop 1
  v_cndmask_b32 v94, v94, v121, vcc
  v_cndmask_b32 v95, v95, v121, s[62:63]
  v_max3_f32 v6, v80, v81, v82
  v_max3_f32 v7, v84, v85, v86
  v_max_f32 v6, v6, v83
  v_max_f32 v7, v7, v87
  s_branch kvattn_kernel_pm0r
kvattn_kernel_pm1:
  s_cmp_eq_i32 s45, -2
  s_cbranch_scc1 kvattn_kernel_fin0
  s_nop 7
  v_mov_b32 v121, 0xff800000
  v_cmp_gt_i32 vcc, 0, v4
  v_cmp_gt_i32 s[62:63], 1, v4
  s_nop 1
  v_cndmask_b32 v96, v96, v121, vcc
  v_cndmask_b32 v97, v97, v121, s[62:63]
  v_cmp_gt_i32 vcc, 2, v4
  v_cmp_gt_i32 s[62:63], 3, v4
  s_nop 1
  v_cndmask_b32 v98, v98, v121, vcc
  v_cndmask_b32 v99, v99, v121, s[62:63]
  v_cmp_gt_i32 vcc, -16, v4
  v_cmp_gt_i32 s[62:63], -15, v4
  s_nop 1
  v_cndmask_b32 v100, v100, v121, vcc
  v_cndmask_b32 v101, v101, v121, s[62:63]
  v_cmp_gt_i32 vcc, -14, v4
  v_cmp_gt_i32 s[62:63], -13, v4
  s_nop 1
  v_cndmask_b32 v102, v102, v121, vcc
  v_cndmask_b32 v103, v103, v121, s[62:63]
  v_cmp_gt_i32 vcc, 16, v4
  v_cmp_gt_i32 s[62:63], 17, v4
  s_nop 1
  v_cndmask_b32 v104, v104, v121, vcc
  v_cndmask_b32 v105, v105, v121, s[62:63]
  v_cmp_gt_i32 vcc, 18, v4
  v_cmp_gt_i32 s[62:63], 19, v4
  s_nop 1
  v_cndmask_b32 v106, v106, v121, vcc
  v_cndmask_b32 v107, v107, v121, s[62:63]
  v_cmp_gt_i32 vcc, 0, v4
  v_cmp_gt_i32 s[62:63], 1, v4
  s_nop 1
  v_cndmask_b32 v108, v108, v121, vcc
  v_cndmask_b32 v109, v109, v121, s[62:63]
  v_cmp_gt_i32 vcc, 2, v4
  v_cmp_gt_i32 s[62:63], 3, v4
  s_nop 1
  v_cndmask_b32 v110, v110, v121, vcc
  v_cndmask_b32 v111, v111, v121, s[62:63]
  v_exp_f32 v8, v96
  v_exp_f32 v9, v97
  v_exp_f32 v10, v98
  v_exp_f32 v11, v99
  s_branch kvattn_kernel_pm1r
kvattn_kernel_h0:
  v_cmp_le_f32 vcc, 2.0, v120
  s_nop 7
  s_cbranch_vccz kvattn_kernel_h0_nr
  v_max3_f32 v6, v96, v97, v98
  v_max3_f32 v6, v6, v99, v104
  v_max3_f32 v6, v6, v105, v106
  v_max_f32 v6, v6, v107
  v_max3_f32 v7, v100, v101, v102
  v_max3_f32 v7, v7, v103, v108
  v_max3_f32 v7, v7, v109, v110
  v_max_f32 v7, v7, v111
  v_mov_b32 v121, v6
  v_mov_b32 v122, v7
  s_nop 1
  v_permlane16_swap_b32 v121, v6
  v_permlane16_swap_b32 v122, v7
  s_nop 0
  v_max_f32 v6, v6, v121
  v_max_f32 v7, v7, v122
  v_mov_b32 v121, v6
  v_mov_b32 v122, v7
  s_nop 1
  v_permlane32_swap_b32 v121, v6
  v_permlane32_swap_b32 v122, v7
  s_nop 0
  v_max_f32 v6, v6, v121
  v_max_f32 v7, v7, v122
  v_add_f32 v6, 0x42200000, v6
  v_max_f32 v6, 0, v6
  v_add_f32 v7, 0x42200000, v7
  v_max_f32 v7, 0, v7
  v_exp_f32 v121, -v6
  v_exp_f32 v122, -v7
  s_nop 0
  v_mul_f32 v192, v192, v121
  v_mul_f32 v193, v193, v121
  v_mul_f32 v194, v194, v121
  v_mul_f32 v195, v195, v121
  v_mul_f32 v196, v196, v122
  v_mul_f32 v197, v197, v122
  v_mul_f32 v198, v198, v122
  v_mul_f32 v199, v199, v122
  v_mul_f32 v200, v200, v121
  v_mul_f32 v201, v201, v121
  v_mul_f32 v202, v202, v121
  v_mul_f32 v203, v203, v121
  v_mul_f32 v204, v204, v122
  v_mul_f32 v205, v205, v122
  v_mul_f32 v206, v206, v122
  v_mul_f32 v207, v207, v122
  v_mul_f32 v208, v208, v121
  v_mul_f32 v209, v209, v121
  v_mul_f32 v210, v210, v121
  v_mul_f32 v211, v211, v121
  v_mul_f32 v212, v212, v122
  v_mul_f32 v213, v213, v122
  v_mul_f32 v214, v214, v122
  v_mul_f32 v215, v215, v122
  v_mul_f32 v216, v216, v121
  v_mul_f32 v217, v217, v121
  v_mul_f32 v218, v218, v121
  v_mul_f32 v219, v219, v121
  v_mul_f32 v220, v220, v122
  v_mul_f32 v221, v221, v122
  v_mul_f32 v222, v222, v122
  v_mul_f32 v223, v223, v122
  v_mul_f32 v224, v224, v121
  v_mul_f32 v225, v225, v121
  v_mul_f32 v226, v226, v121
  v_mul_f32 v227, v227, v121
  v_mul_f32 v228, v228, v122
  v_mul_f32 v229, v229, v122
  v_mul_f32 v230, v230, v122
  v_mul_f32 v231, v231, v122
  v_mul_f32 v232, v232, v121
  v_mul_f32 v233, v233, v121
  v_mul_f32 v234, v234, v121
  v_mul_f32 v235, v235, v121
  v_mul_f32 v236, v236, v122
  v_mul_f32 v237, v237, v122
  v_mul_f32 v238, v238, v122
  v_mul_f32 v239, v239, v122
  v_mul_f32 v240, v240, v121
  v_mul_f32 v241, v241, v121
  v_mul_f32 v242, v242, v121
  v_mul_f32 v243, v243, v121
  v_mul_f32 v244, v244, v122
  v_mul_f32 v245, v245, v122
  v_mul_f32 v246, v246, v122
  v_mul_f32 v247, v247, v122
  v_mul_f32 v248, v248, v121
  v_mul_f32 v249, v249, v121
  v_mul_f32 v250, v250, v121
  v_mul_f32 v251, v251, v121
  v_mul_f32 v252, v252, v122
  v_mul_f32 v253, v253, v122
  v_mul_f32 v254, v254, v122
  v_mul_f32 v255, v255, v122
  v_mul_f32 v24, v24, v121
  v_mul_f32 v25, v25, v121
  v_mul_f32 v26, v26, v121
  v_mul_f32 v27, v27, v121
  v_mul_f32 v28, v28, v122
  v_mul_f32 v29, v29, v122
  v_mul_f32 v30, v30, v122
  v_mul_f32 v31, v31, v122
  v_sub_f32 v96, v96, v6
  v_sub_f32 v97, v97, v6
  v_sub_f32 v98, v98, v6
  v_sub_f32 v99, v99, v6
  v_sub_f32 v100, v100, v7
  v_sub_f32 v101, v101, v7
  v_sub_f32 v102, v102, v7
  v_sub_f32 v103, v103, v7
  v_sub_f32 v104, v104, v6
  v_sub_f32 v105, v105, v6
  v_sub_f32 v106, v106, v6
  v_sub_f32 v107, v107, v6
  v_sub_f32 v108, v108, v7
  v_sub_f32 v109, v109, v7
  v_sub_f32 v110, v110, v7
  v_sub_f32 v111, v111, v7
  v_sub_f32 v80, v80, v6
  v_sub_f32 v81, v81, v6
  v_sub_f32 v82, v82, v6
  v_sub_f32 v83, v83, v6
  v_sub_f32 v84, v84, v7
  v_sub_f32 v85, v85, v7
  v_sub_f32 v86, v86, v7
  v_sub_f32 v87, v87, v7
  v_sub_f32 v88, v88, v6
  v_sub_f32 v89, v89, v6
  v_sub_f32 v90, v90, v6
  v_sub_f32 v91, v91, v6
  v_sub_f32 v92, v92, v7
  v_sub_f32 v93, v93, v7
  v_sub_f32 v94, v94, v7
  v_sub_f32 v95, v95, v7
  v_sub_f32 v16, v16, v6
  v_sub_f32 v17, v17, v6
  v_sub_f32 v18, v18, v6
  v_sub_f32 v19, v19, v6
  v_sub_f32 v20, v20, v7
  v_sub_f32 v21, v21, v7
  v_sub_f32 v22, v22, v7
  v_sub_f32 v23, v23, v7
  v_exp_f32 v8, v96
  v_exp_f32 v9, v97
  v_exp_f32 v10, v98
  v_exp_f32 v11, v99
  v_cvt_pk_bf16_f32 v72, v8, v9
  v_exp_f32 v8, v100
  v_exp_f32 v9, v101
  v_cvt_pk_bf16_f32 v73, v10, v11
  v_exp_f32 v10, v102
  v_exp_f32 v11, v103
  v_cvt_pk_bf16_f32 v76, v8, v9
  v_exp_f32 v8, v104
  v_exp_f32 v9, v105
  v_cvt_pk_bf16_f32 v77, v10, v11
  v_exp_f32 v10, v106
  v_exp_f32 v11, v107
  v_cvt_pk_bf16_f32 v74, v8, v9
  v_exp_f32 v8, v108
  v_exp_f32 v9, v109
  v_cvt_pk_bf16_f32 v75, v10, v11
  v_exp_f32 v10, v110
  v_exp_f32 v11, v111
  v_cvt_pk_bf16_f32 v78, v8, v9
  s_nop 0
  v_cvt_pk_bf16_f32 v79, v10, v11
  s_nop 1
  v_mfma_f32_16x16x32_bf16 v[112:115], v[12:15], v[72:75], v[24:27]
  v_mfma_f32_16x16x32_bf16 v[116:119], v[12:15], v[76:79], v[28:31]
kvattn_kernel_h0_nr:
  s_cmp_eq_u32 s46, 2.0
  s_cbranch_scc1 kvattn_kernel_h0_ret
  s_cmp_eq_u32 s47, 1
  s_cbranch_scc1 kvattn_kernel_fin1
  s_mov_b32 s47, 1
  v_mov_b32 v121, 0xff800000
  v_cmp_gt_i32 s[54:55], 0, v4
  v_cmp_gt_i32 s[56:57], 1, v4
  v_cmp_gt_i32 s[58:59], 2, v4
  v_cmp_gt_i32 s[60:61], 3, v4
  s_nop 0
  v_cndmask_b32 v80, v80, v121, s[54:55]
  v_cndmask_b32 v81, v81, v121, s[56:57]
  v_cndmask_b32 v82, v82, v121, s[58:59]
  v_cndmask_b32 v83, v83, v121, s[60:61]
  v_cmp_gt_i32 s[54:55], -16, v4
  v_cmp_gt_i32 s[56:57], -15, v4
  v_cmp_gt_i32 s[58:59], -14, v4
  v_cmp_gt_i32 s[60:61], -13, v4
  s_nop 0
  v_cndmask_b32 v84, v84, v121, s[54:55]
  v_cndmask_b32 v85, v85, v121, s[56:57]
  v_cndmask_b32 v86, v86, v121, s[58:59]
  v_cndmask_b32 v87, v87, v121, s[60:61]
  v_cmp_gt_i32 s[54:55], 16, v4
  v_cmp_gt_i32 s[56:57], 17, v4
  v_cmp_gt_i32 s[58:59], 18, v4
  v_cmp_gt_i32 s[60:61], 19, v4
  s_nop 0
  v_cndmask_b32 v88, v88, v121, s[54:55]
  v_cndmask_b32 v89, v89, v121, s[56:57]
  v_cndmask_b32 v90, v90, v121, s[58:59]
  v_cndmask_b32 v91, v91, v121, s[60:61]
  v_cmp_gt_i32 s[54:55], 0, v4
  v_cmp_gt_i32 s[56:57], 1, v4
  v_cmp_gt_i32 s[58:59], 2, v4
  v_cmp_gt_i32 s[60:61], 3, v4
  s_nop 0
  v_cndmask_b32 v92, v92, v121, s[54:55]
  v_cndmask_b32 v93, v93, v121, s[56:57]
  v_cndmask_b32 v94, v94, v121, s[58:59]
  v_cndmask_b32 v95, v95, v121, s[60:61]
kvattn_kernel_h0_ret:
  v_exp_f32 v8, v80
  v_exp_f32 v9, v81
  v_exp_f32 v10, v82
  s_cmp_eq_u32 s48, 0
  s_cbranch_scc1 kvattn_kernel_retB0
  s_cmp_eq_u32 s48, 1
  s_cbranch_scc1 kvattn_kernel_retB2
  s_cmp_eq_u32 s48, 2
  s_cbranch_scc1 kvattn_kernel_retB4
  s_cmp_eq_u32 s48, 3
  s_cbranch_scc1 kvattn_kernel_retB6
  s_cmp_eq_u32 s48, 4
  s_cbranch_scc1 kvattn_kernel_retA0
  s_cmp_eq_u32 s48, 5
  s_cbranch_scc1 kvattn_kernel_retA2
  s_cmp_eq_u32 s48, 6
  s_cbranch_scc1 kvattn_kernel_retA4
  s_branch kvattn_kernel_retA6
kvattn_kernel_h1:
  v_cmp_le_f32 vcc, 2.0, v120
  s_nop 7
  s_cbranch_vccz kvattn_kernel_h1_nr
  v_max3_f32 v6, v80, v81, v82
  v_max3_f32 v6, v6, v83, v88
  v_max3_f32 v6, v6, v89, v90
  v_max_f32 v6, v6, v91
  v_max3_f32 v7, v84, v85, v86
  v_max3_f32 v7, v7, v87, v92
  v_max3_f32 v7, v7, v93, v94
  v_max_f32 v7, v7, v95
  v_mov_b32 v121, v6
  v_mov_b32 v122, v7
  s_nop 1
  v_permlane16_swap_b32 v121, v6
  v_permlane16_swap_b32 v122, v7
  s_nop 0
  v_max_f32 v6, v6, v121
  v_max_f32 v7, v7, v122
  v_mov_b32 v121, v6
  v_mov_b32 v122, v7
  s_nop 1
  v_permlane32_swap_b32 v121, v6
  v_permlane32_swap_b32 v122, v7
  s_nop 0
  v_max_f32 v6, v6, v121
  v_max_f32 v7, v7, v122
  v_add_f32 v6, 0x42200000, v6
  v_max_f32 v6, 0, v6
  v_add_f32 v7, 0x42200000, v7
  v_max_f32 v7, 0, v7
  v_exp_f32 v121, -v6
  v_exp_f32 v122, -v7
  s_nop 0
  v_mul_f32 v192, v192, v121
  v_mul_f32 v193, v193, v121
  v_mul_f32 v194, v194, v121
  v_mul_f32 v195, v195, v121
  v_mul_f32 v196, v196, v122
  v_mul_f32 v197, v197, v122
  v_mul_f32 v198, v198, v122
  v_mul_f32 v199, v199, v122
  v_mul_f32 v200, v200, v121
  v_mul_f32 v201, v201, v121
  v_mul_f32 v202, v202, v121
  v_mul_f32 v203, v203, v121
  v_mul_f32 v204, v204, v122
  v_mul_f32 v205, v205, v122
  v_mul_f32 v206, v206, v122
  v_mul_f32 v207, v207, v122
  v_mul_f32 v208, v208, v121
  v_mul_f32 v209, v209, v121
  v_mul_f32 v210, v210, v121
  v_mul_f32 v211, v211, v121
  v_mul_f32 v212, v212, v122
  v_mul_f32 v213, v213, v122
  v_mul_f32 v214, v214, v122
  v_mul_f32 v215, v215, v122
  v_mul_f32 v216, v216, v121
  v_mul_f32 v217, v217, v121
  v_mul_f32 v218, v218, v121
  v_mul_f32 v219, v219, v121
  v_mul_f32 v220, v220, v122
  v_mul_f32 v221, v221, v122
  v_mul_f32 v222, v222, v122
  v_mul_f32 v223, v223, v122
  v_mul_f32 v224, v224, v121
  v_mul_f32 v225, v225, v121
  v_mul_f32 v226, v226, v121
  v_mul_f32 v227, v227, v121
  v_mul_f32 v228, v228, v122
  v_mul_f32 v229, v229, v122
  v_mul_f32 v230, v230, v122
  v_mul_f32 v231, v231, v122
  v_mul_f32 v232, v232, v121
  v_mul_f32 v233, v233, v121
  v_mul_f32 v234, v234, v121
  v_mul_f32 v235, v235, v121
  v_mul_f32 v236, v236, v122
  v_mul_f32 v237, v237, v122
  v_mul_f32 v238, v238, v122
  v_mul_f32 v239, v239, v122
  v_mul_f32 v240, v240, v121
  v_mul_f32 v241, v241, v121
  v_mul_f32 v242, v242, v121
  v_mul_f32 v243, v243, v121
  v_mul_f32 v244, v244, v122
  v_mul_f32 v245, v245, v122
  v_mul_f32 v246, v246, v122
  v_mul_f32 v247, v247, v122
  v_mul_f32 v248, v248, v121
  v_mul_f32 v249, v249, v121
  v_mul_f32 v250, v250, v121
  v_mul_f32 v251, v251, v121
  v_mul_f32 v252, v252, v122
  v_mul_f32 v253, v253, v122
  v_mul_f32 v254, v254, v122
  v_mul_f32 v255, v255, v122
  v_mul_f32 v112, v112, v121
  v_mul_f32 v113, v113, v121
  v_mul_f32 v114, v114, v121
  v_mul_f32 v115, v115, v121
  v_mul_f32 v116, v116, v122
  v_mul_f32 v117, v117, v122
  v_mul_f32 v118, v118, v122
  v_mul_f32 v119, v119, v122
  v_sub_f32 v80, v80, v6
  v_sub_f32 v81, v81, v6
  v_sub_f32 v82, v82, v6
  v_sub_f32 v83, v83, v6
  v_sub_f32 v84, v84, v7
  v_sub_f32 v85, v85, v7
  v_sub_f32 v86, v86, v7
  v_sub_f32 v87, v87, v7
  v_sub_f32 v88, v88, v6
  v_sub_f32 v89, v89, v6
  v_sub_f32 v90, v90, v6
  v_sub_f32 v91, v91, v6
  v_sub_f32 v92, v92, v7
  v_sub_f32 v93, v93, v7
  v_sub_f32 v94, v94, v7
  v_sub_f32 v95, v95, v7
  v_sub_f32 v96, v96, v6
  v_sub_f32 v97, v97, v6
  v_sub_f32 v98, v98, v6
  v_sub_f32 v99, v99, v6
  v_sub_f32 v100, v100, v7
  v_sub_f32 v101, v101, v7
  v_sub_f32 v102, v102, v7
  v_sub_f32 v103, v103, v7
  v_sub_f32 v104, v104, v6
  v_sub_f32 v105, v105, v6
  v_sub_f32 v106, v106, v6
  v_sub_f32 v107, v107, v6
  v_sub_f32 v108, v108, v7
  v_sub_f32 v109, v109, v7
  v_sub_f32 v110, v110, v7
  v_sub_f32 v111, v111, v7
  v_sub_f32 v16, v16, v6
  v_sub_f32 v17, v17, v6
  v_sub_f32 v18, v18, v6
  v_sub_f32 v19, v19, v6
  v_sub_f32 v20, v20, v7
  v_sub_f32 v21, v21, v7
  v_sub_f32 v22, v22, v7
  v_sub_f32 v23, v23, v7
  v_exp_f32 v8, v80
  v_exp_f32 v9, v81
  v_exp_f32 v10, v82
  v_exp_f32 v11, v83
  v_cvt_pk_bf16_f32 v64, v8, v9
  v_exp_f32 v8, v84
  v_exp_f32 v9, v85
  v_cvt_pk_bf16_f32 v65, v10, v11
  v_exp_f32 v10, v86
  v_exp_f32 v11, v87
  v_cvt_pk_bf16_f32 v68, v8, v9
  v_exp_f32 v8, v88
  v_exp_f32 v9, v89
  v_cvt_pk_bf16_f32 v69, v10, v11
  v_exp_f32 v10, v90
  v_exp_f32 v11, v91
  v_cvt_pk_bf16_f32 v66, v8, v9
  v_exp_f32 v8, v92
  v_exp_f32 v9, v93
  v_cvt_pk_bf16_f32 v67, v10, v11
  v_exp_f32 v10, v94
  v_exp_f32 v11, v95
  v_cvt_pk_bf16_f32 v70, v8, v9
  s_nop 0
  v_cvt_pk_bf16_f32 v71, v10, v11
  s_nop 1
  v_mfma_f32_16x16x32_bf16 v[24:27], v[12:15], v[64:67], v[112:115]
  v_mfma_f32_16x16x32_bf16 v[28:31], v[12:15], v[68:71], v[116:119]
kvattn_kernel_h1_nr:
  s_cmp_eq_u32 s46, 2.0
  s_cbranch_scc1 kvattn_kernel_h1_ret
  s_cmp_eq_u32 s47, 1
  s_cbranch_scc1 kvattn_kernel_fin0
  s_mov_b32 s47, 1
  v_mov_b32 v121, 0xff800000
  v_cmp_gt_i32 s[54:55], 0, v4
  v_cmp_gt_i32 s[56:57], 1, v4
  v_cmp_gt_i32 s[58:59], 2, v4
  v_cmp_gt_i32 s[60:61], 3, v4
  s_nop 0
  v_cndmask_b32 v96, v96, v121, s[54:55]
  v_cndmask_b32 v97, v97, v121, s[56:57]
  v_cndmask_b32 v98, v98, v121, s[58:59]
  v_cndmask_b32 v99, v99, v121, s[60:61]
  v_cmp_gt_i32 s[54:55], -16, v4
  v_cmp_gt_i32 s[56:57], -15, v4
  v_cmp_gt_i32 s[58:59], -14, v4
  v_cmp_gt_i32 s[60:61], -13, v4
  s_nop 0
  v_cndmask_b32 v100, v100, v121, s[54:55]
  v_cndmask_b32 v101, v101, v121, s[56:57]
  v_cndmask_b32 v102, v102, v121, s[58:59]
  v_cndmask_b32 v103, v103, v121, s[60:61]
  v_cmp_gt_i32 s[54:55], 16, v4
  v_cmp_gt_i32 s[56:57], 17, v4
  v_cmp_gt_i32 s[58:59], 18, v4
  v_cmp_gt_i32 s[60:61], 19, v4
  s_nop 0
  v_cndmask_b32 v104, v104, v121, s[54:55]
  v_cndmask_b32 v105, v105, v121, s[56:57]
  v_cndmask_b32 v106, v106, v121, s[58:59]
  v_cndmask_b32 v107, v107, v121, s[60:61]
  v_cmp_gt_i32 s[54:55], 0, v4
  v_cmp_gt_i32 s[56:57], 1, v4
  v_cmp_gt_i32 s[58:59], 2, v4
  v_cmp_gt_i32 s[60:61], 3, v4
  s_nop 0
  v_cndmask_b32 v108, v108, v121, s[54:55]
  v_cndmask_b32 v109, v109, v121, s[56:57]
  v_cndmask_b32 v110, v110, v121, s[58:59]
  v_cndmask_b32 v111, v111, v121, s[60:61]
kvattn_kernel_h1_ret:
  v_exp_f32 v8, v96
  v_exp_f32 v9, v97
  v_exp_f32 v10, v98
  s_cmp_eq_u32 s48, 0
  s_cbranch_scc1 kvattn_kernel_retB1
  s_cmp_eq_u32 s48, 1
  s_cbranch_scc1 kvattn_kernel_retB3
  s_cmp_eq_u32 s48, 2
  s_cbranch_scc1 kvattn_kernel_retB5
  s_cmp_eq_u32 s48, 3
  s_cbranch_scc1 kvattn_kernel_retB7
  s_cmp_eq_u32 s48, 4
  s_cbranch_scc1 kvattn_kernel_retA1
  s_cmp_eq_u32 s48, 5
  s_cbranch_scc1 kvattn_kernel_retA3
  s_cmp_eq_u32 s48, 6
  s_cbranch_scc1 kvattn_kernel_retA5
  s_branch kvattn_kernel_retA7
kvattn_kernel_fin1:
  s_cmp_eq_u32 s52, 0
  s_cbranch_scc1 kvattn_kernel_fin1_b
  s_cmp_ge_u32 s40, s42
  s_cselect_b32 s53, 1, 0
  s_cbranch_scc1 kvattn_kernel_fin1_b
  s_add_u32 s49, s40, 32768
  s_and_b32 s49, s49, 0xc000
  s_add_u32 m0, s49, s43
  s_nop 0
  buffer_load_dwordx4 v1, s[32:35], s40 offen offset:0 sc1 lds
  buffer_load_dwordx4 v1, s[32:35], s40 offen offset:1024 sc1 lds
  buffer_load_dwordx4 v1, s[32:35], s40 offen offset:2048 sc1 lds
  buffer_load_dwordx4 v1, s[32:35], s40 offen offset:3072 sc1 lds
  s_add_u32 s40, s40, 0x4000
  s_and_b32 s49, s41, 0xc000
  s_add_u32 m0, s49, s44
  s_nop 0
  buffer_load_dwordx4 v1, s[36:39], s41 offen offset:0 sc1 lds
  buffer_load_dwordx4 v1, s[36:39], s41 offen offset:1024 sc1 lds
  buffer_load_dwordx4 v1, s[36:39], s41 offen offset:2048 sc1 lds
  buffer_load_dwordx4 v1, s[36:39], s41 offen offset:3072 sc1 lds
  s_add_u32 s41, s41, 0x4000
  s_branch kvattn_kernel_fin1_c
kvattn_kernel_fin1_b:
  s_setprio 2
kvattn_kernel_fin1_c:
  s_waitcnt lgkmcnt(0)
  s_nop 3
  v_mfma_f32_16x16x32_bf16 v[192:195], v[128:131], v[72:75], v[192:195]
  s_mov_b32 s54, 0x10000
  s_mov_b32 s55, 0x14000
  v_bfe_u32 v8, v0, 2, 2
  v_lshrrev_b32 v9, 4, v0
  v_mfma_f32_16x16x32_bf16 v[196:199], v[128:131], v[76:79], v[196:199]
  s_add_u32 s56, s42, 32768
  s_and_b32 s56, s56, 0xc000
  v_lshl_add_u32 v9, v9, 2, v8
  v_lshlrev_b32 v9, 8, v9
  v_mfma_f32_16x16x32_bf16 v[200:203], v[132:135], v[72:75], v[200:203]
  s_add_u32 s56, s56, 98304
  s_add_u32 s57, s42, 0
  v_bfe_u32 v8, v0, 2, 3
  v_lshl_add_u32 v9, v8, 5, v9
  v_mfma_f32_16x16x32_bf16 v[204:207], v[132:135], v[76:79], v[204:207]
  s_and_b32 s57, s57, 0xc000
  s_add_u32 s58, s42, 49152
  v_and_b32 v8, 3, v0
  v_lshl_add_u32 v56, v8, 3, v9
  v_mfma_f32_16x16x32_bf16 v[208:211], v[136:139], v[72:75], v[208:211]
  s_and_b32 s58, s58, 0xc000
  s_add_u32 s58, s58, 98304
  v_xor_b32 v57, 32, v56
  v_xor_b32 v58, 64, v56
  v_mfma_f32_16x16x32_bf16 v[212:215], v[136:139], v[76:79], v[212:215]
  s_add_u32 s60, s42, 16384
  s_and_b32 s60, s60, 0xc000
  v_xor_b32 v59, 96, v56
  v_xor_b32 v60, 128, v56
  v_mfma_f32_16x16x32_bf16 v[216:219], v[140:143], v[72:75], v[216:219]
  s_add_u32 s59, s42, 65536
  s_and_b32 s59, s59, 0xc000
  v_xor_b32 v61, 160, v56
  v_xor_b32 v62, 192, v56
  v_mfma_f32_16x16x32_bf16 v[220:223], v[140:143], v[76:79], v[220:223]
  s_add_u32 s59, s59, 98304
  s_add_u32 s61, s42, 32768
  v_xor_b32 v63, 224, v56
  v_and_b32 v10, 3, v0
  v_mfma_f32_16x16x32_bf16 v[224:227], v[144:147], v[72:75], v[224:227]
  v_rcp_f32 v120, v112
  s_and_b32 s61, s61, 0xc000
  s_mov_b32 s48, 0
  v_lshl_add_u32 v10, v10, 3, s9
  v_mov_b32 v4, s85
  v_mfma_f32_16x16x32_bf16 v[228:231], v[144:147], v[76:79], v[228:231]
  v_rcp_f32 v122, v116
  s_mov_b32 s47, 0
  s_mov_b32 s45, 0
  v_mfma_f32_16x16x32_bf16 v[232:235], v[148:151], v[72:75], v[232:235]
  v_mfma_f32_16x16x32_bf16 v[236:239], v[148:151], v[76:79], v[236:239]
  v_mfma_f32_16x16x32_bf16 v[240:243], v[152:155], v[72:75], v[240:243]
  v_mfma_f32_16x16x32_bf16 v[244:247], v[152:155], v[76:79], v[244:247]
  v_mfma_f32_16x16x32_bf16 v[248:251], v[156:159], v[72:75], v[248:251]
  v_mfma_f32_16x16x32_bf16 v[252:255], v[156:159], v[76:79], v[252:255]
  s_branch kvattn_kernel_epi
kvattn_kernel_fin0:
  s_cmp_eq_u32 s52, 0
  s_cbranch_scc1 kvattn_kernel_fin0_b
  s_mov_b32 s53, 0
  s_and_b32 s49, s41, 0xc000
  s_add_u32 m0, s49, s44
  s_nop 0
  buffer_load_dwordx4 v1, s[36:39], s41 offen offset:0 sc1 lds
  buffer_load_dwordx4 v1, s[36:39], s41 offen offset:1024 sc1 lds
  buffer_load_dwordx4 v1, s[36:39], s41 offen offset:2048 sc1 lds
  buffer_load_dwordx4 v1, s[36:39], s41 offen offset:3072 sc1 lds
  s_add_u32 s41, s41, 0x4000
  s_branch kvattn_kernel_fin0_c
kvattn_kernel_fin0_b:
  s_setprio 2
kvattn_kernel_fin0_c:
  s_waitcnt lgkmcnt(0)
  s_nop 3
  v_mfma_f32_16x16x32_bf16 v[192:195], v[128:131], v[64:67], v[192:195]
  s_mov_b32 s54, 0x10000
  s_mov_b32 s55, 0x14000
  v_bfe_u32 v8, v0, 2, 2
  v_lshrrev_b32 v9, 4, v0
  v_mfma_f32_16x16x32_bf16 v[196:199], v[128:131], v[68:71], v[196:199]
  s_add_u32 s56, s42, 32768
  s_and_b32 s56, s56, 0xc000
  v_lshl_add_u32 v9, v9, 2, v8
  v_lshlrev_b32 v9, 8, v9
  v_mfma_f32_16x16x32_bf16 v[200:203], v[132:135], v[64:67], v[200:203]
  s_add_u32 s56, s56, 98304
  s_add_u32 s57, s42, 0
  v_bfe_u32 v8, v0, 2, 3
  v_lshl_add_u32 v9, v8, 5, v9
  v_mfma_f32_16x16x32_bf16 v[204:207], v[132:135], v[68:71], v[204:207]
  s_and_b32 s57, s57, 0xc000
  s_add_u32 s58, s42, 49152
  v_and_b32 v8, 3, v0
  v_lshl_add_u32 v56, v8, 3, v9
  v_mfma_f32_16x16x32_bf16 v[208:211], v[136:139], v[64:67], v[208:211]
  s_and_b32 s58, s58, 0xc000
  s_add_u32 s58, s58, 98304
  v_xor_b32 v57, 32, v56
  v_xor_b32 v58, 64, v56
  v_mfma_f32_16x16x32_bf16 v[212:215], v[136:139], v[68:71], v[212:215]
  s_add_u32 s60, s42, 16384
  s_and_b32 s60, s60, 0xc000
  v_xor_b32 v59, 96, v56
  v_xor_b32 v60, 128, v56
  v_mfma_f32_16x16x32_bf16 v[216:219], v[140:143], v[64:67], v[216:219]
  s_add_u32 s59, s42, 65536
  s_and_b32 s59, s59, 0xc000
  v_xor_b32 v61, 160, v56
  v_xor_b32 v62, 192, v56
  v_mfma_f32_16x16x32_bf16 v[220:223], v[140:143], v[68:71], v[220:223]
  s_add_u32 s59, s59, 98304
  s_add_u32 s61, s42, 32768
  v_xor_b32 v63, 224, v56
  v_and_b32 v10, 3, v0
  v_mfma_f32_16x16x32_bf16 v[224:227], v[144:147], v[64:67], v[224:227]
  v_rcp_f32 v120, v24
  s_and_b32 s61, s61, 0xc000
  s_mov_b32 s48, 0
  v_lshl_add_u32 v10, v10, 3, s9
  v_mov_b32 v4, s85
  v_mfma_f32_16x16x32_bf16 v[228:231], v[144:147], v[68:71], v[228:231]
  v_rcp_f32 v122, v28
  s_mov_b32 s47, 0
  s_mov_b32 s45, 0
  v_mfma_f32_16x16x32_bf16 v[232:235], v[148:151], v[64:67], v[232:235]
  v_mfma_f32_16x16x32_bf16 v[236:239], v[148:151], v[68:71], v[236:239]
  v_mfma_f32_16x16x32_bf16 v[240:243], v[152:155], v[64:67], v[240:243]
  v_mfma_f32_16x16x32_bf16 v[244:247], v[152:155], v[68:71], v[244:247]
  v_mfma_f32_16x16x32_bf16 v[248:251], v[156:159], v[64:67], v[248:251]
  v_mfma_f32_16x16x32_bf16 v[252:255], v[156:159], v[68:71], v[252:255]
kvattn_kernel_epi:
  s_and_b32 s50, s12, 5
  s_cmp_eq_u32 s50, 0
  s_cbranch_scc0 kvattn_kernel_epi2
  s_barrier
kvattn_kernel_epi2:
  s_nop 1
  v_mul_f32 v192, v120, v192
  v_mul_f32 v193, v120, v193
  v_mul_f32 v194, v120, v194
  v_mul_f32 v195, v120, v195
  v_mul_f32 v200, v120, v200
  v_mul_f32 v201, v120, v201
  v_mul_f32 v202, v120, v202
  v_mul_f32 v203, v120, v203
  v_cvt_pk_bf16_f32 v128, v192, v193
  v_cvt_pk_bf16_f32 v129, v194, v195
  v_cvt_pk_bf16_f32 v130, v200, v201
  v_cvt_pk_bf16_f32 v131, v202, v203
  buffer_store_dwordx4 v[128:131], v5, s[28:31], s6 offen offset:0 sc1
  v_mul_f32 v196, v122, v196
  v_mul_f32 v197, v122, v197
  v_mul_f32 v198, v122, v198
  v_mul_f32 v199, v122, v199
  v_mul_f32 v204, v122, v204
  v_mul_f32 v205, v122, v205
  v_mul_f32 v206, v122, v206
  v_mul_f32 v207, v122, v207
  v_cvt_pk_bf16_f32 v132, v196, v197
  v_cvt_pk_bf16_f32 v133, v198, v199
  v_cvt_pk_bf16_f32 v134, v204, v205
  v_cvt_pk_bf16_f32 v135, v206, v207
  buffer_store_dwordx4 v[132:135], v5, s[28:31], s6 offen offset:1024 sc1
  v_mul_f32 v208, v120, v208
  v_mul_f32 v209, v120, v209
  v_mul_f32 v210, v120, v210
  v_mul_f32 v211, v120, v211
  v_mul_f32 v216, v120, v216
  v_mul_f32 v217, v120, v217
  v_mul_f32 v218, v120, v218
  v_mul_f32 v219, v120, v219
  v_cvt_pk_bf16_f32 v136, v208, v209
  v_cvt_pk_bf16_f32 v137, v210, v211
  v_cvt_pk_bf16_f32 v138, v216, v217
  v_cvt_pk_bf16_f32 v139, v218, v219
  buffer_store_dwordx4 v[136:139], v5, s[28:31], s6 offen offset:2048 sc1
  v_mul_f32 v212, v122, v212
  v_mul_f32 v213, v122, v213
  v_mul_f32 v214, v122, v214
  v_mul_f32 v215, v122, v215
  v_mul_f32 v220, v122, v220
  v_mul_f32 v221, v122, v221
  v_mul_f32 v222, v122, v222
  v_mul_f32 v223, v122, v223
  v_cvt_pk_bf16_f32 v140, v212, v213
  v_cvt_pk_bf16_f32 v141, v214, v215
  v_cvt_pk_bf16_f32 v142, v220, v221
  v_cvt_pk_bf16_f32 v143, v222, v223
  buffer_store_dwordx4 v[140:143], v5, s[28:31], s6 offen offset:3072 sc1
  v_mul_f32 v224, v120, v224
  v_mul_f32 v225, v120, v225
  v_mul_f32 v226, v120, v226
  v_mul_f32 v227, v120, v227
  v_mul_f32 v232, v120, v232
  v_mul_f32 v233, v120, v233
  v_mul_f32 v234, v120, v234
  v_mul_f32 v235, v120, v235
  v_cvt_pk_bf16_f32 v144, v224, v225
  v_cvt_pk_bf16_f32 v145, v226, v227
  v_cvt_pk_bf16_f32 v146, v232, v233
  v_cvt_pk_bf16_f32 v147, v234, v235
  buffer_store_dwordx4 v[144:147], v5, s[28:31], s7 offen offset:0 sc1
  v_mul_f32 v228, v122, v228
  v_mul_f32 v229, v122, v229
  v_mul_f32 v230, v122, v230
  v_mul_f32 v231, v122, v231
  v_mul_f32 v236, v122, v236
  v_mul_f32 v237, v122, v237
  v_mul_f32 v238, v122, v238
  v_mul_f32 v239, v122, v239
  v_cvt_pk_bf16_f32 v148, v228, v229
  v_cvt_pk_bf16_f32 v149, v230, v231
  v_cvt_pk_bf16_f32 v150, v236, v237
  v_cvt_pk_bf16_f32 v151, v238, v239
  buffer_store_dwordx4 v[148:151], v5, s[28:31], s7 offen offset:1024 sc1
  v_mul_f32 v240, v120, v240
  v_mul_f32 v241, v120, v241
  v_mul_f32 v242, v120, v242
  v_mul_f32 v243, v120, v243
  v_mul_f32 v248, v120, v248
  v_mul_f32 v249, v120, v249
  v_mul_f32 v250, v120, v250
  v_mul_f32 v251, v120, v251
  v_cvt_pk_bf16_f32 v152, v240, v241
  v_cvt_pk_bf16_f32 v153, v242, v243
  v_cvt_pk_bf16_f32 v154, v248, v249
  v_cvt_pk_bf16_f32 v155, v250, v251
  buffer_store_dwordx4 v[152:155], v5, s[28:31], s7 offen offset:2048 sc1
  v_mul_f32 v244, v122, v244
  v_mul_f32 v245, v122, v245
  v_mul_f32 v246, v122, v246
  v_mul_f32 v247, v122, v247
  v_mul_f32 v252, v122, v252
  v_mul_f32 v253, v122, v253
  v_mul_f32 v254, v122, v254
  v_mul_f32 v255, v122, v255
  v_cvt_pk_bf16_f32 v156, v244, v245
  v_cvt_pk_bf16_f32 v157, v246, v247
  v_cvt_pk_bf16_f32 v158, v252, v253
  v_cvt_pk_bf16_f32 v159, v254, v255
  buffer_store_dwordx4 v[156:159], v5, s[28:31], s7 offen offset:3072 sc1
  s_cmp_eq_u32 s52, 0
  s_cbranch_scc1 kvattn_kernel_obs
  v_lshrrev_b32 v8, 4, v0
  v_lshlrev_b32 v9, 1, v8
  v_and_b32 v6, 15, v0
  v_xor_b32 v6, v6, v9
  v_lshlrev_b32 v6, 4, v6
  v_lshl_add_u32 v6, v8, 10, v6
  v_xor_b32 v7, 128, v6
  v_mov_b32 v8, 0
  v_mov_b32 v9, 0
  s_cmp_eq_u32 s53, 1
  s_cbranch_scc1 kvattn_kernel_ld_v1
  s_waitcnt vmcnt(12)
  s_barrier
kvattn_kernel_ld_mid:
  s_cmp_ge_u32 s40, s42
  s_cbranch_scc1 kvattn_kernel_ld_v1
  s_cmp_eq_u32 s47, 0
  s_cbranch_scc0 kvattn_kernel_npa
  v_and_b32 v3, 3, v0
  v_lshlrev_b32 v3, 13, v3
  buffer_load_dword v3, v3, s[96:99], s8 offen sc1
kvattn_kernel_npa:
  s_add_u32 s49, s40, 32768
  s_and_b32 s49, s49, 0xc000
  s_add_u32 m0, s49, s43
  s_nop 0
  buffer_load_dwordx4 v1, s[32:35], s40 offen offset:0 sc1 lds
  buffer_load_dwordx4 v1, s[32:35], s40 offen offset:1024 sc1 lds
  buffer_load_dwordx4 v1, s[32:35], s40 offen offset:2048 sc1 lds
  buffer_load_dwordx4 v1, s[32:35], s40 offen offset:3072 sc1 lds
  s_add_u32 s40, s40, 0x4000
  s_and_b32 s49, s41, 0xc000
  s_add_u32 m0, s49, s44
  s_nop 0
  buffer_load_dwordx4 v1, s[36:39], s41 offen offset:0 sc1 lds
  buffer_load_dwordx4 v1, s[36:39], s41 offen offset:1024 sc1 lds
  buffer_load_dwordx4 v1, s[36:39], s41 offen offset:2048 sc1 lds
  buffer_load_dwordx4 v1, s[36:39], s41 offen offset:3072 sc1 lds
  s_add_u32 s41, s41, 0x4000
  s_cmp_eq_u32 s47, 7
  s_cbranch_scc0 kvattn_kernel_ld_x
  s_waitcnt vmcnt(4)
  s_barrier
  s_branch kvattn_kernel_ld_mid
kvattn_kernel_ld_x:
  s_cmp_eq_u32 s45, 0
  s_cbranch_scc0 kvattn_kernel_xw0a
  s_add_u32 s50, s18, 0
  s_and_b32 s50, s50, 3
  s_lshl_b32 s50, s50, 17
  s_add_u32 s50, s50, s4
  s_add_u32 m0, s54, s44
  s_add_u32 s49, s50, 0
  buffer_load_dwordx4 v6, s[20:23], s49 offen offset:0 lds
  s_add_u32 s49, s50, 3072
  buffer_load_dwordx4 v7, s[20:23], s49 offen offset:1024 lds
  s_add_u32 s49, s50, 6144
  buffer_load_dwordx4 v6, s[20:23], s49 offen offset:2048 lds
  s_add_u32 s49, s50, 9216
  buffer_load_dwordx4 v7, s[20:23], s49 offen offset:3072 lds
  s_mov_b32 s45, 1
  s_branch kvattn_kernel_xea
kvattn_kernel_xw0a:
  s_cmp_eq_u32 s45, 1
  s_cbranch_scc0 kvattn_kernel_xw1a
  s_add_u32 s50, s18, 0
  s_and_b32 s50, s50, 3
  s_lshl_b32 s50, s50, 17
  s_add_u32 s50, s50, s4
  s_add_u32 m0, s55, s44
  s_add_u32 s49, s50, 65536
  buffer_load_dwordx4 v6, s[20:23], s49 offen offset:0 lds
  s_add_u32 s49, s50, 68608
  buffer_load_dwordx4 v7, s[20:23], s49 offen offset:1024 lds
  s_add_u32 s49, s50, 71680
  buffer_load_dwordx4 v6, s[20:23], s49 offen offset:2048 lds
  s_add_u32 s49, s50, 74752
  buffer_load_dwordx4 v7, s[20:23], s49 offen offset:3072 lds
  s_mov_b32 s45, 2
  s_branch kvattn_kernel_xea
kvattn_kernel_xw1a:
  s_cmp_eq_u32 s47, 1
  s_cbranch_scc0 kvattn_kernel_x0a
  s_add_u32 s50, s18, 1
  s_and_b32 s50, s50, 3
  s_lshl_b32 s50, s50, 13
  s_add_u32 s50, s50, s5
  buffer_load_dwordx4 v[160:163], v5, s[28:31], s50 offen offset:0 sc1
  buffer_load_dwordx4 v[164:167], v5, s[28:31], s50 offen offset:1024 sc1
  buffer_load_dwordx4 v[168:171], v5, s[28:31], s50 offen offset:2048 sc1
  buffer_load_dwordx4 v[172:175], v5, s[28:31], s50 offen offset:3072 sc1
  s_mov_b32 s47, 2
  s_branch kvattn_kernel_xea
kvattn_kernel_x0a:
  s_cmp_eq_u32 s47, 2
  s_cbranch_scc0 kvattn_kernel_x1a
  s_add_u32 s50, s18, 1
  s_and_b32 s50, s50, 3
  s_lshl_b32 s50, s50, 13
  s_add_u32 s50, s50, s5
  s_add_u32 s50, s50, 4096
  buffer_load_dwordx4 v[176:179], v5, s[28:31], s50 offen offset:0 sc1
  buffer_load_dwordx4 v[180:183], v5, s[28:31], s50 offen offset:1024 sc1
  buffer_load_dwordx4 v[184:187], v5, s[28:31], s50 offen offset:2048 sc1
  buffer_load_dwordx4 v[188:191], v5, s[28:31], s50 offen offset:3072 sc1
  s_mov_b32 s47, 3
  s_branch kvattn_kernel_xea
kvattn_kernel_x1a:
  s_cmp_eq_u32 s47, 3
  s_cbranch_scc0 kvattn_kernel_x2a
  s_add_u32 s50, s18, 2
  s_and_b32 s50, s50, 3
  s_lshl_b32 s50, s50, 13
  s_add_u32 s50, s50, s5
  buffer_load_dwordx4 v[192:195], v5, s[28:31], s50 offen offset:0 sc1
  buffer_load_dwordx4 v[196:199], v5, s[28:31], s50 offen offset:1024 sc1
  buffer_load_dwordx4 v[200:203], v5, s[28:31], s50 offen offset:2048 sc1
  buffer_load_dwordx4 v[204:207], v5, s[28:31], s50 offen offset:3072 sc1
  s_mov_b32 s47, 4
  s_branch kvattn_kernel_xea
kvattn_kernel_x2a:
  s_cmp_eq_u32 s47, 4
  s_cbranch_scc0 kvattn_kernel_x3a
  s_add_u32 s50, s18, 2
  s_and_b32 s50, s50, 3
  s_lshl_b32 s50, s50, 13
  s_add_u32 s50, s50, s5
  s_add_u32 s50, s50, 4096
  buffer_load_dwordx4 v[208:211], v5, s[28:31], s50 offen offset:0 sc1
  buffer_load_dwordx4 v[212:215], v5, s[28:31], s50 offen offset:1024 sc1
  buffer_load_dwordx4 v[216:219], v5, s[28:31], s50 offen offset:2048 sc1
  buffer_load_dwordx4 v[220:223], v5, s[28:31], s50 offen offset:3072 sc1
  s_mov_b32 s47, 5
  s_branch kvattn_kernel_xea
kvattn_kernel_x3a:
  s_cmp_eq_u32 s47, 5
  s_cbranch_scc0 kvattn_kernel_x4a
  s_add_u32 s50, s18, 3
  s_and_b32 s50, s50, 3
  s_lshl_b32 s50, s50, 13
  s_add_u32 s50, s50, s5
  buffer_load_dwordx4 v[224:227], v5, s[28:31], s50 offen offset:0 sc1
  buffer_load_dwordx4 v[228:231], v5, s[28:31], s50 offen offset:1024 sc1
  buffer_load_dwordx4 v[232:235], v5, s[28:31], s50 offen offset:2048 sc1
  buffer_load_dwordx4 v[236:239], v5, s[28:31], s50 offen offset:3072 sc1
  s_mov_b32 s47, 6
  s_branch kvattn_kernel_xea
kvattn_kernel_x4a:
  s_cmp_eq_u32 s47, 6
  s_cbranch_scc0 kvattn_kernel_x5a
  s_add_u32 s50, s18, 3
  s_and_b32 s50, s50, 3
  s_lshl_b32 s50, s50, 13
  s_add_u32 s50, s50, s5
  s_add_u32 s50, s50, 4096
  buffer_load_dwordx4 v[240:243], v5, s[28:31], s50 offen offset:0 sc1
  buffer_load_dwordx4 v[244:247], v5, s[28:31], s50 offen offset:1024 sc1
  buffer_load_dwordx4 v[248:251], v5, s[28:31], s50 offen offset:2048 sc1
  buffer_load_dwordx4 v[252:255], v5, s[28:31], s50 offen offset:3072 sc1
  s_mov_b32 s47, 7
  s_branch kvattn_kernel_xea
kvattn_kernel_x5a:
  s_waitcnt vmcnt(4)
kvattn_kernel_xea:
  s_waitcnt vmcnt(8)
  s_cmp_eq_u32 s48, 0
  s_cbranch_scc0 kvattn_kernel_nfa
  s_mov_b64 exec, 1
  buffer_store_dword v4, off, s[96:99], s101 sc1
  s_mov_b64 exec, -1
  s_mov_b32 s48, 1
kvattn_kernel_nfa:
  s_cmp_eq_u32 s47, 0
  s_cbranch_scc0 kvattn_kernel_xsa
  v_cmp_ne_u32 vcc, s85, v3
  s_cbranch_vccnz kvattn_kernel_xsa
  s_mov_b32 s47, 1
kvattn_kernel_xsa:
  s_barrier
  s_branch kvattn_kernel_ld_mid
kvattn_kernel_ld_v1:
  s_add_u32 s50, s18, 1
  s_and_b32 s50, s50, 3
  s_lshl_b32 s50, s50, 17
  s_add_u32 s50, s50, s4
  s_add_u32 m0, s56, s44
  s_add_u32 s49, s50, 0
  buffer_load_dwordx4 v6, s[20:23], s49 offen offset:0 lds
  s_add_u32 s49, s50, 3072
  buffer_load_dwordx4 v7, s[20:23], s49 offen offset:1024 lds
  s_add_u32 s49, s50, 6144
  buffer_load_dwordx4 v6, s[20:23], s49 offen offset:2048 lds
  s_add_u32 s49, s50, 9216
  buffer_load_dwordx4 v7, s[20:23], s49 offen offset:3072 lds
  s_add_u32 s50, s18, 1
  s_and_b32 s50, s50, 3
  s_lshl_b32 s50, s50, 17
  s_add_u32 s50, s50, s4
  s_add_u32 m0, s57, s44
  s_add_u32 s49, s50, 65536
  buffer_load_dwordx4 v6, s[20:23], s49 offen offset:0 lds
  s_add_u32 s49, s50, 68608
  buffer_load_dwordx4 v7, s[20:23], s49 offen offset:1024 lds
  s_add_u32 s49, s50, 71680
  buffer_load_dwordx4 v6, s[20:23], s49 offen offset:2048 lds
  s_add_u32 s49, s50, 74752
  buffer_load_dwordx4 v7, s[20:23], s49 offen offset:3072 lds
  s_add_u32 s50, s18, 2
  s_and_b32 s50, s50, 3
  s_lshl_b32 s50, s50, 17
  s_add_u32 s50, s50, s4
  s_add_u32 m0, s58, s44
  s_add_u32 s49, s50, 0
  buffer_load_dwordx4 v6, s[20:23], s49 offen offset:0 lds
  s_add_u32 s49, s50, 3072
  buffer_load_dwordx4 v7, s[20:23], s49 offen offset:1024 lds
  s_add_u32 s49, s50, 6144
  buffer_load_dwordx4 v6, s[20:23], s49 offen offset:2048 lds
  s_add_u32 s49, s50, 9216
  buffer_load_dwordx4 v7, s[20:23], s49 offen offset:3072 lds
  s_waitcnt vmcnt(12)
  s_cmp_eq_u32 s48, 0
  s_cbranch_scc0 kvattn_kernel_nfb
  s_mov_b64 exec, 1
  buffer_store_dword v4, off, s[96:99], s101 sc1
  s_mov_b64 exec, -1
  s_mov_b32 s48, 1
kvattn_kernel_nfb:
  s_cmp_gt_u32 s45, 0
  s_cbranch_scc1 kvattn_kernel_v1w0
  s_add_u32 s50, s18, 0
  s_and_b32 s50, s50, 3
  s_lshl_b32 s50, s50, 17
  s_add_u32 s50, s50, s4
  s_add_u32 m0, s54, s44
  s_add_u32 s49, s50, 0
  buffer_load_dwordx4 v6, s[20:23], s49 offen offset:0 lds
  s_add_u32 s49, s50, 3072
  buffer_load_dwordx4 v7, s[20:23], s49 offen offset:1024 lds
  s_add_u32 s49, s50, 6144
  buffer_load_dwordx4 v6, s[20:23], s49 offen offset:2048 lds
  s_add_u32 s49, s50, 9216
  buffer_load_dwordx4 v7, s[20:23], s49 offen offset:3072 lds
kvattn_kernel_v1w0:
  s_cmp_gt_u32 s45, 1
  s_cbranch_scc1 kvattn_kernel_v1w1
  s_add_u32 s50, s18, 0
  s_and_b32 s50, s50, 3
  s_lshl_b32 s50, s50, 17
  s_add_u32 s50, s50, s4
  s_add_u32 m0, s55, s44
  s_add_u32 s49, s50, 65536
  buffer_load_dwordx4 v6, s[20:23], s49 offen offset:0 lds
  s_add_u32 s49, s50, 68608
  buffer_load_dwordx4 v7, s[20:23], s49 offen offset:1024 lds
  s_add_u32 s49, s50, 71680
  buffer_load_dwordx4 v6, s[20:23], s49 offen offset:2048 lds
  s_add_u32 s49, s50, 74752
  buffer_load_dwordx4 v7, s[20:23], s49 offen offset:3072 lds
kvattn_kernel_v1w1:
  s_barrier
  s_add_u32 s50, s18, 2
  s_and_b32 s50, s50, 3
  s_lshl_b32 s50, s50, 17
  s_add_u32 s50, s50, s4
  s_add_u32 m0, s59, s44
  s_add_u32 s49, s50, 65536
  buffer_load_dwordx4 v6, s[20:23], s49 offen offset:0 lds
  s_add_u32 s49, s50, 68608
  buffer_load_dwordx4 v7, s[20:23], s49 offen offset:1024 lds
  s_add_u32 s49, s50, 71680
  buffer_load_dwordx4 v6, s[20:23], s49 offen offset:2048 lds
  s_add_u32 s49, s50, 74752
  buffer_load_dwordx4 v7, s[20:23], s49 offen offset:3072 lds
  s_add_u32 s50, s18, 3
  s_and_b32 s50, s50, 3
  s_lshl_b32 s50, s50, 17
  s_add_u32 s50, s50, s4
  s_add_u32 m0, s60, s44
  s_add_u32 s49, s50, 0
  buffer_load_dwordx4 v6, s[20:23], s49 offen offset:0 lds
  s_add_u32 s49, s50, 3072
  buffer_load_dwordx4 v7, s[20:23], s49 offen offset:1024 lds
  s_add_u32 s49, s50, 6144
  buffer_load_dwordx4 v6, s[20:23], s49 offen offset:2048 lds
  s_add_u32 s49, s50, 9216
  buffer_load_dwordx4 v7, s[20:23], s49 offen offset:3072 lds
  s_lshl_b64 exec, 1, s16
  ds_write_b64 v10, v[8:9]
  s_mov_b64 exec, -1
  s_setprio 0
  s_waitcnt vmcnt(8) lgkmcnt(0)
  s_barrier
  s_add_u32 s50, s18, 3
  s_and_b32 s50, s50, 3
  s_lshl_b32 s50, s50, 17
  s_add_u32 s50, s50, s4
  s_add_u32 m0, s61, s44
  s_add_u32 s49, s50, 65536
  buffer_load_dwordx4 v6, s[20:23], s49 offen offset:0 lds
  s_add_u32 s49, s50, 68608
  buffer_load_dwordx4 v7, s[20:23], s49 offen offset:1024 lds
  s_add_u32 s49, s50, 71680
  buffer_load_dwordx4 v6, s[20:23], s49 offen offset:2048 lds
  s_add_u32 s49, s50, 74752
  buffer_load_dwordx4 v7, s[20:23], s49 offen offset:3072 lds
  s_branch kvattn_kernel_ogo
kvattn_kernel_obs:
  s_cmp_ge_u32 s12, 2
  s_cbranch_scc1 kvattn_kernel_ob2
  s_barrier
kvattn_kernel_ob2:
  s_lshl_b64 exec, 1, s16
  ds_write_b32 v10, v4 offset:4
  s_mov_b64 exec, -1
kvattn_kernel_ogo:
  s_sub_u32 s61, s61, s60
  s_sub_u32 s60, s60, s59
  s_sub_u32 s59, s59, s58
  s_sub_u32 s58, s58, s57
  s_sub_u32 s57, s57, s56
  s_sub_u32 s56, s56, s55
  s_sub_u32 s55, s55, s54
  v_add_u32 v56, s54, v56
  v_add_u32 v57, s54, v57
  v_add_u32 v58, s54, v58
  v_add_u32 v59, s54, v59
  v_add_u32 v60, s54, v60
  v_add_u32 v61, s54, v61
  v_add_u32 v62, s54, v62
  v_add_u32 v63, s54, v63
  ds_read_b64_tr_b16 v[32:33], v56 offset:0
  ds_read_b64_tr_b16 v[34:35], v56 offset:4096
  ds_read_b64_tr_b16 v[36:37], v57 offset:0
  ds_read_b64_tr_b16 v[38:39], v57 offset:4096
  ds_read_b64_tr_b16 v[40:41], v58 offset:0
  ds_read_b64_tr_b16 v[42:43], v58 offset:4096
  ds_read_b64_tr_b16 v[44:45], v59 offset:0
  ds_read_b64_tr_b16 v[46:47], v59 offset:4096
  ds_read_b64_tr_b16 v[48:49], v60 offset:0
  ds_read_b64_tr_b16 v[50:51], v60 offset:4096
  s_waitcnt lgkmcnt(8)
  v_mfma_f32_16x16x32_bf16 v[64:67], v[32:35], v[128:131], 0
  ds_read_b64_tr_b16 v[52:53], v61 offset:0
  v_mfma_f32_16x16x32_bf16 v[68:71], v[32:35], v[132:135], 0
  ds_read_b64_tr_b16 v[54:55], v61 offset:4096
  s_waitcnt lgkmcnt(8)
  v_mfma_f32_16x16x32_bf16 v[72:75], v[36:39], v[128:131], 0
  ds_read_b64_tr_b16 v[32:33], v62 offset:0
  v_mfma_f32_16x16x32_bf16 v[76:79], v[36:39], v[132:135], 0
  ds_read_b64_tr_b16 v[34:35], v62 offset:4096
  s_waitcnt lgkmcnt(8)
  v_mfma_f32_16x16x32_bf16 v[80:83], v[40:43], v[128:131], 0
  ds_read_b64_tr_b16 v[36:37], v63 offset:0
  v_mfma_f32_16x16x32_bf16 v[84:87], v[40:43], v[132:135], 0
  ds_read_b64_tr_b16 v[38:39], v63 offset:4096
  s_waitcnt lgkmcnt(8)
  v_mfma_f32_16x16x32_bf16 v[88:91], v[44:47], v[128:131], 0
  ds_read_b64_tr_b16 v[40:41], v56 offset:8192
  v_mfma_f32_16x16x32_bf16 v[92:95], v[44:47], v[132:135], 0
  ds_read_b64_tr_b16 v[42:43], v56 offset:12288
  s_waitcnt lgkmcnt(8)
  v_mfma_f32_16x16x32_bf16 v[96:99], v[48:51], v[128:131], 0
  ds_read_b64_tr_b16 v[44:45], v57 offset:8192
  v_mfma_f32_16x16x32_bf16 v[100:103], v[48:51], v[132:135], 0
  ds_read_b64_tr_b16 v[46:47], v57 offset:12288
  s_waitcnt lgkmcnt(8)
  v_mfma_f32_16x16x32_bf16 v[104:107], v[52:55], v[128:131], 0
  ds_read_b64_tr_b16 v[48:49], v58 offset:8192
  v_mfma_f32_16x16x32_bf16 v[108:111], v[52:55], v[132:135], 0
  ds_read_b64_tr_b16 v[50:51], v58 offset:12288
  s_waitcnt lgkmcnt(8)
  v_mfma_f32_16x16x32_bf16 v[112:115], v[32:35], v[128:131], 0
  ds_read_b64_tr_b16 v[52:53], v59 offset:8192
  v_mfma_f32_16x16x32_bf16 v[116:119], v[32:35], v[132:135], 0
  ds_read_b64_tr_b16 v[54:55], v59 offset:12288
  s_waitcnt lgkmcnt(8)
  v_mfma_f32_16x16x32_bf16 v[120:123], v[36:39], v[128:131], 0
  ds_read_b64_tr_b16 v[32:33], v60 offset:8192
  v_mfma_f32_16x16x32_bf16 v[124:127], v[36:39], v[132:135], 0
  ds_read_b64_tr_b16 v[34:35], v60 offset:12288
  s_waitcnt lgkmcnt(8)
  v_mfma_f32_16x16x32_bf16 v[64:67], v[40:43], v[136:139], v[64:67]
  ds_read_b64_tr_b16 v[36:37], v61 offset:8192
  v_mfma_f32_16x16x32_bf16 v[68:71], v[40:43], v[140:143], v[68:71]
  ds_read_b64_tr_b16 v[38:39], v61 offset:12288
  s_waitcnt lgkmcnt(8)
  v_mfma_f32_16x16x32_bf16 v[72:75], v[44:47], v[136:139], v[72:75]
  ds_read_b64_tr_b16 v[40:41], v62 offset:8192
  v_mfma_f32_16x16x32_bf16 v[76:79], v[44:47], v[140:143], v[76:79]
  ds_read_b64_tr_b16 v[42:43], v62 offset:12288
  s_waitcnt lgkmcnt(8)
  v_mfma_f32_16x16x32_bf16 v[80:83], v[48:51], v[136:139], v[80:83]
  ds_read_b64_tr_b16 v[44:45], v63 offset:8192
  v_mfma_f32_16x16x32_bf16 v[84:87], v[48:51], v[140:143], v[84:87]
  ds_read_b64_tr_b16 v[46:47], v63 offset:12288
  s_waitcnt lgkmcnt(8)
  v_mfma_f32_16x16x32_bf16 v[88:91], v[52:55], v[136:139], v[88:91]
  v_add_u32 v56, s55, v56
  v_add_u32 v57, s55, v57
  v_add_u32 v58, s55, v58
  v_add_u32 v59, s55, v59
  v_add_u32 v60, s55, v60
  v_add_u32 v61, s55, v61
  v_add_u32 v62, s55, v62
  v_add_u32 v63, s55, v63
  ds_read_b64_tr_b16 v[48:49], v56 offset:0
  v_mfma_f32_16x16x32_bf16 v[92:95], v[52:55], v[140:143], v[92:95]
  ds_read_b64_tr_b16 v[50:51], v56 offset:4096
  s_waitcnt lgkmcnt(8)
  v_mfma_f32_16x16x32_bf16 v[96:99], v[32:35], v[136:139], v[96:99]
  ds_read_b64_tr_b16 v[52:53], v57 offset:0
  v_mfma_f32_16x16x32_bf16 v[100:103], v[32:35], v[140:143], v[100:103]
  ds_read_b64_tr_b16 v[54:55], v57 offset:4096
  s_cmp_eq_u32 s48, 0
  s_cbranch_scc0 kvattn_kernel_nfd
  s_waitcnt vmcnt(0)
  s_mov_b64 exec, 1
  buffer_store_dword v4, off, s[96:99], s101 sc1
  s_mov_b64 exec, -1
  s_mov_b32 s48, 1
kvattn_kernel_nfd:
  s_waitcnt lgkmcnt(8)
  v_mfma_f32_16x16x32_bf16 v[104:107], v[36:39], v[136:139], v[104:107]
  ds_read_b64_tr_b16 v[32:33], v58 offset:0
  v_mfma_f32_16x16x32_bf16 v[108:111], v[36:39], v[140:143], v[108:111]
  ds_read_b64_tr_b16 v[34:35], v58 offset:4096
  s_waitcnt lgkmcnt(8)
  v_mfma_f32_16x16x32_bf16 v[112:115], v[40:43], v[136:139], v[112:115]
  ds_read_b64_tr_b16 v[36:37], v59 offset:0
  v_mfma_f32_16x16x32_bf16 v[116:119], v[40:43], v[140:143], v[116:119]
  ds_read_b64_tr_b16 v[38:39], v59 offset:4096
  s_waitcnt lgkmcnt(8)
  v_mfma_f32_16x16x32_bf16 v[120:123], v[44:47], v[136:139], v[120:123]
  ds_read_b64_tr_b16 v[40:41], v60 offset:0
  v_mfma_f32_16x16x32_bf16 v[124:127], v[44:47], v[140:143], v[124:127]
  ds_read_b64_tr_b16 v[42:43], v60 offset:4096
  s_waitcnt lgkmcnt(8)
  v_mfma_f32_16x16x32_bf16 v[64:67], v[48:51], v[144:147], v[64:67]
  ds_read_b64_tr_b16 v[44:45], v61 offset:0
  v_mfma_f32_16x16x32_bf16 v[68:71], v[48:51], v[148:151], v[68:71]
  ds_read_b64_tr_b16 v[46:47], v61 offset:4096
  s_waitcnt lgkmcnt(8)
  v_mfma_f32_16x16x32_bf16 v[72:75], v[52:55], v[144:147], v[72:75]
  ds_read_b64_tr_b16 v[48:49], v62 offset:0
  v_mfma_f32_16x16x32_bf16 v[76:79], v[52:55], v[148:151], v[76:79]
  ds_read_b64_tr_b16 v[50:51], v62 offset:4096
  s_waitcnt lgkmcnt(8)
  v_mfma_f32_16x16x32_bf16 v[80:83], v[32:35], v[144:147], v[80:83]
  ds_read_b64_tr_b16 v[52:53], v63 offset:0
  v_mfma_f32_16x16x32_bf16 v[84:87], v[32:35], v[148:151], v[84:87]
  ds_read_b64_tr_b16 v[54:55], v63 offset:4096
  s_waitcnt lgkmcnt(8)
  v_mfma_f32_16x16x32_bf16 v[88:91], v[36:39], v[144:147], v[88:91]
  ds_read_b64_tr_b16 v[32:33], v56 offset:8192
  v_mfma_f32_16x16x32_bf16 v[92:95], v[36:39], v[148:151], v[92:95]
  ds_read_b64_tr_b16 v[34:35], v56 offset:12288
  s_waitcnt lgkmcnt(8)
  v_mfma_f32_16x16x32_bf16 v[96:99], v[40:43], v[144:147], v[96:99]
  ds_read_b64_tr_b16 v[36:37], v57 offset:8192
  v_mfma_f32_16x16x32_bf16 v[100:103], v[40:43], v[148:151], v[100:103]
  ds_read_b64_tr_b16 v[38:39], v57 offset:12288
  s_waitcnt lgkmcnt(8)
  v_mfma_f32_16x16x32_bf16 v[104:107], v[44:47], v[144:147], v[104:107]
  ds_read_b64_tr_b16 v[40:41], v58 offset:8192
  v_mfma_f32_16x16x32_bf16 v[108:111], v[44:47], v[148:151], v[108:111]
  ds_read_b64_tr_b16 v[42:43], v58 offset:12288
  s_waitcnt lgkmcnt(8)
  v_mfma_f32_16x16x32_bf16 v[112:115], v[48:51], v[144:147], v[112:115]
  ds_read_b64_tr_b16 v[44:45], v59 offset:8192
  v_mfma_f32_16x16x32_bf16 v[116:119], v[48:51], v[148:151], v[116:119]
  ds_read_b64_tr_b16 v[46:47], v59 offset:12288
  s_waitcnt lgkmcnt(8)
  v_mfma_f32_16x16x32_bf16 v[120:123], v[52:55], v[144:147], v[120:123]
  ds_read_b64_tr_b16 v[48:49], v60 offset:8192
  v_mfma_f32_16x16x32_bf16 v[124:127], v[52:55], v[148:151], v[124:127]
  ds_read_b64_tr_b16 v[50:51], v60 offset:12288
  s_waitcnt lgkmcnt(8)
  v_mfma_f32_16x16x32_bf16 v[64:67], v[32:35], v[152:155], v[64:67]
  ds_read_b64_tr_b16 v[52:53], v61 offset:8192
  v_mfma_f32_16x16x32_bf16 v[68:71], v[32:35], v[156:159], v[68:71]
  ds_read_b64_tr_b16 v[54:55], v61 offset:12288
  s_cmp_eq_u32 s47, 0
  s_cbranch_scc0 kvattn_kernel_npp
  v_and_b32 v3, 3, v0
  v_lshlrev_b32 v3, 13, v3
  buffer_load_dword v3, v3, s[96:99], s8 offen sc1
kvattn_kernel_npp:
  s_waitcnt lgkmcnt(8)
  v_mfma_f32_16x16x32_bf16 v[72:75], v[36:39], v[152:155], v[72:75]
  ds_read_b64_tr_b16 v[32:33], v62 offset:8192
  v_mfma_f32_16x16x32_bf16 v[76:79], v[36:39], v[156:159], v[76:79]
  ds_read_b64_tr_b16 v[34:35], v62 offset:12288
  s_waitcnt lgkmcnt(8)
  v_mfma_f32_16x16x32_bf16 v[80:83], v[40:43], v[152:155], v[80:83]
  ds_read_b64_tr_b16 v[36:37], v63 offset:8192
  v_mfma_f32_16x16x32_bf16 v[84:87], v[40:43], v[156:159], v[84:87]
  ds_read_b64_tr_b16 v[38:39], v63 offset:12288
  s_waitcnt lgkmcnt(8)
  v_mfma_f32_16x16x32_bf16 v[88:91], v[44:47], v[152:155], v[88:91]
  v_add_u32 v56, s56, v56
  v_add_u32 v57, s56, v57
  v_add_u32 v58, s56, v58
  v_add_u32 v59, s56, v59
  v_add_u32 v60, s56, v60
  v_add_u32 v61, s56, v61
  v_add_u32 v62, s56, v62
  v_add_u32 v63, s56, v63
  ds_read_b64_tr_b16 v[40:41], v56 offset:0
  v_mfma_f32_16x16x32_bf16 v[92:95], v[44:47], v[156:159], v[92:95]
  ds_read_b64_tr_b16 v[42:43], v56 offset:4096
  s_waitcnt lgkmcnt(8)
  v_mfma_f32_16x16x32_bf16 v[96:99], v[48:51], v[152:155], v[96:99]
  ds_read_b64_tr_b16 v[44:45], v57 offset:0
  v_mfma_f32_16x16x32_bf16 v[100:103], v[48:51], v[156:159], v[100:103]
  ds_read_b64_tr_b16 v[46:47], v57 offset:4096
  s_waitcnt lgkmcnt(8)
  v_mfma_f32_16x16x32_bf16 v[104:107], v[52:55], v[152:155], v[104:107]
  ds_read_b64_tr_b16 v[48:49], v58 offset:0
  v_mfma_f32_16x16x32_bf16 v[108:111], v[52:55], v[156:159], v[108:111]
  ds_read_b64_tr_b16 v[50:51], v58 offset:4096
  s_waitcnt lgkmcnt(8)
  v_mfma_f32_16x16x32_bf16 v[112:115], v[32:35], v[152:155], v[112:115]
  ds_read_b64_tr_b16 v[52:53], v59 offset:0
  v_mfma_f32_16x16x32_bf16 v[116:119], v[32:35], v[156:159], v[116:119]
  ds_read_b64_tr_b16 v[54:55], v59 offset:4096
  s_waitcnt vmcnt(0)
  s_cmp_eq_u32 s52, 0
  s_cbranch_scc1 kvattn_kernel_oc1
  s_lshl_b64 exec, 1, s16
  ds_write_b32 v10, v4 offset:0
  s_mov_b64 exec, -1
  s_cmp_eq_u32 s47, 7
  s_cbranch_scc1 kvattn_kernel_og5
  ds_read_b32 v11, v10 offset:4
  s_waitcnt lgkmcnt(0)
  v_cmp_ne_u32 vcc, s85, v11
  s_cbranch_vccnz kvattn_kernel_lspinb
kvattn_kernel_lreadyb:
kvattn_kernel_oc1:
  s_cmp_eq_u32 s47, 0
  s_cbranch_scc0 kvattn_kernel_oc2
  v_cmp_ne_u32 vcc, s85, v3
  s_cbranch_vccnz kvattn_kernel_spinc
kvattn_kernel_readyc:
  s_mov_b32 s47, 1
kvattn_kernel_oc2:
  s_cmp_gt_u32 s47, 1
  s_cbranch_scc1 kvattn_kernel_og0
  s_add_u32 s50, s18, 1
  s_and_b32 s50, s50, 3
  s_lshl_b32 s50, s50, 13
  s_add_u32 s50, s50, s5
  buffer_load_dwordx4 v[160:163], v5, s[28:31], s50 offen offset:0 sc1
  buffer_load_dwordx4 v[164:167], v5, s[28:31], s50 offen offset:1024 sc1
  buffer_load_dwordx4 v[168:171], v5, s[28:31], s50 offen offset:2048 sc1
  buffer_load_dwordx4 v[172:175], v5, s[28:31], s50 offen offset:3072 sc1
kvattn_kernel_og0:
  s_cmp_gt_u32 s47, 2
  s_cbranch_scc1 kvattn_kernel_og1
  s_add_u32 s50, s18, 1
  s_and_b32 s50, s50, 3
  s_lshl_b32 s50, s50, 13
  s_add_u32 s50, s50, s5
  s_add_u32 s50, s50, 4096
  buffer_load_dwordx4 v[176:179], v5, s[28:31], s50 offen offset:0 sc1
  buffer_load_dwordx4 v[180:183], v5, s[28:31], s50 offen offset:1024 sc1
  buffer_load_dwordx4 v[184:187], v5, s[28:31], s50 offen offset:2048 sc1
  buffer_load_dwordx4 v[188:191], v5, s[28:31], s50 offen offset:3072 sc1
kvattn_kernel_og1:
  s_cmp_gt_u32 s47, 3
  s_cbranch_scc1 kvattn_kernel_og2
  s_add_u32 s50, s18, 2
  s_and_b32 s50, s50, 3
  s_lshl_b32 s50, s50, 13
  s_add_u32 s50, s50, s5
  buffer_load_dwordx4 v[192:195], v5, s[28:31], s50 offen offset:0 sc1
  buffer_load_dwordx4 v[196:199], v5, s[28:31], s50 offen offset:1024 sc1
  buffer_load_dwordx4 v[200:203], v5, s[28:31], s50 offen offset:2048 sc1
  buffer_load_dwordx4 v[204:207], v5, s[28:31], s50 offen offset:3072 sc1
kvattn_kernel_og2:
  s_cmp_gt_u32 s47, 4
  s_cbranch_scc1 kvattn_kernel_og3
  s_add_u32 s50, s18, 2
  s_and_b32 s50, s50, 3
  s_lshl_b32 s50, s50, 13
  s_add_u32 s50, s50, s5
  s_add_u32 s50, s50, 4096
  buffer_load_dwordx4 v[208:211], v5, s[28:31], s50 offen offset:0 sc1
  buffer_load_dwordx4 v[212:215], v5, s[28:31], s50 offen offset:1024 sc1
  buffer_load_dwordx4 v[216:219], v5, s[28:31], s50 offen offset:2048 sc1
  buffer_load_dwordx4 v[220:223], v5, s[28:31], s50 offen offset:3072 sc1
kvattn_kernel_og3:
  s_cmp_gt_u32 s47, 5
  s_cbranch_scc1 kvattn_kernel_og4
  s_add_u32 s50, s18, 3
  s_and_b32 s50, s50, 3
  s_lshl_b32 s50, s50, 13
  s_add_u32 s50, s50, s5
  buffer_load_dwordx4 v[224:227], v5, s[28:31], s50 offen offset:0 sc1
  buffer_load_dwordx4 v[228:231], v5, s[28:31], s50 offen offset:1024 sc1
  buffer_load_dwordx4 v[232:235], v5, s[28:31], s50 offen offset:2048 sc1
  buffer_load_dwordx4 v[236:239], v5, s[28:31], s50 offen offset:3072 sc1
kvattn_kernel_og4:
  s_cmp_gt_u32 s47, 6
  s_cbranch_scc1 kvattn_kernel_og5
  s_add_u32 s50, s18, 3
  s_and_b32 s50, s50, 3
  s_lshl_b32 s50, s50, 13
  s_add_u32 s50, s50, s5
  s_add_u32 s50, s50, 4096
  buffer_load_dwordx4 v[240:243], v5, s[28:31], s50 offen offset:0 sc1
  buffer_load_dwordx4 v[244:247], v5, s[28:31], s50 offen offset:1024 sc1
  buffer_load_dwordx4 v[248:251], v5, s[28:31], s50 offen offset:2048 sc1
  buffer_load_dwordx4 v[252:255], v5, s[28:31], s50 offen offset:3072 sc1
kvattn_kernel_og5:
  s_waitcnt lgkmcnt(8)
  v_mfma_f32_16x16x32_bf16 v[120:123], v[36:39], v[152:155], v[120:123]
  ds_read_b64_tr_b16 v[32:33], v60 offset:0
  v_mfma_f32_16x16x32_bf16 v[124:127], v[36:39], v[156:159], v[124:127]
  ds_read_b64_tr_b16 v[34:35], v60 offset:4096
  s_waitcnt vmcnt(22) lgkmcnt(8)
  v_mfma_f32_16x16x32_bf16 v[64:67], v[40:43], v[160:163], v[64:67]
  ds_read_b64_tr_b16 v[36:37], v61 offset:0
  v_mfma_f32_16x16x32_bf16 v[68:71], v[40:43], v[164:167], v[68:71]
  ds_read_b64_tr_b16 v[38:39], v61 offset:4096
  s_waitcnt lgkmcnt(8)
  v_mfma_f32_16x16x32_bf16 v[72:75], v[44:47], v[160:163], v[72:75]
  ds_read_b64_tr_b16 v[40:41], v62 offset:0
  v_mfma_f32_16x16x32_bf16 v[76:79], v[44:47], v[164:167], v[76:79]
  ds_read_b64_tr_b16 v[42:43], v62 offset:4096
  s_waitcnt lgkmcnt(8)
  v_mfma_f32_16x16x32_bf16 v[80:83], v[48:51], v[160:163], v[80:83]
  ds_read_b64_tr_b16 v[44:45], v63 offset:0
  v_mfma_f32_16x16x32_bf16 v[84:87], v[48:51], v[164:167], v[84:87]
  ds_read_b64_tr_b16 v[46:47], v63 offset:4096
  s_and_b32 s32, s2, 4
  s_bfe_u32 s37, s2, 0x20003
  s_waitcnt lgkmcnt(8)
  v_mfma_f32_16x16x32_bf16 v[88:91], v[52:55], v[160:163], v[88:91]
  ds_read_b64_tr_b16 v[48:49], v56 offset:8192
  v_mfma_f32_16x16x32_bf16 v[92:95], v[52:55], v[164:167], v[92:95]
  ds_read_b64_tr_b16 v[50:51], v56 offset:12288
  s_add_u32 s32, s32, s37
  s_and_b32 s33, s2, 3
  s_waitcnt lgkmcnt(8)
  v_mfma_f32_16x16x32_bf16 v[96:99], v[32:35], v[160:163], v[96:99]
  ds_read_b64_tr_b16 v[52:53], v57 offset:8192
  v_mfma_f32_16x16x32_bf16 v[100:103], v[32:35], v[164:167], v[100:103]
  ds_read_b64_tr_b16 v[54:55], v57 offset:12288
  s_mul_i32 s33, s33, 7
  s_lshr_b32 s37, s2, 5
  s_waitcnt lgkmcnt(8)
  v_mfma_f32_16x16x32_bf16 v[104:107], v[36:39], v[160:163], v[104:107]
  ds_read_b64_tr_b16 v[32:33], v58 offset:8192
  v_mfma_f32_16x16x32_bf16 v[108:111], v[36:39], v[164:167], v[108:111]
  ds_read_b64_tr_b16 v[34:35], v58 offset:12288
  s_add_u32 s33, s33, s37
  s_lshl_b32 s39, s32, 2
  s_waitcnt lgkmcnt(8)
  v_mfma_f32_16x16x32_bf16 v[112:115], v[40:43], v[160:163], v[112:115]
  ds_read_b64_tr_b16 v[36:37], v59 offset:8192
  v_mfma_f32_16x16x32_bf16 v[116:119], v[40:43], v[164:167], v[116:119]
  ds_read_b64_tr_b16 v[38:39], v59 offset:12288
  s_and_b32 s19, s2, 3
  s_add_u32 s39, s39, s19
  s_waitcnt lgkmcnt(8)
  v_mfma_f32_16x16x32_bf16 v[120:123], v[44:47], v[160:163], v[120:123]
  ds_read_b64_tr_b16 v[40:41], v60 offset:8192
  v_mfma_f32_16x16x32_bf16 v[124:127], v[44:47], v[164:167], v[124:127]
  ds_read_b64_tr_b16 v[42:43], v60 offset:12288
  s_lshl_b32 s39, s39, 8
  s_lshl_b32 s19, s37, 2
  s_waitcnt vmcnt(20) lgkmcnt(8)
  v_mfma_f32_16x16x32_bf16 v[64:67], v[48:51], v[168:171], v[64:67]
  ds_read_b64_tr_b16 v[44:45], v61 offset:8192
  v_mfma_f32_16x16x32_bf16 v[68:71], v[48:51], v[172:175], v[68:71]
  ds_read_b64_tr_b16 v[46:47], v61 offset:12288
  s_add_u32 s39, s39, s19
  s_add_u32 s39, s39, 32768
  s_waitcnt lgkmcnt(8)
  v_mfma_f32_16x16x32_bf16 v[72:75], v[52:55], v[168:171], v[72:75]
  ds_read_b64_tr_b16 v[48:49], v62 offset:8192
  v_mfma_f32_16x16x32_bf16 v[76:79], v[52:55], v[172:175], v[76:79]
  ds_read_b64_tr_b16 v[50:51], v62 offset:12288
  s_add_u32 s18, s39, 116
  s_cmp_le_u32 s37, 3
  s_cselect_b32 s39, s39, 0x1000000
  s_waitcnt lgkmcnt(8)
  v_mfma_f32_16x16x32_bf16 v[80:83], v[32:35], v[168:171], v[80:83]
  ds_read_b64_tr_b16 v[52:53], v63 offset:8192
  v_mfma_f32_16x16x32_bf16 v[84:87], v[32:35], v[172:175], v[84:87]
  ds_read_b64_tr_b16 v[54:55], v63 offset:12288
  s_cmp_ge_u32 s37, 3
  s_cselect_b32 s18, s18, 0x1000000
  s_cmp_eq_u32 s12, 1
  s_cselect_b32 s39, s18, s39
  s_waitcnt lgkmcnt(8)
  v_mfma_f32_16x16x32_bf16 v[88:91], v[36:39], v[168:171], v[88:91]
  v_add_u32 v56, s57, v56
  v_add_u32 v57, s57, v57
  v_add_u32 v58, s57, v58
  v_add_u32 v59, s57, v59
  v_add_u32 v60, s57, v60
  v_add_u32 v61, s57, v61
  v_add_u32 v62, s57, v62
  v_add_u32 v63, s57, v63
  ds_read_b64_tr_b16 v[32:33], v56 offset:0
  v_mfma_f32_16x16x32_bf16 v[92:95], v[36:39], v[172:175], v[92:95]
  ds_read_b64_tr_b16 v[34:35], v56 offset:4096
  s_cmp_lt_u32 s12, 2
  s_cselect_b32 s39, s39, 0x1000000
  s_lshl_b32 s3, s32, 3
  s_waitcnt lgkmcnt(8)
  v_mfma_f32_16x16x32_bf16 v[96:99], v[40:43], v[168:171], v[96:99]
  ds_read_b64_tr_b16 v[36:37], v57 offset:0
  v_mfma_f32_16x16x32_bf16 v[100:103], v[40:43], v[172:175], v[100:103]
  ds_read_b64_tr_b16 v[38:39], v57 offset:4096
  s_add_u32 s3, s3, s12
  s_lshl_b32 s3, s3, 7
  s_waitcnt lgkmcnt(8)
  v_mfma_f32_16x16x32_bf16 v[104:107], v[44:47], v[168:171], v[104:107]
  ds_read_b64_tr_b16 v[40:41], v58 offset:0
  v_mfma_f32_16x16x32_bf16 v[108:111], v[44:47], v[172:175], v[108:111]
  ds_read_b64_tr_b16 v[42:43], v58 offset:4096
  s_add_u32 s3, s3, 40960
  s_lshl_b32 s32, s32, 2
  s_waitcnt lgkmcnt(8)
  v_mfma_f32_16x16x32_bf16 v[112:115], v[48:51], v[168:171], v[112:115]
  ds_read_b64_tr_b16 v[44:45], v59 offset:0
  v_mfma_f32_16x16x32_bf16 v[116:119], v[48:51], v[172:175], v[116:119]
  ds_read_b64_tr_b16 v[46:47], v59 offset:4096
  s_sub_u32 s37, 56, s32
  s_cmp_lt_u32 s12, 4
  s_cselect_b32 s32, s32, s37
  s_waitcnt lgkmcnt(8)
  v_mfma_f32_16x16x32_bf16 v[120:123], v[52:55], v[168:171], v[120:123]
  ds_read_b64_tr_b16 v[48:49], v60 offset:0
  v_mfma_f32_16x16x32_bf16 v[124:127], v[52:55], v[172:175], v[124:127]
  ds_read_b64_tr_b16 v[50:51], v60 offset:4096
  s_add_u32 s32, s32, s12
  s_lshl_b32 s34, s32, 15
  s_waitcnt vmcnt(18) lgkmcnt(8)
  v_mfma_f32_16x16x32_bf16 v[64:67], v[32:35], v[176:179], v[64:67]
  ds_read_b64_tr_b16 v[52:53], v61 offset:0
  v_mfma_f32_16x16x32_bf16 v[68:71], v[32:35], v[180:183], v[68:71]
  ds_read_b64_tr_b16 v[54:55], v61 offset:4096
  s_mul_i32 s35, s12, 28672
  s_lshl_b32 s37, s33, 7
  s_waitcnt lgkmcnt(8)
  v_mfma_f32_16x16x32_bf16 v[72:75], v[36:39], v[176:179], v[72:75]
  ds_read_b64_tr_b16 v[32:33], v62 offset:0
  v_mfma_f32_16x16x32_bf16 v[76:79], v[36:39], v[180:183], v[76:79]
  ds_read_b64_tr_b16 v[34:35], v62 offset:4096
  s_add_u32 s35, s35, s37
  s_cmp_lt_u32 s2, 224
  s_cselect_b32 s35, s35, 0x1000000
  s_waitcnt lgkmcnt(8)
  v_mfma_f32_16x16x32_bf16 v[80:83], v[40:43], v[176:179], v[80:83]
  ds_read_b64_tr_b16 v[36:37], v63 offset:0
  v_mfma_f32_16x16x32_bf16 v[84:87], v[40:43], v[180:183], v[84:87]
  ds_read_b64_tr_b16 v[38:39], v63 offset:4096
  s_lshl_b32 s36, s12, 10
  s_mul_i32 s38, s32, 114688
  s_waitcnt lgkmcnt(8)
  v_mfma_f32_16x16x32_bf16 v[88:91], v[44:47], v[176:179], v[88:91]
  ds_read_b64_tr_b16 v[40:41], v56 offset:8192
  v_mfma_f32_16x16x32_bf16 v[92:95], v[44:47], v[180:183], v[92:95]
  ds_read_b64_tr_b16 v[42:43], v56 offset:12288
  s_lshl_b32 s37, s33, 12
  s_add_u32 s38, s38, s37
  s_waitcnt lgkmcnt(8)
  v_mfma_f32_16x16x32_bf16 v[96:99], v[48:51], v[176:179], v[96:99]
  ds_read_b64_tr_b16 v[44:45], v57 offset:8192
  v_mfma_f32_16x16x32_bf16 v[100:103], v[48:51], v[180:183], v[100:103]
  ds_read_b64_tr_b16 v[46:47], v57 offset:12288
  v_lshrrev_b32 v30, 4, v0
  v_lshlrev_b32 v31, 1, v30
  s_waitcnt lgkmcnt(8)
  v_mfma_f32_16x16x32_bf16 v[104:107], v[52:55], v[176:179], v[104:107]
  ds_read_b64_tr_b16 v[48:49], v58 offset:8192
  v_mfma_f32_16x16x32_bf16 v[108:111], v[52:55], v[180:183], v[108:111]
  ds_read_b64_tr_b16 v[50:51], v58 offset:12288
  v_and_b32 v12, 7, v0
  v_xor_b32 v12, v12, v31
  s_waitcnt lgkmcnt(8)
  v_mfma_f32_16x16x32_bf16 v[112:115], v[32:35], v[176:179], v[112:115]
  ds_read_b64_tr_b16 v[52:53], v59 offset:8192
  v_mfma_f32_16x16x32_bf16 v[116:119], v[32:35], v[180:183], v[116:119]
  ds_read_b64_tr_b16 v[54:55], v59 offset:12288
  v_lshlrev_b32 v12, 4, v12
  v_lshrrev_b32 v31, 3, v0
  s_waitcnt lgkmcnt(8)
  v_mfma_f32_16x16x32_bf16 v[120:123], v[36:39], v[176:179], v[120:123]
  ds_read_b64_tr_b16 v[32:33], v60 offset:8192
  v_mfma_f32_16x16x32_bf16 v[124:127], v[36:39], v[180:183], v[124:127]
  ds_read_b64_tr_b16 v[34:35], v60 offset:12288
  v_lshl_add_u32 v13, v31, 10, v12
  v_mul_u32_u24 v31, 3584, v31
  s_waitcnt vmcnt(16) lgkmcnt(8)
  v_mfma_f32_16x16x32_bf16 v[64:67], v[40:43], v[184:187], v[64:67]
  ds_read_b64_tr_b16 v[36:37], v61 offset:8192
  v_mfma_f32_16x16x32_bf16 v[68:71], v[40:43], v[188:191], v[68:71]
  ds_read_b64_tr_b16 v[38:39], v61 offset:12288
  v_add_u32 v12, v12, v31
  v_lshrrev_b32 v31, 2, v0
  s_waitcnt lgkmcnt(8)
  v_mfma_f32_16x16x32_bf16 v[72:75], v[44:47], v[184:187], v[72:75]
  ds_read_b64_tr_b16 v[40:41], v62 offset:8192
  v_mfma_f32_16x16x32_bf16 v[76:79], v[44:47], v[188:191], v[76:79]
  ds_read_b64_tr_b16 v[42:43], v62 offset:12288
  v_lshlrev_b32 v31, 7, v31
  v_bfe_u32 v30, v0, 3, 2
  s_waitcnt lgkmcnt(8)
  v_mfma_f32_16x16x32_bf16 v[80:83], v[48:51], v[184:187], v[80:83]
  ds_read_b64_tr_b16 v[44:45], v63 offset:8192
  v_mfma_f32_16x16x32_bf16 v[84:87], v[48:51], v[188:191], v[84:87]
  ds_read_b64_tr_b16 v[46:47], v63 offset:12288
  v_lshl_add_u32 v31, v30, 5, v31
  v_and_b32 v30, 3, v0
  s_waitcnt lgkmcnt(8)
  v_mfma_f32_16x16x32_bf16 v[88:91], v[52:55], v[184:187], v[88:91]
  v_add_u32 v56, s58, v56
  v_add_u32 v57, s58, v57
  v_add_u32 v58, s58, v58
  v_add_u32 v59, s58, v59
  v_add_u32 v60, s58, v60
  v_add_u32 v61, s58, v61
  v_add_u32 v62, s58, v62
  v_add_u32 v63, s58, v63
  ds_read_b64_tr_b16 v[48:49], v56 offset:0
  v_mfma_f32_16x16x32_bf16 v[92:95], v[52:55], v[188:191], v[92:95]
  ds_read_b64_tr_b16 v[50:51], v56 offset:4096
  v_lshl_add_u32 v14, v30, 3, v31
  v_xor_b32 v15, 32, v14
  s_waitcnt lgkmcnt(8)
  v_mfma_f32_16x16x32_bf16 v[96:99], v[32:35], v[184:187], v[96:99]
  ds_read_b64_tr_b16 v[52:53], v57 offset:0
  v_mfma_f32_16x16x32_bf16 v[100:103], v[32:35], v[188:191], v[100:103]
  ds_read_b64_tr_b16 v[54:55], v57 offset:4096
  v_xor_b32 v16, 64, v14
  v_xor_b32 v17, 96, v14
  s_waitcnt lgkmcnt(8)
  v_mfma_f32_16x16x32_bf16 v[104:107], v[36:39], v[184:187], v[104:107]
  ds_read_b64_tr_b16 v[32:33], v58 offset:0
  v_mfma_f32_16x16x32_bf16 v[108:111], v[36:39], v[188:191], v[108:111]
  ds_read_b64_tr_b16 v[34:35], v58 offset:4096
  v_mov_b32 v18, 0xbfb8aa3b
  v_mov_b32 v20, 1.0
  s_waitcnt lgkmcnt(8)
  v_mfma_f32_16x16x32_bf16 v[112:115], v[40:43], v[184:187], v[112:115]
  ds_read_b64_tr_b16 v[36:37], v59 offset:0
  v_mfma_f32_16x16x32_bf16 v[116:119], v[40:43], v[188:191], v[116:119]
  ds_read_b64_tr_b16 v[38:39], v59 offset:4096
  s_mov_b32 s20, s88
  s_mov_b32 s21, s89
  s_waitcnt lgkmcnt(8)
  v_mfma_f32_16x16x32_bf16 v[120:123], v[44:47], v[184:187], v[120:123]
  ds_read_b64_tr_b16 v[40:41], v60 offset:0
  v_mfma_f32_16x16x32_bf16 v[124:127], v[44:47], v[188:191], v[124:127]
  ds_read_b64_tr_b16 v[42:43], v60 offset:4096
  s_mov_b32 s22, 0x1c0000
  s_mov_b32 s23, 0x20000
  s_waitcnt vmcnt(14) lgkmcnt(8)
  v_mfma_f32_16x16x32_bf16 v[64:67], v[48:51], v[192:195], v[64:67]
  ds_read_b64_tr_b16 v[44:45], v61 offset:0
  v_mfma_f32_16x16x32_bf16 v[68:71], v[48:51], v[196:199], v[68:71]
  ds_read_b64_tr_b16 v[46:47], v61 offset:4096
  s_mov_b32 s28, s90
  s_mov_b32 s29, s91
  s_waitcnt lgkmcnt(8)
  v_mfma_f32_16x16x32_bf16 v[72:75], v[52:55], v[192:195], v[72:75]
  ds_read_b64_tr_b16 v[48:49], v62 offset:0
  v_mfma_f32_16x16x32_bf16 v[76:79], v[52:55], v[196:199], v[76:79]
  ds_read_b64_tr_b16 v[50:51], v62 offset:4096
  s_mov_b32 s30, 0x1c0000
  s_mov_b32 s31, 0x20000
  s_waitcnt lgkmcnt(8)
  v_mfma_f32_16x16x32_bf16 v[80:83], v[32:35], v[192:195], v[80:83]
  ds_read_b64_tr_b16 v[52:53], v63 offset:0
  v_mfma_f32_16x16x32_bf16 v[84:87], v[32:35], v[196:199], v[84:87]
  ds_read_b64_tr_b16 v[54:55], v63 offset:4096
  s_mov_b32 s48, s86
  s_mov_b32 s49, s87
  s_waitcnt lgkmcnt(8)
  v_mfma_f32_16x16x32_bf16 v[88:91], v[36:39], v[192:195], v[88:91]
  ds_read_b64_tr_b16 v[32:33], v56 offset:8192
  v_mfma_f32_16x16x32_bf16 v[92:95], v[36:39], v[196:199], v[92:95]
  ds_read_b64_tr_b16 v[34:35], v56 offset:12288
  s_mov_b32 s50, 0x1c0000
  s_mov_b32 s51, 0x20000
  s_waitcnt lgkmcnt(8)
  v_mfma_f32_16x16x32_bf16 v[96:99], v[40:43], v[192:195], v[96:99]
  ds_read_b64_tr_b16 v[36:37], v57 offset:8192
  v_mfma_f32_16x16x32_bf16 v[100:103], v[40:43], v[196:199], v[100:103]
  ds_read_b64_tr_b16 v[38:39], v57 offset:12288
  s_add_u32 s44, s10, 0x5200000
  s_addc_u32 s45, s11, 0
  s_mov_b32 s46, 0x200000
  s_waitcnt lgkmcnt(8)
  v_mfma_f32_16x16x32_bf16 v[104:107], v[44:47], v[192:195], v[104:107]
  ds_read_b64_tr_b16 v[40:41], v58 offset:8192
  v_mfma_f32_16x16x32_bf16 v[108:111], v[44:47], v[196:199], v[108:111]
  ds_read_b64_tr_b16 v[42:43], v58 offset:12288
  s_mov_b32 s47, 0x20000
  s_and_b32 s15, s2, 7
  s_waitcnt lgkmcnt(8)
  v_mfma_f32_16x16x32_bf16 v[112:115], v[48:51], v[192:195], v[112:115]
  ds_read_b64_tr_b16 v[44:45], v59 offset:8192
  v_mfma_f32_16x16x32_bf16 v[116:119], v[48:51], v[196:199], v[116:119]
  ds_read_b64_tr_b16 v[46:47], v59 offset:12288
  s_lshl_b32 s15, s15, 2
  s_bfe_u32 s19, s2, 0x20003
  s_waitcnt lgkmcnt(8)
  v_mfma_f32_16x16x32_bf16 v[120:123], v[52:55], v[192:195], v[120:123]
  ds_read_b64_tr_b16 v[48:49], v60 offset:8192
  v_mfma_f32_16x16x32_bf16 v[124:127], v[52:55], v[196:199], v[124:127]
  ds_read_b64_tr_b16 v[50:51], v60 offset:12288
  ds_read_b32 v11, v10
  s_add_u32 s15, s15, s19
  s_lshr_b32 s16, s2, 5
  s_waitcnt vmcnt(12) lgkmcnt(9)
  v_mfma_f32_16x16x32_bf16 v[64:67], v[32:35], v[200:203], v[64:67]
  ds_read_b64_tr_b16 v[52:53], v61 offset:8192
  v_mfma_f32_16x16x32_bf16 v[68:71], v[32:35], v[204:207], v[68:71]
  ds_read_b64_tr_b16 v[54:55], v61 offset:12288
  s_mul_i32 s42, s15, 229376
  s_mul_i32 s19, s12, 14336
  s_waitcnt lgkmcnt(9)
  v_mfma_f32_16x16x32_bf16 v[72:75], v[36:39], v[200:203], v[72:75]
  ds_read_b64_tr_b16 v[32:33], v62 offset:8192
  v_mfma_f32_16x16x32_bf16 v[76:79], v[36:39], v[204:207], v[76:79]
  ds_read_b64_tr_b16 v[34:35], v62 offset:12288
  s_add_u32 s42, s42, s19
  s_add_u32 s43, s42, 114688
  s_waitcnt lgkmcnt(9)
  v_mfma_f32_16x16x32_bf16 v[80:83], v[40:43], v[200:203], v[80:83]
  ds_read_b64_tr_b16 v[36:37], v63 offset:8192
  v_mfma_f32_16x16x32_bf16 v[84:87], v[40:43], v[204:207], v[84:87]
  ds_read_b64_tr_b16 v[38:39], v63 offset:12288
  s_mul_i32 s17, s12, 229376
  s_lshl_b32 s19, s16, 7
  s_waitcnt lgkmcnt(9)
  v_mfma_f32_16x16x32_bf16 v[88:91], v[44:47], v[200:203], v[88:91]
  s_waitcnt lgkmcnt(6)
  v_cmp_ne_u32 vcc, s85, v11
  s_cbranch_vccnz kvattn_kernel_lspinw
kvattn_kernel_lreadyw:
  v_add_u32 v56, s59, v56
  v_add_u32 v57, s59, v57
  v_add_u32 v58, s59, v58
  v_add_u32 v59, s59, v59
  v_add_u32 v60, s59, v60
  v_add_u32 v61, s59, v61
  v_add_u32 v62, s59, v62
  v_add_u32 v63, s59, v63
  ds_read_b64_tr_b16 v[40:41], v56 offset:0
  v_mfma_f32_16x16x32_bf16 v[92:95], v[44:47], v[204:207], v[92:95]
  ds_read_b64_tr_b16 v[42:43], v56 offset:4096
  s_add_u32 s17, s17, s19
  s_lshl_b32 s18, s12, 12
  v_mfma_f32_16x16x32_bf16 v[96:99], v[48:51], v[200:203], v[96:99]
  ds_read_b64_tr_b16 v[44:45], v57 offset:0
  v_mfma_f32_16x16x32_bf16 v[100:103], v[48:51], v[204:207], v[100:103]
  ds_read_b64_tr_b16 v[46:47], v57 offset:4096
  s_lshr_b32 s8, s15, 1
  s_sub_u32 s19, 15, s8
  s_waitcnt lgkmcnt(8)
  v_mfma_f32_16x16x32_bf16 v[104:107], v[52:55], v[200:203], v[104:107]
  ds_read_b64_tr_b16 v[48:49], v58 offset:0
  v_mfma_f32_16x16x32_bf16 v[108:111], v[52:55], v[204:207], v[108:111]
  ds_read_b64_tr_b16 v[50:51], v58 offset:4096
  s_min_u32 s8, s8, s19
  s_lshl_b32 s8, s8, 3
  s_waitcnt lgkmcnt(8)
  v_mfma_f32_16x16x32_bf16 v[112:115], v[32:35], v[200:203], v[112:115]
  ds_read_b64_tr_b16 v[52:53], v59 offset:0
  v_mfma_f32_16x16x32_bf16 v[116:119], v[32:35], v[204:207], v[116:119]
  ds_read_b64_tr_b16 v[54:55], v59 offset:4096
  s_add_u32 s8, s8, s12
  s_lshl_b32 s8, s8, 7
  s_waitcnt lgkmcnt(8)
  v_mfma_f32_16x16x32_bf16 v[120:123], v[36:39], v[200:203], v[120:123]
  ds_read_b64_tr_b16 v[32:33], v60 offset:0
  v_mfma_f32_16x16x32_bf16 v[124:127], v[36:39], v[204:207], v[124:127]
  ds_read_b64_tr_b16 v[34:35], v60 offset:4096
  s_add_u32 s8, s8, 32768
  s_lshr_b32 s37, s13, 2
  s_waitcnt vmcnt(10) lgkmcnt(8)
  v_mfma_f32_16x16x32_bf16 v[64:67], v[40:43], v[208:211], v[64:67]
  ds_read_b64_tr_b16 v[36:37], v61 offset:0
  v_mfma_f32_16x16x32_bf16 v[68:71], v[40:43], v[212:215], v[68:71]
  ds_read_b64_tr_b16 v[38:39], v61 offset:4096
  s_lshl_b32 s100, s14, 3
  s_add_u32 s100, s100, s37
  s_waitcnt lgkmcnt(8)
  v_mfma_f32_16x16x32_bf16 v[72:75], v[44:47], v[208:211], v[72:75]
  ds_read_b64_tr_b16 v[40:41], v62 offset:0
  v_mfma_f32_16x16x32_bf16 v[76:79], v[44:47], v[212:215], v[76:79]
  ds_read_b64_tr_b16 v[42:43], v62 offset:4096
  s_lshl_b32 s100, s100, 5
  s_and_b32 s19, s13, 3
  s_waitcnt lgkmcnt(8)
  v_mfma_f32_16x16x32_bf16 v[80:83], v[48:51], v[208:211], v[80:83]
  ds_read_b64_tr_b16 v[44:45], v63 offset:0
  v_mfma_f32_16x16x32_bf16 v[84:87], v[48:51], v[212:215], v[84:87]
  ds_read_b64_tr_b16 v[46:47], v63 offset:4096
  s_add_u32 s100, s100, s19
  s_lshl_b32 s100, s100, 2
  s_waitcnt lgkmcnt(8)
  v_mfma_f32_16x16x32_bf16 v[88:91], v[52:55], v[208:211], v[88:91]
  ds_read_b64_tr_b16 v[48:49], v56 offset:8192
  v_mfma_f32_16x16x32_bf16 v[92:95], v[52:55], v[212:215], v[92:95]
  ds_read_b64_tr_b16 v[50:51], v56 offset:12288
  s_add_u32 s100, s100, 40960
  s_cmp_eq_u32 s12, 0
  s_cselect_b32 s100, s100, 0x1000000
  s_waitcnt lgkmcnt(8)
  v_mfma_f32_16x16x32_bf16 v[96:99], v[32:35], v[208:211], v[96:99]
  ds_read_b64_tr_b16 v[52:53], v57 offset:8192
  v_mfma_f32_16x16x32_bf16 v[100:103], v[32:35], v[212:215], v[100:103]
  ds_read_b64_tr_b16 v[54:55], v57 offset:12288
  s_xor_b32 s37, s37, 4
  s_lshl_b32 s9, s37, 3
  s_waitcnt lgkmcnt(8)
  v_mfma_f32_16x16x32_bf16 v[104:107], v[36:39], v[208:211], v[104:107]
  ds_read_b64_tr_b16 v[32:33], v58 offset:8192
  v_mfma_f32_16x16x32_bf16 v[108:111], v[36:39], v[212:215], v[108:111]
  ds_read_b64_tr_b16 v[34:35], v58 offset:12288
  s_add_u32 s9, s9, s14
  s_lshl_b32 s9, s9, 2
  s_waitcnt lgkmcnt(8)
  v_mfma_f32_16x16x32_bf16 v[112:115], v[40:43], v[208:211], v[112:115]
  ds_read_b64_tr_b16 v[36:37], v59 offset:8192
  v_mfma_f32_16x16x32_bf16 v[116:119], v[40:43], v[212:215], v[116:119]
  ds_read_b64_tr_b16 v[38:39], v59 offset:12288
  s_lshr_b32 s37, s12, 1
  s_add_u32 s9, s9, s37
  s_waitcnt lgkmcnt(8)
  v_mfma_f32_16x16x32_bf16 v[120:123], v[44:47], v[208:211], v[120:123]
  ds_read_b64_tr_b16 v[40:41], v60 offset:8192
  v_mfma_f32_16x16x32_bf16 v[124:127], v[44:47], v[212:215], v[124:127]
  ds_read_b64_tr_b16 v[42:43], v60 offset:12288
  s_lshl_b32 s9, s9, 7
  s_add_u32 s9, s9, 327680
  s_waitcnt vmcnt(8) lgkmcnt(8)
  v_mfma_f32_16x16x32_bf16 v[64:67], v[48:51], v[216:219], v[64:67]
  ds_read_b64_tr_b16 v[44:45], v61 offset:8192
  v_mfma_f32_16x16x32_bf16 v[68:71], v[48:51], v[220:223], v[68:71]
  ds_read_b64_tr_b16 v[46:47], v61 offset:12288
  s_lshl_b32 s101, s12, 3
  s_add_u32 s101, s101, s14
  s_waitcnt lgkmcnt(8)
  v_mfma_f32_16x16x32_bf16 v[72:75], v[52:55], v[216:219], v[72:75]
  ds_read_b64_tr_b16 v[48:49], v62 offset:8192
  v_mfma_f32_16x16x32_bf16 v[76:79], v[52:55], v[220:223], v[76:79]
  ds_read_b64_tr_b16 v[50:51], v62 offset:12288
  s_lshl_b32 s101, s101, 2
  s_and_b32 s37, s13, 3
  s_waitcnt lgkmcnt(8)
  v_mfma_f32_16x16x32_bf16 v[80:83], v[32:35], v[216:219], v[80:83]
  ds_read_b64_tr_b16 v[52:53], v63 offset:8192
  v_mfma_f32_16x16x32_bf16 v[84:87], v[32:35], v[220:223], v[84:87]
  ds_read_b64_tr_b16 v[54:55], v63 offset:12288
  s_add_u32 s101, s101, s37
  s_lshl_b32 s101, s101, 7
  s_waitcnt lgkmcnt(8)
  v_mfma_f32_16x16x32_bf16 v[88:91], v[36:39], v[216:219], v[88:91]
  v_add_u32 v56, s60, v56
  ds_read_b64_tr_b16 v[32:33], v56 offset:0
  v_mfma_f32_16x16x32_bf16 v[92:95], v[36:39], v[220:223], v[92:95]
  ds_read_b64_tr_b16 v[34:35], v56 offset:4096
  s_and_b32 s37, s13, 28
  s_add_u32 s101, s101, s37
  s_waitcnt lgkmcnt(8)
  v_mfma_f32_16x16x32_bf16 v[96:99], v[40:43], v[216:219], v[96:99]
  v_add_u32 v57, s60, v57
  ds_read_b64_tr_b16 v[36:37], v57 offset:0
  v_mfma_f32_16x16x32_bf16 v[100:103], v[40:43], v[220:223], v[100:103]
  ds_read_b64_tr_b16 v[38:39], v57 offset:4096
  s_add_u32 s101, s101, 327680
  s_sub_u32 s37, 14, s14
  s_waitcnt lgkmcnt(8)
  v_mfma_f32_16x16x32_bf16 v[104:107], v[44:47], v[216:219], v[104:107]
  ds_read_b64_tr_b16 v[40:41], v56 offset:8192
  v_mfma_f32_16x16x32_bf16 v[108:111], v[44:47], v[220:223], v[108:111]
  ds_read_b64_tr_b16 v[42:43], v56 offset:12288
  s_cmp_lt_u32 s13, 16
  s_cselect_b32 s37, s14, s37
  s_lshl_b32 s37, s37, 4
  s_waitcnt lgkmcnt(8)
  v_mfma_f32_16x16x32_bf16 v[112:115], v[48:51], v[216:219], v[112:115]
  ds_read_b64_tr_b16 v[44:45], v57 offset:8192
  v_mfma_f32_16x16x32_bf16 v[116:119], v[48:51], v[220:223], v[116:119]
  ds_read_b64_tr_b16 v[46:47], v57 offset:12288
  s_add_u32 s37, s37, s13
  s_lshl_b32 s13, s37, 13
  s_waitcnt lgkmcnt(8)
  v_mfma_f32_16x16x32_bf16 v[120:123], v[52:55], v[216:219], v[120:123]
  v_add_u32 v56, s61, v56
  ds_read_b64_tr_b16 v[48:49], v56 offset:0
  v_mfma_f32_16x16x32_bf16 v[124:127], v[52:55], v[220:223], v[124:127]
  ds_read_b64_tr_b16 v[50:51], v56 offset:4096
  s_lshl_b32 s19, s12, 7
  s_add_u32 s13, s13, s19
  s_waitcnt vmcnt(6) lgkmcnt(8)
  v_mfma_f32_16x16x32_bf16 v[64:67], v[32:35], v[224:227], v[64:67]
  v_add_u32 v57, s61, v57
  ds_read_b64_tr_b16 v[52:53], v57 offset:0
  v_mfma_f32_16x16x32_bf16 v[68:71], v[32:35], v[228:231], v[68:71]
  ds_read_b64_tr_b16 v[54:55], v57 offset:4096
  s_lshl_b32 s63, s12, 8
  s_lshr_b32 s40, s37, 2
  s_waitcnt lgkmcnt(8)
  v_mfma_f32_16x16x32_bf16 v[72:75], v[36:39], v[224:227], v[72:75]
  ds_read_b64_tr_b16 v[32:33], v56 offset:8192
  v_mfma_f32_16x16x32_bf16 v[76:79], v[36:39], v[228:231], v[76:79]
  ds_read_b64_tr_b16 v[34:35], v56 offset:12288
  s_mul_i32 s41, s40, 229376
  s_lshl_b32 s40, s40, 15
  s_waitcnt vmcnt(4) lgkmcnt(8)
  v_mfma_f32_16x16x32_bf16 v[64:67], v[40:43], v[232:235], v[64:67]
  ds_read_b64_tr_b16 v[36:37], v57 offset:8192
  v_mfma_f32_16x16x32_bf16 v[68:71], v[40:43], v[236:239], v[68:71]
  ds_read_b64_tr_b16 v[38:39], v57 offset:12288
  s_bfe_u32 s19, s37, 0x10001
  s_lshl_b32 s19, s19, 10
  s_waitcnt lgkmcnt(8)
  v_mfma_f32_16x16x32_bf16 v[72:75], v[44:47], v[232:235], v[72:75]
  v_add_u32 v58, s60, v58
  ds_read_b64_tr_b16 v[40:41], v58 offset:0
  v_mfma_f32_16x16x32_bf16 v[76:79], v[44:47], v[236:239], v[76:79]
  ds_read_b64_tr_b16 v[42:43], v58 offset:4096
  s_add_u32 s40, s40, s19
  s_and_b32 s19, s37, 1
  s_waitcnt vmcnt(2) lgkmcnt(8)
  v_mfma_f32_16x16x32_bf16 v[64:67], v[48:51], v[240:243], v[64:67]
  v_add_u32 v59, s60, v59
  ds_read_b64_tr_b16 v[44:45], v59 offset:0
  v_mfma_f32_16x16x32_bf16 v[68:71], v[48:51], v[244:247], v[68:71]
  ds_read_b64_tr_b16 v[46:47], v59 offset:4096
  s_lshl_b32 s19, s19, 7
  s_add_u32 s40, s40, s19
  s_waitcnt lgkmcnt(8)
  v_mfma_f32_16x16x32_bf16 v[72:75], v[52:55], v[240:243], v[72:75]
  ds_read_b64_tr_b16 v[48:49], v58 offset:8192
  v_mfma_f32_16x16x32_bf16 v[76:79], v[52:55], v[244:247], v[76:79]
  ds_read_b64_tr_b16 v[50:51], v58 offset:12288
  s_lshl_b32 s19, s12, 12
  s_add_u32 s40, s40, s19
  s_waitcnt vmcnt(0) lgkmcnt(8)
  v_mfma_f32_16x16x32_bf16 v[64:67], v[32:35], v[248:251], v[64:67]
  ds_read_b64_tr_b16 v[52:53], v59 offset:8192
  v_mfma_f32_16x16x32_bf16 v[68:71], v[32:35], v[252:255], v[68:71]
  ds_read_b64_tr_b16 v[54:55], v59 offset:12288
  s_add_u32 s41, s41, s40
  v_and_b32 v27, 7, v0
  s_waitcnt lgkmcnt(8)
  v_mfma_f32_16x16x32_bf16 v[72:75], v[36:39], v[248:251], v[72:75]
  v_add_u32 v58, s61, v58
  ds_read_b64_tr_b16 v[32:33], v58 offset:0
  v_mfma_f32_16x16x32_bf16 v[76:79], v[36:39], v[252:255], v[76:79]
  ds_read_b64_tr_b16 v[34:35], v58 offset:4096
  v_bfe_u32 v30, v0, 3, 1
  v_lshrrev_b32 v31, 4, v0
  s_waitcnt lgkmcnt(8)
  v_mfma_f32_16x16x32_bf16 v[80:83], v[40:43], v[224:227], v[80:83]
  v_add_u32 v59, s61, v59
  ds_read_b64_tr_b16 v[36:37], v59 offset:0
  v_mfma_f32_16x16x32_bf16 v[84:87], v[40:43], v[228:231], v[84:87]
  ds_read_b64_tr_b16 v[38:39], v59 offset:4096
  v_lshlrev_b32 v22, 4, v27
  v_lshl_add_u32 v22, v31, 8, v22
  s_waitcnt lgkmcnt(8)
  v_mfma_f32_16x16x32_bf16 v[88:91], v[44:47], v[224:227], v[88:91]
  ds_read_b64_tr_b16 v[40:41], v58 offset:8192
  v_mfma_f32_16x16x32_bf16 v[92:95], v[44:47], v[228:231], v[92:95]
  ds_read_b64_tr_b16 v[42:43], v58 offset:12288
  v_cvt_pk_bf16_f32 v128, v64, v65
  v_cvt_pk_bf16_f32 v129, v66, v67
  v_cvt_pk_bf16_f32 v130, v72, v73
  v_cvt_pk_bf16_f32 v131, v74, v75
  buffer_store_dwordx4 v[128:131], v5, s[24:27], s6 offen offset:0 sc1
  v_lshl_add_u32 v22, v30, 11, v22
  v_lshlrev_b32 v23, 10, v27
  s_waitcnt lgkmcnt(8)
  v_mfma_f32_16x16x32_bf16 v[80:83], v[48:51], v[232:235], v[80:83]
  ds_read_b64_tr_b16 v[44:45], v59 offset:8192
  v_mfma_f32_16x16x32_bf16 v[84:87], v[48:51], v[236:239], v[84:87]
  ds_read_b64_tr_b16 v[46:47], v59 offset:12288
  v_lshl_add_u32 v23, v30, 6, v23
  v_and_b32 v24, 1, v31
  s_waitcnt lgkmcnt(8)
  v_mfma_f32_16x16x32_bf16 v[88:91], v[52:55], v[232:235], v[88:91]
  v_add_u32 v60, s60, v60
  ds_read_b64_tr_b16 v[48:49], v60 offset:0
  v_mfma_f32_16x16x32_bf16 v[92:95], v[52:55], v[236:239], v[92:95]
  ds_read_b64_tr_b16 v[50:51], v60 offset:4096
  v_lshl_add_u32 v23, v24, 5, v23
  v_lshrrev_b32 v24, 1, v31
  s_waitcnt lgkmcnt(8)
  v_mfma_f32_16x16x32_bf16 v[80:83], v[32:35], v[240:243], v[80:83]
  v_add_u32 v61, s60, v61
  ds_read_b64_tr_b16 v[52:53], v61 offset:0
  v_mfma_f32_16x16x32_bf16 v[84:87], v[32:35], v[244:247], v[84:87]
  ds_read_b64_tr_b16 v[54:55], v61 offset:4096
  v_lshl_add_u32 v23, v24, 4, v23
  v_lshlrev_b32 v24, 4, v31
  s_waitcnt lgkmcnt(8)
  v_mfma_f32_16x16x32_bf16 v[88:91], v[36:39], v[240:243], v[88:91]
  ds_read_b64_tr_b16 v[32:33], v60 offset:8192
  v_mfma_f32_16x16x32_bf16 v[92:95], v[36:39], v[244:247], v[92:95]
  ds_read_b64_tr_b16 v[34:35], v60 offset:12288
  v_cvt_pk_bf16_f32 v132, v68, v69
  v_cvt_pk_bf16_f32 v133, v70, v71
  v_cvt_pk_bf16_f32 v134, v76, v77
  v_cvt_pk_bf16_f32 v135, v78, v79
  buffer_store_dwordx4 v[132:135], v5, s[24:27], s6 offen offset:1024 sc1
  v_lshl_add_u32 v24, v30, 7, v24
  v_lshlrev_b32 v25, 6, v27
  s_waitcnt lgkmcnt(8)
  v_mfma_f32_16x16x32_bf16 v[80:83], v[40:43], v[248:251], v[80:83]
  ds_read_b64_tr_b16 v[36:37], v61 offset:8192
  v_mfma_f32_16x16x32_bf16 v[84:87], v[40:43], v[252:255], v[84:87]
  ds_read_b64_tr_b16 v[38:39], v61 offset:12288
  v_add_u32 v25, 131072, v25
  s_lshl_b32 s37, s12, 3
  s_waitcnt lgkmcnt(8)
  v_mfma_f32_16x16x32_bf16 v[88:91], v[44:47], v[248:251], v[88:91]
  v_add_u32 v60, s61, v60
  ds_read_b64_tr_b16 v[40:41], v60 offset:0
  v_mfma_f32_16x16x32_bf16 v[92:95], v[44:47], v[252:255], v[92:95]
  ds_read_b64_tr_b16 v[42:43], v60 offset:4096
  v_add_u32 v26, s37, v25
  v_lshlrev_b32 v27, 2, v27
  s_waitcnt lgkmcnt(8)
  v_mfma_f32_16x16x32_bf16 v[96:99], v[48:51], v[224:227], v[96:99]
  v_add_u32 v61, s61, v61
  ds_read_b64_tr_b16 v[44:45], v61 offset:0
  v_mfma_f32_16x16x32_bf16 v[100:103], v[48:51], v[228:231], v[100:103]
  ds_read_b64_tr_b16 v[46:47], v61 offset:4096
  v_and_b32 v29, 12, v27
  s_waitcnt lgkmcnt(8)
  v_mfma_f32_16x16x32_bf16 v[104:107], v[52:55], v[224:227], v[104:107]
  ds_read_b64_tr_b16 v[48:49], v60 offset:8192
  v_mfma_f32_16x16x32_bf16 v[108:111], v[52:55], v[228:231], v[108:111]
  ds_read_b64_tr_b16 v[50:51], v60 offset:12288
  v_cvt_pk_bf16_f32 v136, v80, v81
  v_cvt_pk_bf16_f32 v137, v82, v83
  v_cvt_pk_bf16_f32 v138, v88, v89
  v_cvt_pk_bf16_f32 v139, v90, v91
  buffer_store_dwordx4 v[136:139], v5, s[24:27], s6 offen offset:2048 sc1
  s_waitcnt lgkmcnt(8)
  v_mfma_f32_16x16x32_bf16 v[96:99], v[32:35], v[232:235], v[96:99]
  ds_read_b64_tr_b16 v[52:53], v61 offset:8192
  v_mfma_f32_16x16x32_bf16 v[100:103], v[32:35], v[236:239], v[100:103]
  ds_read_b64_tr_b16 v[54:55], v61 offset:12288
  s_waitcnt lgkmcnt(8)
  v_mfma_f32_16x16x32_bf16 v[104:107], v[36:39], v[232:235], v[104:107]
  v_add_u32 v62, s60, v62
  ds_read_b64_tr_b16 v[32:33], v62 offset:0
  v_mfma_f32_16x16x32_bf16 v[108:111], v[36:39], v[236:239], v[108:111]
  ds_read_b64_tr_b16 v[34:35], v62 offset:4096
  s_waitcnt lgkmcnt(8)
  v_mfma_f32_16x16x32_bf16 v[96:99], v[40:43], v[240:243], v[96:99]
  v_add_u32 v63, s60, v63
  ds_read_b64_tr_b16 v[36:37], v63 offset:0
  v_mfma_f32_16x16x32_bf16 v[100:103], v[40:43], v[244:247], v[100:103]
  ds_read_b64_tr_b16 v[38:39], v63 offset:4096
  s_waitcnt lgkmcnt(8)
  v_mfma_f32_16x16x32_bf16 v[104:107], v[44:47], v[240:243], v[104:107]
  ds_read_b64_tr_b16 v[40:41], v62 offset:8192
  v_mfma_f32_16x16x32_bf16 v[108:111], v[44:47], v[244:247], v[108:111]
  ds_read_b64_tr_b16 v[42:43], v62 offset:12288
  v_cvt_pk_bf16_f32 v140, v84, v85
  v_cvt_pk_bf16_f32 v141, v86, v87
  v_cvt_pk_bf16_f32 v142, v92, v93
  v_cvt_pk_bf16_f32 v143, v94, v95
  buffer_store_dwordx4 v[140:143], v5, s[24:27], s6 offen offset:3072 sc1
  s_waitcnt lgkmcnt(8)
  v_mfma_f32_16x16x32_bf16 v[96:99], v[48:51], v[248:251], v[96:99]
  ds_read_b64_tr_b16 v[44:45], v63 offset:8192
  v_mfma_f32_16x16x32_bf16 v[100:103], v[48:51], v[252:255], v[100:103]
  ds_read_b64_tr_b16 v[46:47], v63 offset:12288
  s_waitcnt lgkmcnt(8)
  v_mfma_f32_16x16x32_bf16 v[104:107], v[52:55], v[248:251], v[104:107]
  v_add_u32 v62, s61, v62
  ds_read_b64_tr_b16 v[48:49], v62 offset:0
  v_mfma_f32_16x16x32_bf16 v[108:111], v[52:55], v[252:255], v[108:111]
  ds_read_b64_tr_b16 v[50:51], v62 offset:4096
  s_waitcnt lgkmcnt(8)
  v_mfma_f32_16x16x32_bf16 v[112:115], v[32:35], v[224:227], v[112:115]
  v_add_u32 v63, s61, v63
  ds_read_b64_tr_b16 v[52:53], v63 offset:0
  v_mfma_f32_16x16x32_bf16 v[116:119], v[32:35], v[228:231], v[116:119]
  ds_read_b64_tr_b16 v[54:55], v63 offset:4096
  s_waitcnt lgkmcnt(8)
  v_mfma_f32_16x16x32_bf16 v[120:123], v[36:39], v[224:227], v[120:123]
  ds_read_b64_tr_b16 v[32:33], v62 offset:8192
  v_mfma_f32_16x16x32_bf16 v[124:127], v[36:39], v[228:231], v[124:127]
  ds_read_b64_tr_b16 v[34:35], v62 offset:12288
  v_cvt_pk_bf16_f32 v144, v96, v97
  v_cvt_pk_bf16_f32 v145, v98, v99
  v_cvt_pk_bf16_f32 v146, v104, v105
  v_cvt_pk_bf16_f32 v147, v106, v107
  buffer_store_dwordx4 v[144:147], v5, s[24:27], s7 offen offset:0 sc1
  s_waitcnt lgkmcnt(8)
  v_mfma_f32_16x16x32_bf16 v[112:115], v[40:43], v[232:235], v[112:115]
  ds_read_b64_tr_b16 v[36:37], v63 offset:8192
  v_mfma_f32_16x16x32_bf16 v[116:119], v[40:43], v[236:239], v[116:119]
  ds_read_b64_tr_b16 v[38:39], v63 offset:12288
  s_waitcnt lgkmcnt(8)
  v_mfma_f32_16x16x32_bf16 v[120:123], v[44:47], v[232:235], v[120:123]
  v_mfma_f32_16x16x32_bf16 v[124:127], v[44:47], v[236:239], v[124:127]
  s_mov_b32 s52, s10
  s_mov_b32 s53, s11
  s_mov_b32 s54, 0x3000
  s_waitcnt lgkmcnt(6)
  v_mfma_f32_16x16x32_bf16 v[112:115], v[48:51], v[240:243], v[112:115]
  v_mfma_f32_16x16x32_bf16 v[116:119], v[48:51], v[244:247], v[116:119]
  s_mov_b32 s55, 0x20000
  s_add_u32 s56, s10, 0x5000000
  s_addc_u32 s57, s11, 0
  s_waitcnt lgkmcnt(4)
  v_mfma_f32_16x16x32_bf16 v[120:123], v[52:55], v[240:243], v[120:123]
  v_mfma_f32_16x16x32_bf16 v[124:127], v[52:55], v[244:247], v[124:127]
  v_cvt_pk_bf16_f32 v148, v100, v101
  v_cvt_pk_bf16_f32 v149, v102, v103
  v_cvt_pk_bf16_f32 v150, v108, v109
  v_cvt_pk_bf16_f32 v151, v110, v111
  buffer_store_dwordx4 v[148:151], v5, s[24:27], s7 offen offset:1024 sc1
  s_mov_b32 s58, 0x200000
  s_mov_b32 s59, 0x20000
  s_waitcnt lgkmcnt(2)
  v_mfma_f32_16x16x32_bf16 v[112:115], v[32:35], v[248:251], v[112:115]
  v_mfma_f32_16x16x32_bf16 v[116:119], v[32:35], v[252:255], v[116:119]
  s_waitcnt lgkmcnt(0)
  v_mfma_f32_16x16x32_bf16 v[120:123], v[36:39], v[248:251], v[120:123]
  v_mfma_f32_16x16x32_bf16 v[124:127], v[36:39], v[252:255], v[124:127]
  s_nop 5
  v_cvt_pk_bf16_f32 v152, v112, v113
  v_cvt_pk_bf16_f32 v153, v114, v115
  v_cvt_pk_bf16_f32 v154, v120, v121
  v_cvt_pk_bf16_f32 v155, v122, v123
  buffer_store_dwordx4 v[152:155], v5, s[24:27], s7 offen offset:2048 sc1
  v_cvt_pk_bf16_f32 v156, v116, v117
  v_cvt_pk_bf16_f32 v157, v118, v119
  v_cvt_pk_bf16_f32 v158, v124, v125
  v_cvt_pk_bf16_f32 v159, v126, v127
  buffer_store_dwordx4 v[156:159], v5, s[24:27], s7 offen offset:3072 sc1
  s_mov_b32 s4, s94
  s_mov_b32 s5, s95
  s_mov_b32 s6, 0x200000
  s_mov_b32 s7, 0x20000
  s_barrier
  buffer_load_dwordx4 v[8:11], v23, s[4:7], s13 offen
  s_add_u32 s37, s63, 4096
  buffer_load_dwordx4 v[64:67], v24, s[52:55], s37 offen sc1
  buffer_load_dwordx4 v[68:71], v24, s[52:55], s37 offen offset:64 sc1
  s_add_u32 s37, s63, 8192
  buffer_load_dwordx4 v[72:75], v24, s[52:55], s37 offen sc1
  buffer_load_dwordx4 v[76:79], v24, s[52:55], s37 offen offset:64 sc1
  s_add_u32 s37, s63, 6144
  buffer_load_dwordx4 v[80:83], v24, s[52:55], s37 offen sc1
  buffer_load_dwordx4 v[84:87], v24, s[52:55], s37 offen offset:64 sc1
  s_cmp_ge_u32 s2, 224
  s_cbranch_scc1 kvattn_kernel_ti1
  s_add_u32 m0, s36, 0
  s_add_u32 s37, s35, 0
  buffer_load_dwordx4 v12, s[20:23], s37 offen lds
  s_add_u32 m0, s36, 8192
  s_add_u32 s37, s35, 0
  buffer_load_dwordx4 v12, s[28:31], s37 offen lds
  s_add_u32 m0, s36, 16384
  s_add_u32 s37, s35, 229376
  buffer_load_dwordx4 v12, s[20:23], s37 offen lds
  s_add_u32 m0, s36, 24576
  s_add_u32 s37, s35, 229376
  buffer_load_dwordx4 v12, s[28:31], s37 offen lds
  s_waitcnt vmcnt(11)
  s_branch kvattn_kernel_tj1
kvattn_kernel_ti1:
  s_waitcnt vmcnt(7)
kvattn_kernel_tj1:
  s_mov_b64 exec, 1
  buffer_store_dword v4, off, s[96:99], s101 offset:0 sc1
  s_mov_b64 exec, -1
  s_or_b32 s62, s2, s12
  s_cbranch_scc1 kvattn_kernel_tne
  s_mov_b32 s62, 425984
  s_mov_b64 exec, 1
  buffer_store_dword v4, off, s[96:99], s62 offset:0 sc1
  s_mov_b64 exec, -1
kvattn_kernel_tne:
  buffer_load_dword v3, v27, s[96:99], s9 offen sc1
  s_waitcnt vmcnt(0)
  v_cmp_ne_u32 vcc, s85, v3
  s_cbranch_vccnz kvattn_kernel_gpo
  s_add_u32 s19, s41, 0
  buffer_load_dwordx4 v[32:35], v22, s[24:27], s19 offen sc1
  s_add_u32 s19, s41, 32768
  buffer_load_dwordx4 v[36:39], v22, s[24:27], s19 offen sc1
  s_add_u32 s19, s41, 65536
  buffer_load_dwordx4 v[40:43], v22, s[24:27], s19 offen sc1
  s_add_u32 s19, s41, 98304
  buffer_load_dwordx4 v[44:47], v22, s[24:27], s19 offen sc1
  s_add_u32 s19, s41, 131072
  buffer_load_dwordx4 v[48:51], v22, s[24:27], s19 offen sc1
  s_add_u32 s19, s41, 163840
  buffer_load_dwordx4 v[52:55], v22, s[24:27], s19 offen sc1
  s_add_u32 s19, s41, 196608
  buffer_load_dwordx4 v[56:59], v22, s[24:27], s19 offen sc1
  s_add_u32 s19, s41, 229376
  buffer_load_dwordx4 v[60:63], v22, s[24:27], s19 offen sc1
  s_cmp_ge_u32 s2, 224
  s_cbranch_scc1 kvattn_kernel_ti2
  s_add_u32 m0, s36, 32768
  s_add_u32 s37, s35, 458752
  buffer_load_dwordx4 v12, s[20:23], s37 offen lds
  s_add_u32 m0, s36, 40960
  s_add_u32 s37, s35, 458752
  buffer_load_dwordx4 v12, s[28:31], s37 offen lds
  s_add_u32 m0, s36, 49152
  s_add_u32 s37, s35, 688128
  buffer_load_dwordx4 v12, s[20:23], s37 offen lds
  s_add_u32 m0, s36, 57344
  s_add_u32 s37, s35, 688128
  buffer_load_dwordx4 v12, s[28:31], s37 offen lds
  s_add_u32 m0, s36, 65536
  s_add_u32 s37, s35, 917504
  buffer_load_dwordx4 v12, s[20:23], s37 offen lds
  s_add_u32 m0, s36, 73728
  s_add_u32 s37, s35, 917504
  buffer_load_dwordx4 v12, s[28:31], s37 offen lds
  s_add_u32 m0, s36, 81920
  s_add_u32 s37, s35, 1146880
  buffer_load_dwordx4 v12, s[20:23], s37 offen lds
  s_add_u32 m0, s36, 90112
  s_add_u32 s37, s35, 1146880
  buffer_load_dwordx4 v12, s[28:31], s37 offen lds
  s_add_u32 m0, s36, 98304
  s_add_u32 s37, s35, 1376256
  buffer_load_dwordx4 v12, s[20:23], s37 offen lds
  s_add_u32 m0, s36, 106496
  s_add_u32 s37, s35, 1376256
  buffer_load_dwordx4 v12, s[28:31], s37 offen lds
  s_add_u32 m0, s36, 114688
  s_add_u32 s37, s35, 1605632
  buffer_load_dwordx4 v12, s[20:23], s37 offen lds
  s_add_u32 m0, s36, 122880
  s_add_u32 s37, s35, 1605632
  buffer_load_dwordx4 v12, s[28:31], s37 offen lds
  s_branch kvattn_kernel_tj2
kvattn_kernel_ti2:
  s_waitcnt vmcnt(0)
kvattn_kernel_tj2:
  v_xor_b32 v64, s85, v64
  v_xor_b32 v65, s85, v65
  v_xor_b32 v66, s85, v66
  v_xor_b32 v67, s85, v67
  v_xor_b32 v68, s85, v68
  v_xor_b32 v69, s85, v69
  v_xor_b32 v70, s85, v70
  v_xor_b32 v71, s85, v71
  v_xor_b32 v72, s85, v72
  v_xor_b32 v73, s85, v73
  v_xor_b32 v74, s85, v74
  v_xor_b32 v75, s85, v75
  v_xor_b32 v76, s85, v76
  v_xor_b32 v77, s85, v77
  v_xor_b32 v78, s85, v78
  v_xor_b32 v79, s85, v79
  v_xor_b32 v80, s85, v80
  v_xor_b32 v81, s85, v81
  v_xor_b32 v82, s85, v82
  v_xor_b32 v83, s85, v83
  v_xor_b32 v84, s85, v84
  v_xor_b32 v85, s85, v85
  v_xor_b32 v86, s85, v86
  v_xor_b32 v87, s85, v87
  s_waitcnt vmcnt(19)
  v_lshlrev_b32 v88, 16, v32
  v_and_b32 v89, 0xffff0000, v32
  v_lshlrev_b32 v90, 16, v33
  v_and_b32 v91, 0xffff0000, v33
  v_lshlrev_b32 v92, 16, v34
  v_and_b32 v93, 0xffff0000, v34
  v_lshlrev_b32 v94, 16, v35
  v_and_b32 v95, 0xffff0000, v35
  v_permlane16_swap_b32 v8, v10
  v_permlane16_swap_b32 v9, v11
  s_waitcnt vmcnt(18)
  v_lshlrev_b32 v136, 16, v36
  v_and_b32 v137, 0xffff0000, v36
  v_lshlrev_b32 v138, 16, v37
  v_and_b32 v139, 0xffff0000, v37
  v_lshlrev_b32 v140, 16, v38
  v_and_b32 v141, 0xffff0000, v38
  v_lshlrev_b32 v142, 16, v39
  v_and_b32 v143, 0xffff0000, v39
  v_pk_add_f32 v[88:89], v[88:89], v[136:137]
  v_pk_add_f32 v[90:91], v[90:91], v[138:139]
  v_pk_add_f32 v[92:93], v[92:93], v[140:141]
  v_pk_add_f32 v[94:95], v[94:95], v[142:143]
  s_waitcnt vmcnt(17)
  v_lshlrev_b32 v144, 16, v40
  v_and_b32 v145, 0xffff0000, v40
  v_lshlrev_b32 v146, 16, v41
  v_and_b32 v147, 0xffff0000, v41
  v_lshlrev_b32 v148, 16, v42
  v_and_b32 v149, 0xffff0000, v42
  v_lshlrev_b32 v150, 16, v43
  v_and_b32 v151, 0xffff0000, v43
  s_waitcnt vmcnt(16)
  v_lshlrev_b32 v152, 16, v44
  v_and_b32 v153, 0xffff0000, v44
  v_lshlrev_b32 v154, 16, v45
  v_and_b32 v155, 0xffff0000, v45
  v_lshlrev_b32 v156, 16, v46
  v_and_b32 v157, 0xffff0000, v46
  v_lshlrev_b32 v158, 16, v47
  v_and_b32 v159, 0xffff0000, v47
  v_pk_add_f32 v[144:145], v[144:145], v[152:153]
  v_pk_add_f32 v[146:147], v[146:147], v[154:155]
  v_pk_add_f32 v[148:149], v[148:149], v[156:157]
  v_pk_add_f32 v[150:151], v[150:151], v[158:159]
  v_pk_add_f32 v[88:89], v[88:89], v[144:145]
  v_pk_add_f32 v[90:91], v[90:91], v[146:147]
  v_pk_add_f32 v[92:93], v[92:93], v[148:149]
  v_pk_add_f32 v[94:95], v[94:95], v[150:151]
  s_waitcnt vmcnt(15)
  v_lshlrev_b32 v160, 16, v48
  v_and_b32 v161, 0xffff0000, v48
  v_lshlrev_b32 v162, 16, v49
  v_and_b32 v163, 0xffff0000, v49
  v_lshlrev_b32 v164, 16, v50
  v_and_b32 v165, 0xffff0000, v50
  v_lshlrev_b32 v166, 16, v51
  v_and_b32 v167, 0xffff0000, v51
  s_waitcnt vmcnt(14)
  v_lshlrev_b32 v168, 16, v52
  v_and_b32 v169, 0xffff0000, v52
  v_lshlrev_b32 v170, 16, v53
  v_and_b32 v171, 0xffff0000, v53
  v_lshlrev_b32 v172, 16, v54
  v_and_b32 v173, 0xffff0000, v54
  v_lshlrev_b32 v174, 16, v55
  v_and_b32 v175, 0xffff0000, v55
  v_pk_add_f32 v[160:161], v[160:161], v[168:169]
  v_pk_add_f32 v[162:163], v[162:163], v[170:171]
  v_pk_add_f32 v[164:165], v[164:165], v[172:173]
  v_pk_add_f32 v[166:167], v[166:167], v[174:175]
  s_waitcnt vmcnt(13)
  v_lshlrev_b32 v176, 16, v56
  v_and_b32 v177, 0xffff0000, v56
  v_lshlrev_b32 v178, 16, v57
  v_and_b32 v179, 0xffff0000, v57
  v_lshlrev_b32 v180, 16, v58
  v_and_b32 v181, 0xffff0000, v58
  v_lshlrev_b32 v182, 16, v59
  v_and_b32 v183, 0xffff0000, v59
  s_waitcnt vmcnt(12)
  v_lshlrev_b32 v184, 16, v60
  v_and_b32 v185, 0xffff0000, v60
  v_lshlrev_b32 v186, 16, v61
  v_and_b32 v187, 0xffff0000, v61
  v_lshlrev_b32 v188, 16, v62
  v_and_b32 v189, 0xffff0000, v62
  v_lshlrev_b32 v190, 16, v63
  v_and_b32 v191, 0xffff0000, v63
  v_pk_add_f32 v[176:177], v[176:177], v[184:185]
  v_pk_add_f32 v[178:179], v[178:179], v[186:187]
  v_pk_add_f32 v[180:181], v[180:181], v[188:189]
  v_pk_add_f32 v[182:183], v[182:183], v[190:191]
  v_pk_add_f32 v[160:161], v[160:161], v[176:177]
  v_pk_add_f32 v[162:163], v[162:163], v[178:179]
  v_pk_add_f32 v[164:165], v[164:165], v[180:181]
  v_pk_add_f32 v[166:167], v[166:167], v[182:183]
  v_pk_add_f32 v[88:89], v[88:89], v[160:161]
  v_pk_add_f32 v[90:91], v[90:91], v[162:163]
  v_pk_add_f32 v[92:93], v[92:93], v[164:165]
  v_pk_add_f32 v[94:95], v[94:95], v[166:167]
kvattn_kernel_gpr:
  s_add_u32 s24, s10, 0x5400000
  s_addc_u32 s25, s11, 0
  s_mov_b32 s26, 0x700000
  s_mov_b32 s27, 0x20000
  v_lshlrev_b32 v96, 16, v8
  v_and_b32 v97, 0xffff0000, v8
  v_lshlrev_b32 v98, 16, v9
  v_and_b32 v99, 0xffff0000, v9
  v_lshlrev_b32 v100, 16, v10
  v_and_b32 v101, 0xffff0000, v10
  v_lshlrev_b32 v102, 16, v11
  v_and_b32 v103, 0xffff0000, v11
  v_pk_fma_f32 v[96:97], v[64:65], v[88:89], v[96:97]
  v_pk_fma_f32 v[98:99], v[66:67], v[90:91], v[98:99]
  v_pk_fma_f32 v[100:101], v[68:69], v[92:93], v[100:101]
  v_pk_fma_f32 v[102:103], v[70:71], v[94:95], v[102:103]
  v_cvt_pk_bf16_f32 v8, v96, v97
  v_cvt_pk_bf16_f32 v9, v98, v99
  v_cvt_pk_bf16_f32 v10, v100, v101
  v_cvt_pk_bf16_f32 v11, v102, v103
  buffer_store_dwordx4 v[8:11], v22, s[56:59], s40 offen sc1
  v_lshlrev_b32 v96, 16, v8
  v_and_b32 v97, 0xffff0000, v8
  v_lshlrev_b32 v98, 16, v9
  v_and_b32 v99, 0xffff0000, v9
  v_lshlrev_b32 v100, 16, v10
  v_and_b32 v101, 0xffff0000, v10
  v_lshlrev_b32 v102, 16, v11
  v_and_b32 v103, 0xffff0000, v11
  v_add_f32 v104, v96, v97
  v_mul_f32 v105, v96, v96
  v_fmac_f32 v105, v97, v97
  v_add_f32 v104, v104, v98
  v_fmac_f32 v105, v98, v98
  v_add_f32 v104, v104, v99
  v_fmac_f32 v105, v99, v99
  v_add_f32 v104, v104, v100
  v_fmac_f32 v105, v100, v100
  v_add_f32 v104, v104, v101
  v_fmac_f32 v105, v101, v101
  v_add_f32 v104, v104, v102
  v_fmac_f32 v105, v102, v102
  v_add_f32 v104, v104, v103
  v_fmac_f32 v105, v103, v103
  s_nop 0
  v_add_f32_dpp v104, v104, v104 row_ror:8 row_mask:0xf bank_mask:0xf
  v_add_f32_dpp v105, v105, v105 row_ror:8 row_mask:0xf bank_mask:0xf
  v_mov_b32 v106, v104
  v_mov_b32 v107, v105
  s_nop 1
  v_permlane16_swap_b32 v106, v104
  v_permlane16_swap_b32 v107, v105
  s_nop 0
  v_pk_add_f32 v[104:105], v[104:105], v[106:107]
  v_mov_b32 v106, v104
  v_mov_b32 v107, v105
  s_nop 1
  v_permlane32_swap_b32 v106, v104
  v_permlane32_swap_b32 v107, v105
  s_nop 0
  v_pk_add_f32 v[104:105], v[104:105], v[106:107]
  s_mov_b64 exec, 0xff
  ds_write_b64 v26, v[104:105]
  s_mov_b64 exec, -1
  s_waitcnt lgkmcnt(0)
  s_barrier
  ds_read_b128 v[108:111], v25 offset:0
  ds_read_b128 v[112:115], v25 offset:16
  ds_read_b128 v[116:119], v25 offset:32
  ds_read_b128 v[120:123], v25 offset:48
  s_waitcnt lgkmcnt(0)
  v_pk_add_f32 v[108:109], v[108:109], v[116:117]
  v_pk_add_f32 v[110:111], v[110:111], v[118:119]
  v_pk_add_f32 v[112:113], v[112:113], v[120:121]
  v_pk_add_f32 v[114:115], v[114:115], v[122:123]
  v_pk_add_f32 v[108:109], v[108:109], v[112:113]
  v_pk_add_f32 v[110:111], v[110:111], v[114:115]
  v_pk_add_f32 v[108:109], v[108:109], v[110:111]
  v_mul_f32 v108, 0xbb000000, v108
  v_mov_b32 v110, 0x3727c5ac
  v_fmac_f32 v110, 0x3b000000, v109
  v_fma_f32 v110, -v108, v108, v110
  v_max_f32 v110, 0x3727c5ac, v110
  v_rsq_f32 v110, v110
  v_pk_add_f32 v[96:97], v[96:97], v[108:109] op_sel_hi:[1,0]
  v_pk_add_f32 v[98:99], v[98:99], v[108:109] op_sel_hi:[1,0]
  v_pk_add_f32 v[100:101], v[100:101], v[108:109] op_sel_hi:[1,0]
  v_pk_add_f32 v[102:103], v[102:103], v[108:109] op_sel_hi:[1,0]
  v_pk_mul_f32 v[96:97], v[96:97], v[110:111] op_sel_hi:[1,0]
  v_pk_mul_f32 v[98:99], v[98:99], v[110:111] op_sel_hi:[1,0]
  v_pk_mul_f32 v[100:101], v[100:101], v[110:111] op_sel_hi:[1,0]
  v_pk_mul_f32 v[102:103], v[102:103], v[110:111] op_sel_hi:[1,0]
  v_pk_fma_f32 v[96:97], v[96:97], v[72:73], v[80:81]
  v_pk_fma_f32 v[98:99], v[98:99], v[74:75], v[82:83]
  v_pk_fma_f32 v[100:101], v[100:101], v[76:77], v[84:85]
  v_pk_fma_f32 v[102:103], v[102:103], v[78:79], v[86:87]
  v_cvt_pk_bf16_f32 v88, v96, v97
  v_cvt_pk_bf16_f32 v89, v98, v99
  v_cvt_pk_bf16_f32 v90, v100, v101
  v_cvt_pk_bf16_f32 v91, v102, v103
  buffer_store_dwordx4 v[88:91], v22, s[44:47], s40 offen sc1
  s_waitcnt vmcnt(0)
  s_barrier
  s_mov_b64 exec, 1
  buffer_store_dword v4, off, s[96:99], s100 offset:0 sc1
  s_mov_b64 exec, -1
  s_cmp_ge_u32 s2, 224
  s_cbranch_scc1 kvattn_kernel_tidle
  buffer_load_dword v3, v29, s[96:99], s3 offen sc1
  s_waitcnt vmcnt(0)
  v_cmp_ne_u32 vcc, s85, v3
  s_cbranch_vccnz kvattn_kernel_tspinn
kvattn_kernel_treadyn:
  s_add_u32 s37, s34, 0
  buffer_load_dwordx4 v[128:131], v5, s[44:47], s37 offen offset:0 sc1
  s_add_u32 s37, s34, 0
  buffer_load_dwordx4 v[132:135], v5, s[44:47], s37 offen offset:1024 sc1
  s_add_u32 s37, s34, 0
  buffer_load_dwordx4 v[136:139], v5, s[44:47], s37 offen offset:2048 sc1
  s_add_u32 s37, s34, 0
  buffer_load_dwordx4 v[140:143], v5, s[44:47], s37 offen offset:3072 sc1
  s_add_u32 s37, s34, 4096
  buffer_load_dwordx4 v[144:147], v5, s[44:47], s37 offen offset:0 sc1
  s_add_u32 s37, s34, 4096
  buffer_load_dwordx4 v[148:151], v5, s[44:47], s37 offen offset:1024 sc1
  s_add_u32 s37, s34, 4096
  buffer_load_dwordx4 v[152:155], v5, s[44:47], s37 offen offset:2048 sc1
  s_add_u32 s37, s34, 4096
  buffer_load_dwordx4 v[156:159], v5, s[44:47], s37 offen offset:3072 sc1
  s_add_u32 s37, s34, 8192
  buffer_load_dwordx4 v[160:163], v5, s[44:47], s37 offen offset:0 sc1
  s_add_u32 s37, s34, 8192
  buffer_load_dwordx4 v[164:167], v5, s[44:47], s37 offen offset:1024 sc1
  s_add_u32 s37, s34, 8192
  buffer_load_dwordx4 v[168:171], v5, s[44:47], s37 offen offset:2048 sc1
  s_add_u32 s37, s34, 8192
  buffer_load_dwordx4 v[172:175], v5, s[44:47], s37 offen offset:3072 sc1
  ds_read_b64_tr_b16 v[32:33], v14 offset:0
  ds_read_b64_tr_b16 v[34:35], v14 offset:2048
  ds_read_b64_tr_b16 v[36:37], v15 offset:0
  ds_read_b64_tr_b16 v[38:39], v15 offset:2048
  ds_read_b64_tr_b16 v[40:41], v16 offset:0
  ds_read_b64_tr_b16 v[42:43], v16 offset:2048
  ds_read_b64_tr_b16 v[44:45], v17 offset:0
  ds_read_b64_tr_b16 v[46:47], v17 offset:2048
  ds_read_b64_tr_b16 v[48:49], v14 offset:8192
  ds_read_b64_tr_b16 v[50:51], v14 offset:10240
  s_waitcnt vmcnt(10) lgkmcnt(8)
  v_mfma_f32_16x16x32_bf16 v[64:67], v[32:35], v[128:131], 0
  ds_read_b64_tr_b16 v[52:53], v15 offset:8192
  v_mfma_f32_16x16x32_bf16 v[68:71], v[32:35], v[132:135], 0
  ds_read_b64_tr_b16 v[54:55], v15 offset:10240
  s_add_u32 s37, s34, 12288
  buffer_load_dwordx4 v[176:179], v5, s[44:47], s37 offen offset:0 sc1
  s_waitcnt lgkmcnt(8)
  v_mfma_f32_16x16x32_bf16 v[72:75], v[36:39], v[128:131], 0
  ds_read_b64_tr_b16 v[32:33], v16 offset:8192
  v_mfma_f32_16x16x32_bf16 v[76:79], v[36:39], v[132:135], 0
  ds_read_b64_tr_b16 v[34:35], v16 offset:10240
  s_waitcnt lgkmcnt(8)
  v_mfma_f32_16x16x32_bf16 v[80:83], v[40:43], v[128:131], 0
  ds_read_b64_tr_b16 v[36:37], v17 offset:8192
  v_mfma_f32_16x16x32_bf16 v[84:87], v[40:43], v[132:135], 0
  ds_read_b64_tr_b16 v[38:39], v17 offset:10240
  s_add_u32 s37, s34, 12288
  buffer_load_dwordx4 v[180:183], v5, s[44:47], s37 offen offset:1024 sc1
  s_waitcnt lgkmcnt(8)
  v_mfma_f32_16x16x32_bf16 v[88:91], v[44:47], v[128:131], 0
  ds_read_b64_tr_b16 v[40:41], v14 offset:4096
  v_mfma_f32_16x16x32_bf16 v[92:95], v[44:47], v[132:135], 0
  ds_read_b64_tr_b16 v[42:43], v14 offset:6144
  s_waitcnt lgkmcnt(8)
  v_mfma_f32_16x16x32_bf16 v[96:99], v[48:51], v[128:131], 0
  ds_read_b64_tr_b16 v[44:45], v15 offset:4096
  v_mfma_f32_16x16x32_bf16 v[100:103], v[48:51], v[132:135], 0
  ds_read_b64_tr_b16 v[46:47], v15 offset:6144
  s_add_u32 s37, s34, 12288
  buffer_load_dwordx4 v[184:187], v5, s[44:47], s37 offen offset:2048 sc1
  s_waitcnt lgkmcnt(8)
  v_mfma_f32_16x16x32_bf16 v[104:107], v[52:55], v[128:131], 0
  ds_read_b64_tr_b16 v[48:49], v16 offset:4096
  v_mfma_f32_16x16x32_bf16 v[108:111], v[52:55], v[132:135], 0
  ds_read_b64_tr_b16 v[50:51], v16 offset:6144
  s_waitcnt lgkmcnt(8)
  v_mfma_f32_16x16x32_bf16 v[112:115], v[32:35], v[128:131], 0
  ds_read_b64_tr_b16 v[52:53], v17 offset:4096
  v_mfma_f32_16x16x32_bf16 v[116:119], v[32:35], v[132:135], 0
  ds_read_b64_tr_b16 v[54:55], v17 offset:6144
  s_add_u32 s37, s34, 12288
  buffer_load_dwordx4 v[188:191], v5, s[44:47], s37 offen offset:3072 sc1
  s_waitcnt lgkmcnt(8)
  v_mfma_f32_16x16x32_bf16 v[120:123], v[36:39], v[128:131], 0
  ds_read_b64_tr_b16 v[32:33], v14 offset:12288
  v_mfma_f32_16x16x32_bf16 v[124:127], v[36:39], v[132:135], 0
  ds_read_b64_tr_b16 v[34:35], v14 offset:14336
  s_waitcnt vmcnt(12) lgkmcnt(8)
  v_mfma_f32_16x16x32_bf16 v[64:67], v[40:43], v[136:139], v[64:67]
  ds_read_b64_tr_b16 v[36:37], v15 offset:12288
  v_mfma_f32_16x16x32_bf16 v[68:71], v[40:43], v[140:143], v[68:71]
  ds_read_b64_tr_b16 v[38:39], v15 offset:14336
  s_add_u32 s37, s34, 16384
  buffer_load_dwordx4 v[192:195], v5, s[44:47], s37 offen offset:0 sc1
  s_waitcnt lgkmcnt(8)
  v_mfma_f32_16x16x32_bf16 v[72:75], v[44:47], v[136:139], v[72:75]
  ds_read_b64_tr_b16 v[40:41], v16 offset:12288
  v_mfma_f32_16x16x32_bf16 v[76:79], v[44:47], v[140:143], v[76:79]
  ds_read_b64_tr_b16 v[42:43], v16 offset:14336
  s_waitcnt lgkmcnt(8)
  v_mfma_f32_16x16x32_bf16 v[80:83], v[48:51], v[136:139], v[80:83]
  ds_read_b64_tr_b16 v[44:45], v17 offset:12288
  v_mfma_f32_16x16x32_bf16 v[84:87], v[48:51], v[140:143], v[84:87]
  ds_read_b64_tr_b16 v[46:47], v17 offset:14336
  s_add_u32 s37, s34, 16384
  buffer_load_dwordx4 v[196:199], v5, s[44:47], s37 offen offset:1024 sc1
  s_waitcnt lgkmcnt(8)
  v_mfma_f32_16x16x32_bf16 v[88:91], v[52:55], v[136:139], v[88:91]
  ds_read_b64_tr_b16 v[48:49], v14 offset:16384
  v_mfma_f32_16x16x32_bf16 v[92:95], v[52:55], v[140:143], v[92:95]
  ds_read_b64_tr_b16 v[50:51], v14 offset:18432
  s_waitcnt lgkmcnt(8)
  v_mfma_f32_16x16x32_bf16 v[96:99], v[32:35], v[136:139], v[96:99]
  ds_read_b64_tr_b16 v[52:53], v15 offset:16384
  v_mfma_f32_16x16x32_bf16 v[100:103], v[32:35], v[140:143], v[100:103]
  ds_read_b64_tr_b16 v[54:55], v15 offset:18432
  s_add_u32 s37, s34, 16384
  buffer_load_dwordx4 v[200:203], v5, s[44:47], s37 offen offset:2048 sc1
  s_waitcnt lgkmcnt(8)
  v_mfma_f32_16x16x32_bf16 v[104:107], v[36:39], v[136:139], v[104:107]
  ds_read_b64_tr_b16 v[32:33], v16 offset:16384
  v_mfma_f32_16x16x32_bf16 v[108:111], v[36:39], v[140:143], v[108:111]
  ds_read_b64_tr_b16 v[34:35], v16 offset:18432
  s_waitcnt lgkmcnt(8)
  v_mfma_f32_16x16x32_bf16 v[112:115], v[40:43], v[136:139], v[112:115]
  ds_read_b64_tr_b16 v[36:37], v17 offset:16384
  v_mfma_f32_16x16x32_bf16 v[116:119], v[40:43], v[140:143], v[116:119]
  ds_read_b64_tr_b16 v[38:39], v17 offset:18432
  s_add_u32 s37, s34, 16384
  buffer_load_dwordx4 v[204:207], v5, s[44:47], s37 offen offset:3072 sc1
  s_waitcnt lgkmcnt(8)
  v_mfma_f32_16x16x32_bf16 v[120:123], v[44:47], v[136:139], v[120:123]
  ds_read_b64_tr_b16 v[40:41], v14 offset:24576
  v_mfma_f32_16x16x32_bf16 v[124:127], v[44:47], v[140:143], v[124:127]
  ds_read_b64_tr_b16 v[42:43], v14 offset:26624
  s_waitcnt vmcnt(14) lgkmcnt(8)
  v_mfma_f32_16x16x32_bf16 v[64:67], v[48:51], v[144:147], v[64:67]
  ds_read_b64_tr_b16 v[44:45], v15 offset:24576
  v_mfma_f32_16x16x32_bf16 v[68:71], v[48:51], v[148:151], v[68:71]
  ds_read_b64_tr_b16 v[46:47], v15 offset:26624
  s_add_u32 s37, s34, 20480
  buffer_load_dwordx4 v[128:131], v5, s[44:47], s37 offen offset:0 sc1
  s_waitcnt lgkmcnt(8)
  v_mfma_f32_16x16x32_bf16 v[72:75], v[52:55], v[144:147], v[72:75]
  ds_read_b64_tr_b16 v[48:49], v16 offset:24576
  v_mfma_f32_16x16x32_bf16 v[76:79], v[52:55], v[148:151], v[76:79]
  ds_read_b64_tr_b16 v[50:51], v16 offset:26624
  s_waitcnt lgkmcnt(8)
  v_mfma_f32_16x16x32_bf16 v[80:83], v[32:35], v[144:147], v[80:83]
  ds_read_b64_tr_b16 v[52:53], v17 offset:24576
  v_mfma_f32_16x16x32_bf16 v[84:87], v[32:35], v[148:151], v[84:87]
  ds_read_b64_tr_b16 v[54:55], v17 offset:26624
  s_add_u32 s37, s34, 20480
  buffer_load_dwordx4 v[132:135], v5, s[44:47], s37 offen offset:1024 sc1
  s_waitcnt lgkmcnt(8)
  v_mfma_f32_16x16x32_bf16 v[88:91], v[36:39], v[144:147], v[88:91]
  ds_read_b64_tr_b16 v[32:33], v14 offset:20480
  v_mfma_f32_16x16x32_bf16 v[92:95], v[36:39], v[148:151], v[92:95]
  ds_read_b64_tr_b16 v[34:35], v14 offset:22528
  s_waitcnt lgkmcnt(8)
  v_mfma_f32_16x16x32_bf16 v[96:99], v[40:43], v[144:147], v[96:99]
  ds_read_b64_tr_b16 v[36:37], v15 offset:20480
  v_mfma_f32_16x16x32_bf16 v[100:103], v[40:43], v[148:151], v[100:103]
  ds_read_b64_tr_b16 v[38:39], v15 offset:22528
  s_add_u32 s37, s34, 20480
  buffer_load_dwordx4 v[136:139], v5, s[44:47], s37 offen offset:2048 sc1
  s_waitcnt lgkmcnt(8)
  v_mfma_f32_16x16x32_bf16 v[104:107], v[44:47], v[144:147], v[104:107]
  ds_read_b64_tr_b16 v[40:41], v16 offset:20480
  v_mfma_f32_16x16x32_bf16 v[108:111], v[44:47], v[148:151], v[108:111]
  ds_read_b64_tr_b16 v[42:43], v16 offset:22528
  s_waitcnt lgkmcnt(8)
  v_mfma_f32_16x16x32_bf16 v[112:115], v[48:51], v[144:147], v[112:115]
  ds_read_b64_tr_b16 v[44:45], v17 offset:20480
  v_mfma_f32_16x16x32_bf16 v[116:119], v[48:51], v[148:151], v[116:119]
  ds_read_b64_tr_b16 v[46:47], v17 offset:22528
  s_add_u32 s37, s34, 20480
  buffer_load_dwordx4 v[140:143], v5, s[44:47], s37 offen offset:3072 sc1
  s_waitcnt lgkmcnt(8)
  v_mfma_f32_16x16x32_bf16 v[120:123], v[52:55], v[144:147], v[120:123]
  ds_read_b64_tr_b16 v[48:49], v14 offset:28672
  v_mfma_f32_16x16x32_bf16 v[124:127], v[52:55], v[148:151], v[124:127]
  ds_read_b64_tr_b16 v[50:51], v14 offset:30720
  s_waitcnt vmcnt(16) lgkmcnt(8)
  v_mfma_f32_16x16x32_bf16 v[64:67], v[32:35], v[152:155], v[64:67]
  ds_read_b64_tr_b16 v[52:53], v15 offset:28672
  v_mfma_f32_16x16x32_bf16 v[68:71], v[32:35], v[156:159], v[68:71]
  ds_read_b64_tr_b16 v[54:55], v15 offset:30720
  s_waitcnt lgkmcnt(8)
  v_mfma_f32_16x16x32_bf16 v[72:75], v[36:39], v[152:155], v[72:75]
  ds_read_b64_tr_b16 v[32:33], v16 offset:28672
  v_mfma_f32_16x16x32_bf16 v[76:79], v[36:39], v[156:159], v[76:79]
  ds_read_b64_tr_b16 v[34:35], v16 offset:30720
  s_waitcnt lgkmcnt(8)
  v_mfma_f32_16x16x32_bf16 v[80:83], v[40:43], v[152:155], v[80:83]
  ds_read_b64_tr_b16 v[36:37], v17 offset:28672
  v_mfma_f32_16x16x32_bf16 v[84:87], v[40:43], v[156:159], v[84:87]
  ds_read_b64_tr_b16 v[38:39], v17 offset:30720
  s_waitcnt lgkmcnt(8)
  v_mfma_f32_16x16x32_bf16 v[88:91], v[44:47], v[152:155], v[88:91]
  ds_read_b64_tr_b16 v[40:41], v14 offset:32768
  v_mfma_f32_16x16x32_bf16 v[92:95], v[44:47], v[156:159], v[92:95]
  ds_read_b64_tr_b16 v[42:43], v14 offset:34816
  s_waitcnt lgkmcnt(8)
  v_mfma_f32_16x16x32_bf16 v[96:99], v[48:51], v[152:155], v[96:99]
  ds_read_b64_tr_b16 v[44:45], v15 offset:32768
  v_mfma_f32_16x16x32_bf16 v[100:103], v[48:51], v[156:159], v[100:103]
  ds_read_b64_tr_b16 v[46:47], v15 offset:34816
  s_waitcnt lgkmcnt(8)
  v_mfma_f32_16x16x32_bf16 v[104:107], v[52:55], v[152:155], v[104:107]
  ds_read_b64_tr_b16 v[48:49], v16 offset:32768
  v_mfma_f32_16x16x32_bf16 v[108:111], v[52:55], v[156:159], v[108:111]
  ds_read_b64_tr_b16 v[50:51], v16 offset:34816
  s_waitcnt lgkmcnt(8)
  v_mfma_f32_16x16x32_bf16 v[112:115], v[32:35], v[152:155], v[112:115]
  ds_read_b64_tr_b16 v[52:53], v17 offset:32768
  v_mfma_f32_16x16x32_bf16 v[116:119], v[32:35], v[156:159], v[116:119]
  ds_read_b64_tr_b16 v[54:55], v17 offset:34816
  s_waitcnt lgkmcnt(8)
  v_mfma_f32_16x16x32_bf16 v[120:123], v[36:39], v[152:155], v[120:123]
  ds_read_b64_tr_b16 v[32:33], v14 offset:40960
  v_mfma_f32_16x16x32_bf16 v[124:127], v[36:39], v[156:159], v[124:127]
  ds_read_b64_tr_b16 v[34:35], v14 offset:43008
  s_waitcnt vmcnt(14) lgkmcnt(8)
  v_mfma_f32_16x16x32_bf16 v[64:67], v[40:43], v[160:163], v[64:67]
  ds_read_b64_tr_b16 v[36:37], v15 offset:40960
  v_mfma_f32_16x16x32_bf16 v[68:71], v[40:43], v[164:167], v[68:71]
  ds_read_b64_tr_b16 v[38:39], v15 offset:43008
  s_barrier
  s_add_u32 s37, s34, 24576
  buffer_load_dwordx4 v[144:147], v5, s[44:47], s37 offen offset:0 sc1
  s_waitcnt lgkmcnt(8)
  v_mfma_f32_16x16x32_bf16 v[72:75], v[44:47], v[160:163], v[72:75]
  ds_read_b64_tr_b16 v[40:41], v16 offset:40960
  v_mfma_f32_16x16x32_bf16 v[76:79], v[44:47], v[164:167], v[76:79]
  ds_read_b64_tr_b16 v[42:43], v16 offset:43008
  s_waitcnt lgkmcnt(8)
  v_mfma_f32_16x16x32_bf16 v[80:83], v[48:51], v[160:163], v[80:83]
  ds_read_b64_tr_b16 v[44:45], v17 offset:40960
  v_mfma_f32_16x16x32_bf16 v[84:87], v[48:51], v[164:167], v[84:87]
  ds_read_b64_tr_b16 v[46:47], v17 offset:43008
  s_add_u32 s37, s34, 24576
  buffer_load_dwordx4 v[148:151], v5, s[44:47], s37 offen offset:1024 sc1
  s_waitcnt lgkmcnt(8)
  v_mfma_f32_16x16x32_bf16 v[88:91], v[52:55], v[160:163], v[88:91]
  ds_read_b64_tr_b16 v[48:49], v14 offset:36864
  v_mfma_f32_16x16x32_bf16 v[92:95], v[52:55], v[164:167], v[92:95]
  ds_read_b64_tr_b16 v[50:51], v14 offset:38912
  s_waitcnt lgkmcnt(8)
  v_mfma_f32_16x16x32_bf16 v[96:99], v[32:35], v[160:163], v[96:99]
  ds_read_b64_tr_b16 v[52:53], v15 offset:36864
  v_mfma_f32_16x16x32_bf16 v[100:103], v[32:35], v[164:167], v[100:103]
  ds_read_b64_tr_b16 v[54:55], v15 offset:38912
  s_add_u32 s37, s34, 24576
  buffer_load_dwordx4 v[152:155], v5, s[44:47], s37 offen offset:2048 sc1
  s_waitcnt lgkmcnt(8)
  v_mfma_f32_16x16x32_bf16 v[104:107], v[36:39], v[160:163], v[104:107]
  ds_read_b64_tr_b16 v[32:33], v16 offset:36864
  v_mfma_f32_16x16x32_bf16 v[108:111], v[36:39], v[164:167], v[108:111]
  ds_read_b64_tr_b16 v[34:35], v16 offset:38912
  s_waitcnt lgkmcnt(8)
  v_mfma_f32_16x16x32_bf16 v[112:115], v[40:43], v[160:163], v[112:115]
  ds_read_b64_tr_b16 v[36:37], v17 offset:36864
  v_mfma_f32_16x16x32_bf16 v[116:119], v[40:43], v[164:167], v[116:119]
  ds_read_b64_tr_b16 v[38:39], v17 offset:38912
  s_add_u32 s37, s34, 24576
  buffer_load_dwordx4 v[156:159], v5, s[44:47], s37 offen offset:3072 sc1
  s_waitcnt lgkmcnt(8)
  v_mfma_f32_16x16x32_bf16 v[120:123], v[44:47], v[160:163], v[120:123]
  ds_read_b64_tr_b16 v[40:41], v14 offset:45056
  v_mfma_f32_16x16x32_bf16 v[124:127], v[44:47], v[164:167], v[124:127]
  ds_read_b64_tr_b16 v[42:43], v14 offset:47104
  s_waitcnt vmcnt(16) lgkmcnt(8)
  v_mfma_f32_16x16x32_bf16 v[64:67], v[48:51], v[168:171], v[64:67]
  ds_read_b64_tr_b16 v[44:45], v15 offset:45056
  v_mfma_f32_16x16x32_bf16 v[68:71], v[48:51], v[172:175], v[68:71]
  ds_read_b64_tr_b16 v[46:47], v15 offset:47104
  s_waitcnt lgkmcnt(8)
  v_mfma_f32_16x16x32_bf16 v[72:75], v[52:55], v[168:171], v[72:75]
  ds_read_b64_tr_b16 v[48:49], v16 offset:45056
  v_mfma_f32_16x16x32_bf16 v[76:79], v[52:55], v[172:175], v[76:79]
  ds_read_b64_tr_b16 v[50:51], v16 offset:47104
  s_waitcnt lgkmcnt(8)
  v_mfma_f32_16x16x32_bf16 v[80:83], v[32:35], v[168:171], v[80:83]
  ds_read_b64_tr_b16 v[52:53], v17 offset:45056
  v_mfma_f32_16x16x32_bf16 v[84:87], v[32:35], v[172:175], v[84:87]
  ds_read_b64_tr_b16 v[54:55], v17 offset:47104
  s_waitcnt lgkmcnt(8)
  v_mfma_f32_16x16x32_bf16 v[88:91], v[36:39], v[168:171], v[88:91]
  ds_read_b64_tr_b16 v[32:33], v14 offset:49152
  v_mfma_f32_16x16x32_bf16 v[92:95], v[36:39], v[172:175], v[92:95]
  ds_read_b64_tr_b16 v[34:35], v14 offset:51200
  s_waitcnt lgkmcnt(8)
  v_mfma_f32_16x16x32_bf16 v[96:99], v[40:43], v[168:171], v[96:99]
  ds_read_b64_tr_b16 v[36:37], v15 offset:49152
  v_mfma_f32_16x16x32_bf16 v[100:103], v[40:43], v[172:175], v[100:103]
  ds_read_b64_tr_b16 v[38:39], v15 offset:51200
  s_waitcnt lgkmcnt(8)
  v_mfma_f32_16x16x32_bf16 v[104:107], v[44:47], v[168:171], v[104:107]
  ds_read_b64_tr_b16 v[40:41], v16 offset:49152
  v_mfma_f32_16x16x32_bf16 v[108:111], v[44:47], v[172:175], v[108:111]
  ds_read_b64_tr_b16 v[42:43], v16 offset:51200
  s_waitcnt lgkmcnt(8)
  v_mfma_f32_16x16x32_bf16 v[112:115], v[48:51], v[168:171], v[112:115]
  ds_read_b64_tr_b16 v[44:45], v17 offset:49152
  v_mfma_f32_16x16x32_bf16 v[116:119], v[48:51], v[172:175], v[116:119]
  ds_read_b64_tr_b16 v[46:47], v17 offset:51200
  s_waitcnt lgkmcnt(8)
  v_mfma_f32_16x16x32_bf16 v[120:123], v[52:55], v[168:171], v[120:123]
  ds_read_b64_tr_b16 v[48:49], v14 offset:57344
  v_mfma_f32_16x16x32_bf16 v[124:127], v[52:55], v[172:175], v[124:127]
  ds_read_b64_tr_b16 v[50:51], v14 offset:59392
  s_waitcnt vmcnt(14) lgkmcnt(8)
  v_mfma_f32_16x16x32_bf16 v[64:67], v[32:35], v[176:179], v[64:67]
  ds_read_b64_tr_b16 v[52:53], v15 offset:57344
  v_mfma_f32_16x16x32_bf16 v[68:71], v[32:35], v[180:183], v[68:71]
  ds_read_b64_tr_b16 v[54:55], v15 offset:59392
  s_add_u32 s37, s34, 28672
  buffer_load_dwordx4 v[160:163], v5, s[44:47], s37 offen offset:0 sc1
  s_waitcnt lgkmcnt(8)
  v_mfma_f32_16x16x32_bf16 v[72:75], v[36:39], v[176:179], v[72:75]
  ds_read_b64_tr_b16 v[32:33], v16 offset:57344
  v_mfma_f32_16x16x32_bf16 v[76:79], v[36:39], v[180:183], v[76:79]
  ds_read_b64_tr_b16 v[34:35], v16 offset:59392
  s_waitcnt lgkmcnt(8)
  v_mfma_f32_16x16x32_bf16 v[80:83], v[40:43], v[176:179], v[80:83]
  ds_read_b64_tr_b16 v[36:37], v17 offset:57344
  v_mfma_f32_16x16x32_bf16 v[84:87], v[40:43], v[180:183], v[84:87]
  ds_read_b64_tr_b16 v[38:39], v17 offset:59392
  s_add_u32 s37, s34, 28672
  buffer_load_dwordx4 v[164:167], v5, s[44:47], s37 offen offset:1024 sc1
  s_waitcnt lgkmcnt(8)
  v_mfma_f32_16x16x32_bf16 v[88:91], v[44:47], v[176:179], v[88:91]
  ds_read_b64_tr_b16 v[40:41], v14 offset:53248
  v_mfma_f32_16x16x32_bf16 v[92:95], v[44:47], v[180:183], v[92:95]
  ds_read_b64_tr_b16 v[42:43], v14 offset:55296
  s_waitcnt lgkmcnt(8)
  v_mfma_f32_16x16x32_bf16 v[96:99], v[48:51], v[176:179], v[96:99]
  ds_read_b64_tr_b16 v[44:45], v15 offset:53248
  v_mfma_f32_16x16x32_bf16 v[100:103], v[48:51], v[180:183], v[100:103]
  ds_read_b64_tr_b16 v[46:47], v15 offset:55296
  s_add_u32 s37, s34, 28672
  buffer_load_dwordx4 v[168:171], v5, s[44:47], s37 offen offset:2048 sc1
  s_waitcnt lgkmcnt(8)
  v_mfma_f32_16x16x32_bf16 v[104:107], v[52:55], v[176:179], v[104:107]
  ds_read_b64_tr_b16 v[48:49], v16 offset:53248
  v_mfma_f32_16x16x32_bf16 v[108:111], v[52:55], v[180:183], v[108:111]
  ds_read_b64_tr_b16 v[50:51], v16 offset:55296
  s_waitcnt lgkmcnt(8)
  v_mfma_f32_16x16x32_bf16 v[112:115], v[32:35], v[176:179], v[112:115]
  ds_read_b64_tr_b16 v[52:53], v17 offset:53248
  v_mfma_f32_16x16x32_bf16 v[116:119], v[32:35], v[180:183], v[116:119]
  ds_read_b64_tr_b16 v[54:55], v17 offset:55296
  s_add_u32 s37, s34, 28672
  buffer_load_dwordx4 v[172:175], v5, s[44:47], s37 offen offset:3072 sc1
  s_waitcnt lgkmcnt(8)
  v_mfma_f32_16x16x32_bf16 v[120:123], v[36:39], v[176:179], v[120:123]
  ds_read_b64_tr_b16 v[32:33], v14 offset:61440
  v_mfma_f32_16x16x32_bf16 v[124:127], v[36:39], v[180:183], v[124:127]
  ds_read_b64_tr_b16 v[34:35], v14 offset:63488
  s_waitcnt vmcnt(16) lgkmcnt(8)
  v_mfma_f32_16x16x32_bf16 v[64:67], v[40:43], v[184:187], v[64:67]
  ds_read_b64_tr_b16 v[36:37], v15 offset:61440
  v_mfma_f32_16x16x32_bf16 v[68:71], v[40:43], v[188:191], v[68:71]
  ds_read_b64_tr_b16 v[38:39], v15 offset:63488
  v_lshrrev_b32 v27, 2, v0
  v_lshlrev_b32 v27, 7, v27
  s_waitcnt lgkmcnt(8)
  v_mfma_f32_16x16x32_bf16 v[72:75], v[44:47], v[184:187], v[72:75]
  ds_read_b64_tr_b16 v[40:41], v16 offset:61440
  v_mfma_f32_16x16x32_bf16 v[76:79], v[44:47], v[188:191], v[76:79]
  ds_read_b64_tr_b16 v[42:43], v16 offset:63488
  v_bfe_u32 v26, v0, 3, 2
  v_lshl_add_u32 v27, v26, 5, v27
  s_waitcnt lgkmcnt(8)
  v_mfma_f32_16x16x32_bf16 v[80:83], v[48:51], v[184:187], v[80:83]
  ds_read_b64_tr_b16 v[44:45], v17 offset:61440
  v_mfma_f32_16x16x32_bf16 v[84:87], v[48:51], v[188:191], v[84:87]
  ds_read_b64_tr_b16 v[46:47], v17 offset:63488
  v_and_b32 v26, 3, v0
  v_lshl_add_u32 v22, v26, 3, v27
  s_add_u32 m0, s18, 131072
  s_add_u32 s19, s17, 0
  buffer_load_dwordx4 v13, s[48:51], s19 offen offset:0 lds
  s_waitcnt lgkmcnt(8)
  v_mfma_f32_16x16x32_bf16 v[88:91], v[52:55], v[184:187], v[88:91]
  v_xor_b32 v14, 0x10000, v14
  v_xor_b32 v15, 0x10000, v15
  v_xor_b32 v16, 0x10000, v16
  v_xor_b32 v17, 0x10000, v17
  ds_read_b64_tr_b16 v[48:49], v14 offset:0
  v_mfma_f32_16x16x32_bf16 v[92:95], v[52:55], v[188:191], v[92:95]
  ds_read_b64_tr_b16 v[50:51], v14 offset:2048
  v_xor_b32 v23, 32, v22
  v_xor_b32 v24, 64, v22
  s_waitcnt lgkmcnt(8)
  v_mfma_f32_16x16x32_bf16 v[96:99], v[32:35], v[184:187], v[96:99]
  ds_read_b64_tr_b16 v[52:53], v14 offset:8192
  v_mfma_f32_16x16x32_bf16 v[100:103], v[32:35], v[188:191], v[100:103]
  ds_read_b64_tr_b16 v[54:55], v14 offset:10240
  v_xor_b32 v25, 96, v22
  v_add_u32 v22, s18, v22
  s_add_u32 m0, s18, 131072
  s_add_u32 s19, s17, 7168
  buffer_load_dwordx4 v13, s[48:51], s19 offen offset:1024 lds
  s_waitcnt lgkmcnt(8)
  v_mfma_f32_16x16x32_bf16 v[104:107], v[36:39], v[184:187], v[104:107]
  ds_read_b64_tr_b16 v[32:33], v14 offset:4096
  v_mfma_f32_16x16x32_bf16 v[108:111], v[36:39], v[188:191], v[108:111]
  ds_read_b64_tr_b16 v[34:35], v14 offset:6144
  v_add_u32 v6, 0x20000, v22
  v_add_u32 v23, s18, v23
  s_waitcnt lgkmcnt(8)
  v_mfma_f32_16x16x32_bf16 v[112:115], v[40:43], v[184:187], v[112:115]
  ds_read_b64_tr_b16 v[36:37], v14 offset:12288
  v_mfma_f32_16x16x32_bf16 v[116:119], v[40:43], v[188:191], v[116:119]
  ds_read_b64_tr_b16 v[38:39], v14 offset:14336
  v_add_u32 v7, 0x20000, v23
  v_add_u32 v24, s18, v24
  s_add_u32 m0, s18, 131072
  s_add_u32 s19, s17, 14336
  buffer_load_dwordx4 v13, s[48:51], s19 offen offset:2048 lds
  s_waitcnt lgkmcnt(8)
  v_mfma_f32_16x16x32_bf16 v[120:123], v[44:47], v[184:187], v[120:123]
  ds_read_b64_tr_b16 v[40:41], v14 offset:16384
  v_mfma_f32_16x16x32_bf16 v[124:127], v[44:47], v[188:191], v[124:127]
  ds_read_b64_tr_b16 v[42:43], v14 offset:18432
  v_add_u32 v8, 0x20000, v24
  v_add_u32 v25, s18, v25
  s_waitcnt vmcnt(17) lgkmcnt(8)
  v_mfma_f32_16x16x32_bf16 v[64:67], v[48:51], v[192:195], v[64:67]
  ds_read_b64_tr_b16 v[44:45], v14 offset:24576
  v_mfma_f32_16x16x32_bf16 v[68:71], v[48:51], v[196:199], v[68:71]
  ds_read_b64_tr_b16 v[46:47], v14 offset:26624
  s_barrier
  v_add_u32 v9, 0x20000, v25
  v_add_u32 v10, s18, v5
  s_add_u32 m0, s18, 131072
  s_add_u32 s19, s17, 21504
  buffer_load_dwordx4 v13, s[48:51], s19 offen offset:3072 lds
  s_waitcnt lgkmcnt(8)
  v_mfma_f32_16x16x32_bf16 v[96:99], v[52:55], v[192:195], v[96:99]
  ds_read_b64_tr_b16 v[48:49], v14 offset:20480
  v_mfma_f32_16x16x32_bf16 v[100:103], v[52:55], v[196:199], v[100:103]
  ds_read_b64_tr_b16 v[50:51], v14 offset:22528
  v_add_u32 v11, 0x10000, v10
  v_add_u32 v30, 0x20000, v10
  s_waitcnt vmcnt(16) lgkmcnt(8)
  v_mfma_f32_16x16x32_bf16 v[64:67], v[32:35], v[200:203], v[64:67]
  ds_read_b64_tr_b16 v[52:53], v14 offset:28672
  v_mfma_f32_16x16x32_bf16 v[68:71], v[32:35], v[204:207], v[68:71]
  ds_read_b64_tr_b16 v[54:55], v14 offset:30720
  s_and_b32 s33, s12, 1
  s_lshl_b32 s32, s16, 1
  s_add_u32 m0, s18, 0
  s_add_u32 s19, s17, 32768
  buffer_load_dwordx4 v13, s[48:51], s19 offen offset:0 lds
  s_waitcnt lgkmcnt(8)
  v_mfma_f32_16x16x32_bf16 v[96:99], v[36:39], v[200:203], v[96:99]
  ds_read_b64_tr_b16 v[32:33], v14 offset:32768
  v_mfma_f32_16x16x32_bf16 v[100:103], v[36:39], v[204:207], v[100:103]
  ds_read_b64_tr_b16 v[34:35], v14 offset:34816
  s_add_u32 s32, s32, s33
  s_lshr_b32 s33, s12, 1
  s_waitcnt vmcnt(15) lgkmcnt(8)
  v_mfma_f32_16x16x32_bf16 v[64:67], v[40:43], v[128:131], v[64:67]
  ds_read_b64_tr_b16 v[36:37], v14 offset:40960
  v_mfma_f32_16x16x32_bf16 v[68:71], v[40:43], v[132:135], v[68:71]
  ds_read_b64_tr_b16 v[38:39], v14 offset:43008
  s_lshl_b32 s36, s15, 2
  s_add_u32 s36, s36, s33
  s_add_u32 m0, s18, 0
  s_add_u32 s19, s17, 39936
  buffer_load_dwordx4 v13, s[48:51], s19 offen offset:1024 lds
  s_waitcnt lgkmcnt(8)
  v_mfma_f32_16x16x32_bf16 v[96:99], v[44:47], v[128:131], v[96:99]
  ds_read_b64_tr_b16 v[40:41], v14 offset:36864
  v_mfma_f32_16x16x32_bf16 v[100:103], v[44:47], v[132:135], v[100:103]
  ds_read_b64_tr_b16 v[42:43], v14 offset:38912
  s_lshr_b32 s35, s36, 1
  s_lshl_b32 s35, s35, 4
  s_waitcnt vmcnt(14) lgkmcnt(8)
  v_mfma_f32_16x16x32_bf16 v[64:67], v[48:51], v[136:139], v[64:67]
  ds_read_b64_tr_b16 v[44:45], v14 offset:45056
  v_mfma_f32_16x16x32_bf16 v[68:71], v[48:51], v[140:143], v[68:71]
  ds_read_b64_tr_b16 v[46:47], v14 offset:47104
  s_add_u32 s35, s35, s32
  s_lshl_b32 s35, s35, 1
  s_add_u32 m0, s18, 0
  s_add_u32 s19, s17, 47104
  buffer_load_dwordx4 v13, s[48:51], s19 offen offset:2048 lds
  s_waitcnt lgkmcnt(8)
  v_mfma_f32_16x16x32_bf16 v[96:99], v[52:55], v[136:139], v[96:99]
  ds_read_b64_tr_b16 v[48:49], v14 offset:49152
  v_mfma_f32_16x16x32_bf16 v[100:103], v[52:55], v[140:143], v[100:103]
  ds_read_b64_tr_b16 v[50:51], v14 offset:51200
  s_and_b32 s33, s36, 1
  s_add_u32 s35, s35, s33
  s_waitcnt vmcnt(13) lgkmcnt(8)
  v_mfma_f32_16x16x32_bf16 v[64:67], v[32:35], v[144:147], v[64:67]
  ds_read_b64_tr_b16 v[52:53], v14 offset:57344
  v_mfma_f32_16x16x32_bf16 v[68:71], v[32:35], v[148:151], v[68:71]
  ds_read_b64_tr_b16 v[54:55], v14 offset:59392
  s_lshl_b32 s35, s35, 10
  s_lshl_b32 s60, s36, 14
  s_add_u32 m0, s18, 0
  s_add_u32 s19, s17, 54272
  buffer_load_dwordx4 v13, s[48:51], s19 offen offset:3072 lds
  s_waitcnt lgkmcnt(8)
  v_mfma_f32_16x16x32_bf16 v[96:99], v[36:39], v[144:147], v[96:99]
  ds_read_b64_tr_b16 v[32:33], v14 offset:53248
  v_mfma_f32_16x16x32_bf16 v[100:103], v[36:39], v[148:151], v[100:103]
  ds_read_b64_tr_b16 v[34:35], v14 offset:55296
  s_lshl_b32 s33, s32, 6
  s_add_u32 s60, s60, s33
  s_waitcnt vmcnt(12) lgkmcnt(8)
  v_mfma_f32_16x16x32_bf16 v[64:67], v[40:43], v[152:155], v[64:67]
  ds_read_b64_tr_b16 v[36:37], v14 offset:61440
  v_mfma_f32_16x16x32_bf16 v[68:71], v[40:43], v[156:159], v[68:71]
  ds_read_b64_tr_b16 v[38:39], v14 offset:63488
  v_and_b32 v1, 15, v0
  v_lshlrev_b32 v1, 10, v1
  s_add_u32 s19, s17, 163840
  buffer_load_dwordx4 v[208:211], v13, s[48:51], s19 offen offset:0
  s_waitcnt lgkmcnt(8)
  v_mfma_f32_16x16x32_bf16 v[96:99], v[44:47], v[152:155], v[96:99]
  ds_read_b64_tr_b16 v[40:41], v15 offset:0
  v_mfma_f32_16x16x32_bf16 v[100:103], v[44:47], v[156:159], v[100:103]
  ds_read_b64_tr_b16 v[42:43], v15 offset:2048
  v_bfe_u32 v26, v0, 4, 1
  v_lshl_add_u32 v1, v26, 5, v1
  s_waitcnt vmcnt(11) lgkmcnt(8)
  v_mfma_f32_16x16x32_bf16 v[64:67], v[48:51], v[160:163], v[64:67]
  ds_read_b64_tr_b16 v[44:45], v15 offset:8192
  v_mfma_f32_16x16x32_bf16 v[68:71], v[48:51], v[164:167], v[68:71]
  ds_read_b64_tr_b16 v[46:47], v15 offset:10240
  v_lshrrev_b32 v26, 5, v0
  v_lshl_add_u32 v1, v26, 4, v1
  s_add_u32 s19, s17, 171008
  buffer_load_dwordx4 v[212:215], v13, s[48:51], s19 offen offset:1024
  s_waitcnt lgkmcnt(8)
  v_mfma_f32_16x16x32_bf16 v[96:99], v[52:55], v[160:163], v[96:99]
  ds_read_b64_tr_b16 v[48:49], v15 offset:4096
  v_mfma_f32_16x16x32_bf16 v[100:103], v[52:55], v[164:167], v[100:103]
  ds_read_b64_tr_b16 v[50:51], v15 offset:6144
  v_lshrrev_b32 v2, 4, v0
  v_lshlrev_b32 v2, 4, v2
  s_waitcnt vmcnt(10) lgkmcnt(8)
  v_mfma_f32_16x16x32_bf16 v[64:67], v[32:35], v[168:171], v[64:67]
  ds_read_b64_tr_b16 v[52:53], v15 offset:12288
  v_mfma_f32_16x16x32_bf16 v[68:71], v[32:35], v[172:175], v[68:71]
  ds_read_b64_tr_b16 v[54:55], v15 offset:14336
  s_lshl_b32 s61, s32, 7
  s_add_u32 s61, s61, 10240
  s_add_u32 s19, s17, 178176
  buffer_load_dwordx4 v[216:219], v13, s[48:51], s19 offen offset:2048
  s_waitcnt lgkmcnt(8)
  v_mfma_f32_16x16x32_bf16 v[96:99], v[36:39], v[168:171], v[96:99]
  ds_read_b64_tr_b16 v[32:33], v15 offset:16384
  v_mfma_f32_16x16x32_bf16 v[100:103], v[36:39], v[172:175], v[100:103]
  ds_read_b64_tr_b16 v[34:35], v15 offset:18432
  s_mov_b32 s20, s92
  s_mov_b32 s21, s93
  s_waitcnt lgkmcnt(8)
  v_mfma_f32_16x16x32_bf16 v[72:75], v[40:43], v[192:195], v[72:75]
  ds_read_b64_tr_b16 v[36:37], v15 offset:24576
  v_mfma_f32_16x16x32_bf16 v[76:79], v[40:43], v[196:199], v[76:79]
  ds_read_b64_tr_b16 v[38:39], v15 offset:26624
  s_mov_b32 s22, 0x200000
  s_mov_b32 s23, 0x20000
  s_add_u32 s19, s17, 185344
  buffer_load_dwordx4 v[220:223], v13, s[48:51], s19 offen offset:3072
  s_waitcnt lgkmcnt(8)
  v_mfma_f32_16x16x32_bf16 v[104:107], v[44:47], v[192:195], v[104:107]
  ds_read_b64_tr_b16 v[40:41], v15 offset:20480
  v_mfma_f32_16x16x32_bf16 v[108:111], v[44:47], v[196:199], v[108:111]
  ds_read_b64_tr_b16 v[42:43], v15 offset:22528
  v_mul_f32 v96, v64, v96
  v_mul_f32 v64, v18, v64
  s_waitcnt lgkmcnt(8)
  v_mfma_f32_16x16x32_bf16 v[72:75], v[48:51], v[200:203], v[72:75]
  ds_read_b64_tr_b16 v[44:45], v15 offset:28672
  v_exp_f32 v64, v64
  v_mfma_f32_16x16x32_bf16 v[76:79], v[48:51], v[204:207], v[76:79]
  ds_read_b64_tr_b16 v[46:47], v15 offset:30720
  s_add_u32 s19, s17, 196608
  buffer_load_dwordx4 v[224:227], v13, s[48:51], s19 offen offset:0
  v_mul_f32 v97, v65, v97
  v_mul_f32 v65, v18, v65
  s_waitcnt lgkmcnt(8)
  v_mfma_f32_16x16x32_bf16 v[104:107], v[52:55], v[200:203], v[104:107]
  ds_read_b64_tr_b16 v[48:49], v15 offset:32768
  v_exp_f32 v65, v65
  v_mfma_f32_16x16x32_bf16 v[108:111], v[52:55], v[204:207], v[108:111]
  ds_read_b64_tr_b16 v[50:51], v15 offset:34816
  v_add_f32 v64, 1.0, v64
  v_mul_f32 v98, v66, v98
  v_mul_f32 v66, v18, v66
  s_waitcnt lgkmcnt(8)
  v_mfma_f32_16x16x32_bf16 v[72:75], v[32:35], v[128:131], v[72:75]
  ds_read_b64_tr_b16 v[52:53], v15 offset:40960
  v_exp_f32 v66, v66
  v_mfma_f32_16x16x32_bf16 v[76:79], v[32:35], v[132:135], v[76:79]
  ds_read_b64_tr_b16 v[54:55], v15 offset:43008
  s_add_u32 s19, s17, 203776
  buffer_load_dwordx4 v[228:231], v13, s[48:51], s19 offen offset:1024
  v_add_f32 v65, 1.0, v65
  v_mul_f32 v99, v67, v99
  v_mul_f32 v67, v18, v67
  s_waitcnt lgkmcnt(8)
  v_mfma_f32_16x16x32_bf16 v[104:107], v[36:39], v[128:131], v[104:107]
  ds_read_b64_tr_b16 v[32:33], v15 offset:36864
  v_exp_f32 v67, v67
  v_mfma_f32_16x16x32_bf16 v[108:111], v[36:39], v[132:135], v[108:111]
  ds_read_b64_tr_b16 v[34:35], v15 offset:38912
  v_add_f32 v66, 1.0, v66
  v_mul_f32 v100, v68, v100
  v_mul_f32 v68, v18, v68
  s_waitcnt lgkmcnt(8)
  v_mfma_f32_16x16x32_bf16 v[72:75], v[40:43], v[136:139], v[72:75]
  ds_read_b64_tr_b16 v[36:37], v15 offset:45056
  v_exp_f32 v68, v68
  v_mfma_f32_16x16x32_bf16 v[76:79], v[40:43], v[140:143], v[76:79]
  ds_read_b64_tr_b16 v[38:39], v15 offset:47104
  s_add_u32 s19, s17, 210944
  buffer_load_dwordx4 v[232:235], v13, s[48:51], s19 offen offset:2048
  v_add_f32 v67, 1.0, v67
  v_mul_f32 v101, v69, v101
  v_mul_f32 v69, v18, v69
  s_waitcnt lgkmcnt(8)
  v_mfma_f32_16x16x32_bf16 v[104:107], v[44:47], v[136:139], v[104:107]
  ds_read_b64_tr_b16 v[40:41], v15 offset:49152
  v_exp_f32 v69, v69
  v_mfma_f32_16x16x32_bf16 v[108:111], v[44:47], v[140:143], v[108:111]
  ds_read_b64_tr_b16 v[42:43], v15 offset:51200
  v_add_f32 v68, 1.0, v68
  v_mul_f32 v102, v70, v102
  v_mul_f32 v70, v18, v70
  s_waitcnt lgkmcnt(8)
  v_mfma_f32_16x16x32_bf16 v[72:75], v[48:51], v[144:147], v[72:75]
  ds_read_b64_tr_b16 v[44:45], v15 offset:57344
  v_exp_f32 v70, v70
  v_mfma_f32_16x16x32_bf16 v[76:79], v[48:51], v[148:151], v[76:79]
  ds_read_b64_tr_b16 v[46:47], v15 offset:59392
  s_add_u32 s19, s17, 218112
  buffer_load_dwordx4 v[236:239], v13, s[48:51], s19 offen offset:3072
  v_add_f32 v69, 1.0, v69
  v_mul_f32 v103, v71, v103
  v_mul_f32 v71, v18, v71
  s_waitcnt lgkmcnt(8)
  v_mfma_f32_16x16x32_bf16 v[104:107], v[52:55], v[144:147], v[104:107]
  ds_read_b64_tr_b16 v[48:49], v15 offset:53248
  v_exp_f32 v71, v71
  v_mfma_f32_16x16x32_bf16 v[108:111], v[52:55], v[148:151], v[108:111]
  ds_read_b64_tr_b16 v[50:51], v15 offset:55296
  v_add_f32 v70, 1.0, v70
  s_waitcnt lgkmcnt(8)
  v_mfma_f32_16x16x32_bf16 v[72:75], v[32:35], v[152:155], v[72:75]
  ds_read_b64_tr_b16 v[52:53], v15 offset:61440
  v_rcp_f32 v64, v64
  v_mfma_f32_16x16x32_bf16 v[76:79], v[32:35], v[156:159], v[76:79]
  ds_read_b64_tr_b16 v[54:55], v15 offset:63488
  s_add_u32 s19, s17, 98304
  buffer_load_dwordx4 v[240:243], v13, s[48:51], s19 offen offset:0
  v_mul_f32 v96, v96, v64
  v_add_f32 v71, 1.0, v71
  s_waitcnt lgkmcnt(8)
  v_mfma_f32_16x16x32_bf16 v[104:107], v[36:39], v[152:155], v[104:107]
  ds_read_b64_tr_b16 v[32:33], v16 offset:0
  v_rcp_f32 v65, v65
  v_mfma_f32_16x16x32_bf16 v[108:111], v[36:39], v[156:159], v[108:111]
  ds_read_b64_tr_b16 v[34:35], v16 offset:2048
  v_mul_f32 v97, v97, v65
  s_waitcnt lgkmcnt(8)
  v_mfma_f32_16x16x32_bf16 v[72:75], v[40:43], v[160:163], v[72:75]
  ds_read_b64_tr_b16 v[36:37], v16 offset:8192
  v_rcp_f32 v66, v66
  v_mfma_f32_16x16x32_bf16 v[76:79], v[40:43], v[164:167], v[76:79]
  ds_read_b64_tr_b16 v[38:39], v16 offset:10240
  s_add_u32 s19, s17, 105472
  buffer_load_dwordx4 v[244:247], v13, s[48:51], s19 offen offset:1024
  v_mul_f32 v98, v98, v66
  v_cvt_pk_bf16_f32 v64, v96, v97
  s_waitcnt lgkmcnt(8)
  v_mfma_f32_16x16x32_bf16 v[104:107], v[44:47], v[160:163], v[104:107]
  ds_read_b64_tr_b16 v[40:41], v16 offset:4096
  v_rcp_f32 v67, v67
  v_mfma_f32_16x16x32_bf16 v[108:111], v[44:47], v[164:167], v[108:111]
  ds_read_b64_tr_b16 v[42:43], v16 offset:6144
  v_mul_f32 v99, v99, v67
  s_waitcnt lgkmcnt(8)
  v_mfma_f32_16x16x32_bf16 v[72:75], v[48:51], v[168:171], v[72:75]
  ds_read_b64_tr_b16 v[44:45], v16 offset:12288
  v_rcp_f32 v68, v68
  v_mfma_f32_16x16x32_bf16 v[76:79], v[48:51], v[172:175], v[76:79]
  ds_read_b64_tr_b16 v[46:47], v16 offset:14336
  s_add_u32 s19, s17, 112640
  buffer_load_dwordx4 v[248:251], v13, s[48:51], s19 offen offset:2048
  v_mul_f32 v100, v100, v68
  v_cvt_pk_bf16_f32 v65, v98, v99
  s_waitcnt lgkmcnt(8)
  v_mfma_f32_16x16x32_bf16 v[104:107], v[52:55], v[168:171], v[104:107]
  ds_read_b64_tr_b16 v[48:49], v16 offset:16384
  v_rcp_f32 v69, v69
  v_mfma_f32_16x16x32_bf16 v[108:111], v[52:55], v[172:175], v[108:111]
  ds_read_b64_tr_b16 v[50:51], v16 offset:18432
  v_mul_f32 v101, v101, v69
  s_waitcnt lgkmcnt(8)
  v_mfma_f32_16x16x32_bf16 v[80:83], v[32:35], v[192:195], v[80:83]
  ds_read_b64_tr_b16 v[52:53], v16 offset:24576
  v_rcp_f32 v70, v70
  v_mfma_f32_16x16x32_bf16 v[84:87], v[32:35], v[196:199], v[84:87]
  ds_read_b64_tr_b16 v[54:55], v16 offset:26624
  s_add_u32 s19, s17, 119808
  buffer_load_dwordx4 v[252:255], v13, s[48:51], s19 offen offset:3072
  v_mul_f32 v102, v102, v70
  v_cvt_pk_bf16_f32 v68, v100, v101
  s_waitcnt lgkmcnt(8)
  v_mfma_f32_16x16x32_bf16 v[112:115], v[36:39], v[192:195], v[112:115]
  ds_read_b64_tr_b16 v[32:33], v16 offset:20480
  v_rcp_f32 v71, v71
  v_mfma_f32_16x16x32_bf16 v[116:119], v[36:39], v[196:199], v[116:119]
  ds_read_b64_tr_b16 v[34:35], v16 offset:22528
  v_mul_f32 v103, v103, v71
  v_mul_f32 v104, v72, v104
  v_mul_f32 v72, v18, v72
  s_waitcnt lgkmcnt(8)
  v_mfma_f32_16x16x32_bf16 v[80:83], v[40:43], v[200:203], v[80:83]
  ds_read_b64_tr_b16 v[36:37], v16 offset:28672
  v_exp_f32 v72, v72
  v_mfma_f32_16x16x32_bf16 v[84:87], v[40:43], v[204:207], v[84:87]
  ds_read_b64_tr_b16 v[38:39], v16 offset:30720
  s_add_u32 s19, s17, 131072
  buffer_load_dwordx4 v[176:179], v13, s[48:51], s19 offen offset:0
  v_cvt_pk_bf16_f32 v69, v102, v103
  v_mul_f32 v105, v73, v105
  v_mul_f32 v73, v18, v73
  s_waitcnt lgkmcnt(8)
  v_mfma_f32_16x16x32_bf16 v[112:115], v[44:47], v[200:203], v[112:115]
  ds_read_b64_tr_b16 v[40:41], v16 offset:32768
  v_exp_f32 v73, v73
  v_mfma_f32_16x16x32_bf16 v[116:119], v[44:47], v[204:207], v[116:119]
  ds_read_b64_tr_b16 v[42:43], v16 offset:34816
  v_add_f32 v72, 1.0, v72
  v_mul_f32 v106, v74, v106
  v_mul_f32 v74, v18, v74
  s_waitcnt lgkmcnt(8)
  v_mfma_f32_16x16x32_bf16 v[80:83], v[48:51], v[128:131], v[80:83]
  ds_read_b64_tr_b16 v[44:45], v16 offset:40960
  v_exp_f32 v74, v74
  v_mfma_f32_16x16x32_bf16 v[84:87], v[48:51], v[132:135], v[84:87]
  ds_read_b64_tr_b16 v[46:47], v16 offset:43008
  s_add_u32 s19, s17, 138240
  buffer_load_dwordx4 v[180:183], v13, s[48:51], s19 offen offset:1024
  v_add_f32 v73, 1.0, v73
  v_mul_f32 v107, v75, v107
  v_mul_f32 v75, v18, v75
  s_waitcnt lgkmcnt(8)
  v_mfma_f32_16x16x32_bf16 v[112:115], v[52:55], v[128:131], v[112:115]
  ds_read_b64_tr_b16 v[48:49], v16 offset:36864
  v_exp_f32 v75, v75
  v_mfma_f32_16x16x32_bf16 v[116:119], v[52:55], v[132:135], v[116:119]
  ds_read_b64_tr_b16 v[50:51], v16 offset:38912
  v_add_f32 v74, 1.0, v74
  v_mul_f32 v108, v76, v108
  v_mul_f32 v76, v18, v76
  s_waitcnt lgkmcnt(8)
  v_mfma_f32_16x16x32_bf16 v[80:83], v[32:35], v[136:139], v[80:83]
  ds_read_b64_tr_b16 v[52:53], v16 offset:45056
  v_exp_f32 v76, v76
  v_mfma_f32_16x16x32_bf16 v[84:87], v[32:35], v[140:143], v[84:87]
  ds_read_b64_tr_b16 v[54:55], v16 offset:47104
  s_add_u32 s19, s17, 145408
  buffer_load_dwordx4 v[184:187], v13, s[48:51], s19 offen offset:2048
  v_add_f32 v75, 1.0, v75
  v_mul_f32 v109, v77, v109
  v_mul_f32 v77, v18, v77
  s_waitcnt lgkmcnt(8)
  v_mfma_f32_16x16x32_bf16 v[112:115], v[36:39], v[136:139], v[112:115]
  ds_read_b64_tr_b16 v[32:33], v16 offset:49152
  v_exp_f32 v77, v77
  v_mfma_f32_16x16x32_bf16 v[116:119], v[36:39], v[140:143], v[116:119]
  ds_read_b64_tr_b16 v[34:35], v16 offset:51200
  v_add_f32 v76, 1.0, v76
  v_mul_f32 v110, v78, v110
  v_mul_f32 v78, v18, v78
  s_waitcnt lgkmcnt(8)
  v_mfma_f32_16x16x32_bf16 v[80:83], v[40:43], v[144:147], v[80:83]
  ds_read_b64_tr_b16 v[36:37], v16 offset:57344
  v_exp_f32 v78, v78
  v_mfma_f32_16x16x32_bf16 v[84:87], v[40:43], v[148:151], v[84:87]
  ds_read_b64_tr_b16 v[38:39], v16 offset:59392
  s_add_u32 s19, s17, 152576
  buffer_load_dwordx4 v[188:191], v13, s[48:51], s19 offen offset:3072
  v_add_f32 v77, 1.0, v77
  v_mul_f32 v111, v79, v111
  v_mul_f32 v79, v18, v79
  s_waitcnt lgkmcnt(8)
  v_mfma_f32_16x16x32_bf16 v[112:115], v[44:47], v[144:147], v[112:115]
  ds_read_b64_tr_b16 v[40:41], v16 offset:53248
  v_exp_f32 v79, v79
  v_mfma_f32_16x16x32_bf16 v[116:119], v[44:47], v[148:151], v[116:119]
  ds_read_b64_tr_b16 v[42:43], v16 offset:55296
  v_add_f32 v78, 1.0, v78
  s_waitcnt lgkmcnt(8)
  v_mfma_f32_16x16x32_bf16 v[80:83], v[48:51], v[152:155], v[80:83]
  ds_read_b64_tr_b16 v[44:45], v16 offset:61440
  v_rcp_f32 v72, v72
  v_mfma_f32_16x16x32_bf16 v[84:87], v[48:51], v[156:159], v[84:87]
  ds_read_b64_tr_b16 v[46:47], v16 offset:63488
  s_add_u32 m0, s18, 32768
  s_add_u32 s19, s17, 65536
  buffer_load_dwordx4 v13, s[48:51], s19 offen offset:0 lds
  v_mul_f32 v104, v104, v72
  v_add_f32 v79, 1.0, v79
  s_waitcnt lgkmcnt(8)
  v_mfma_f32_16x16x32_bf16 v[112:115], v[52:55], v[152:155], v[112:115]
  ds_read_b64_tr_b16 v[48:49], v17 offset:0
  v_rcp_f32 v73, v73
  v_mfma_f32_16x16x32_bf16 v[116:119], v[52:55], v[156:159], v[116:119]
  ds_read_b64_tr_b16 v[50:51], v17 offset:2048
  v_mul_f32 v105, v105, v73
  s_waitcnt lgkmcnt(8)
  v_mfma_f32_16x16x32_bf16 v[80:83], v[32:35], v[160:163], v[80:83]
  ds_read_b64_tr_b16 v[52:53], v17 offset:8192
  v_rcp_f32 v74, v74
  v_mfma_f32_16x16x32_bf16 v[84:87], v[32:35], v[164:167], v[84:87]
  ds_read_b64_tr_b16 v[54:55], v17 offset:10240
  s_add_u32 m0, s18, 32768
  s_add_u32 s19, s17, 72704
  buffer_load_dwordx4 v13, s[48:51], s19 offen offset:1024 lds
  v_mul_f32 v106, v106, v74
  v_cvt_pk_bf16_f32 v66, v104, v105
  s_waitcnt lgkmcnt(8)
  v_mfma_f32_16x16x32_bf16 v[112:115], v[36:39], v[160:163], v[112:115]
  ds_read_b64_tr_b16 v[32:33], v17 offset:4096
  v_rcp_f32 v75, v75
  v_mfma_f32_16x16x32_bf16 v[116:119], v[36:39], v[164:167], v[116:119]
  ds_read_b64_tr_b16 v[34:35], v17 offset:6144
  v_mul_f32 v107, v107, v75
  s_waitcnt lgkmcnt(8)
  v_mfma_f32_16x16x32_bf16 v[80:83], v[40:43], v[168:171], v[80:83]
  ds_read_b64_tr_b16 v[36:37], v17 offset:12288
  v_rcp_f32 v76, v76
  v_mfma_f32_16x16x32_bf16 v[84:87], v[40:43], v[172:175], v[84:87]
  ds_read_b64_tr_b16 v[38:39], v17 offset:14336
  s_add_u32 m0, s18, 32768
  s_add_u32 s19, s17, 79872
  buffer_load_dwordx4 v13, s[48:51], s19 offen offset:2048 lds
  v_mul_f32 v108, v108, v76
  v_cvt_pk_bf16_f32 v67, v106, v107
  s_waitcnt lgkmcnt(8)
  v_mfma_f32_16x16x32_bf16 v[112:115], v[44:47], v[168:171], v[112:115]
  ds_read_b64_tr_b16 v[40:41], v17 offset:16384
  v_rcp_f32 v77, v77
  v_mfma_f32_16x16x32_bf16 v[116:119], v[44:47], v[172:175], v[116:119]
  ds_read_b64_tr_b16 v[42:43], v17 offset:18432
  v_mul_f32 v109, v109, v77
  s_waitcnt lgkmcnt(8)
  v_mfma_f32_16x16x32_bf16 v[88:91], v[48:51], v[192:195], v[88:91]
  ds_read_b64_tr_b16 v[44:45], v17 offset:24576
  v_rcp_f32 v78, v78
  v_mfma_f32_16x16x32_bf16 v[92:95], v[48:51], v[196:199], v[92:95]
  ds_read_b64_tr_b16 v[46:47], v17 offset:26624
  s_add_u32 m0, s18, 32768
  s_add_u32 s19, s17, 87040
  buffer_load_dwordx4 v13, s[48:51], s19 offen offset:3072 lds
  v_mul_f32 v110, v110, v78
  v_cvt_pk_bf16_f32 v70, v108, v109
  s_waitcnt lgkmcnt(8)
  v_mfma_f32_16x16x32_bf16 v[120:123], v[52:55], v[192:195], v[120:123]
  ds_read_b64_tr_b16 v[48:49], v17 offset:20480
  v_rcp_f32 v79, v79
  v_mfma_f32_16x16x32_bf16 v[124:127], v[52:55], v[196:199], v[124:127]
  ds_read_b64_tr_b16 v[50:51], v17 offset:22528
  v_mul_f32 v111, v111, v79
  v_mul_f32 v112, v80, v112
  v_mul_f32 v80, v18, v80
  s_waitcnt lgkmcnt(8)
  v_mfma_f32_16x16x32_bf16 v[88:91], v[32:35], v[200:203], v[88:91]
  ds_read_b64_tr_b16 v[52:53], v17 offset:28672
  v_exp_f32 v80, v80
  v_mfma_f32_16x16x32_bf16 v[92:95], v[32:35], v[204:207], v[92:95]
  ds_read_b64_tr_b16 v[54:55], v17 offset:30720
  v_cvt_pk_bf16_f32 v71, v110, v111
  v_mul_f32 v113, v81, v113
  v_mul_f32 v81, v18, v81
  s_waitcnt lgkmcnt(8)
  v_mfma_f32_16x16x32_bf16 v[120:123], v[36:39], v[200:203], v[120:123]
  ds_read_b64_tr_b16 v[32:33], v17 offset:32768
  v_exp_f32 v81, v81
  v_mfma_f32_16x16x32_bf16 v[124:127], v[36:39], v[204:207], v[124:127]
  ds_read_b64_tr_b16 v[34:35], v17 offset:34816
  v_add_f32 v80, 1.0, v80
  v_mul_f32 v114, v82, v114
  v_mul_f32 v82, v18, v82
  buffer_store_dwordx4 v[64:67], v5, s[24:27], s38 offen offset:0 sc1
  buffer_store_dwordx4 v[68:71], v5, s[24:27], s38 offen offset:1024 sc1
  s_waitcnt lgkmcnt(8)
  v_mfma_f32_16x16x32_bf16 v[88:91], v[40:43], v[128:131], v[88:91]
  ds_read_b64_tr_b16 v[36:37], v17 offset:40960
  v_exp_f32 v82, v82
  v_mfma_f32_16x16x32_bf16 v[92:95], v[40:43], v[132:135], v[92:95]
  ds_read_b64_tr_b16 v[38:39], v17 offset:43008
  v_add_f32 v81, 1.0, v81
  v_mul_f32 v115, v83, v115
  v_mul_f32 v83, v18, v83
  s_waitcnt lgkmcnt(8)
  v_mfma_f32_16x16x32_bf16 v[120:123], v[44:47], v[128:131], v[120:123]
  ds_read_b64_tr_b16 v[40:41], v17 offset:36864
  v_exp_f32 v83, v83
  v_mfma_f32_16x16x32_bf16 v[124:127], v[44:47], v[132:135], v[124:127]
  ds_read_b64_tr_b16 v[42:43], v17 offset:38912
  v_add_f32 v82, 1.0, v82
  v_mul_f32 v116, v84, v116
  v_mul_f32 v84, v18, v84
  s_waitcnt lgkmcnt(8)
  v_mfma_f32_16x16x32_bf16 v[88:91], v[48:51], v[136:139], v[88:91]
  ds_read_b64_tr_b16 v[44:45], v17 offset:45056
  v_exp_f32 v84, v84
  v_mfma_f32_16x16x32_bf16 v[92:95], v[48:51], v[140:143], v[92:95]
  ds_read_b64_tr_b16 v[46:47], v17 offset:47104
  v_add_f32 v83, 1.0, v83
  v_mul_f32 v117, v85, v117
  v_mul_f32 v85, v18, v85
  s_waitcnt lgkmcnt(8)
  v_mfma_f32_16x16x32_bf16 v[120:123], v[52:55], v[136:139], v[120:123]
  ds_read_b64_tr_b16 v[48:49], v17 offset:49152
  v_exp_f32 v85, v85
  v_mfma_f32_16x16x32_bf16 v[124:127], v[52:55], v[140:143], v[124:127]
  ds_read_b64_tr_b16 v[50:51], v17 offset:51200
  v_add_f32 v84, 1.0, v84
  v_mul_f32 v118, v86, v118
  v_mul_f32 v86, v18, v86
  s_waitcnt lgkmcnt(8)
  v_mfma_f32_16x16x32_bf16 v[88:91], v[32:35], v[144:147], v[88:91]
  ds_read_b64_tr_b16 v[52:53], v17 offset:57344
  v_exp_f32 v86, v86
  v_mfma_f32_16x16x32_bf16 v[92:95], v[32:35], v[148:151], v[92:95]
  ds_read_b64_tr_b16 v[54:55], v17 offset:59392
  v_add_f32 v85, 1.0, v85
  v_mul_f32 v119, v87, v119
  v_mul_f32 v87, v18, v87
  s_waitcnt lgkmcnt(8)
  v_mfma_f32_16x16x32_bf16 v[120:123], v[36:39], v[144:147], v[120:123]
  ds_read_b64_tr_b16 v[32:33], v17 offset:53248
  v_exp_f32 v87, v87
  v_mfma_f32_16x16x32_bf16 v[124:127], v[36:39], v[148:151], v[124:127]
  ds_read_b64_tr_b16 v[34:35], v17 offset:55296
  v_add_f32 v86, 1.0, v86
  s_waitcnt lgkmcnt(8)
  v_mfma_f32_16x16x32_bf16 v[88:91], v[40:43], v[152:155], v[88:91]
  ds_read_b64_tr_b16 v[36:37], v17 offset:61440
  v_rcp_f32 v80, v80
  v_mfma_f32_16x16x32_bf16 v[92:95], v[40:43], v[156:159], v[92:95]
  ds_read_b64_tr_b16 v[38:39], v17 offset:63488
  v_mul_f32 v112, v112, v80
  v_add_f32 v87, 1.0, v87
  s_waitcnt lgkmcnt(8)
  v_mfma_f32_16x16x32_bf16 v[120:123], v[44:47], v[152:155], v[120:123]
  v_rcp_f32 v81, v81
  v_mfma_f32_16x16x32_bf16 v[124:127], v[44:47], v[156:159], v[124:127]
  v_mul_f32 v113, v113, v81
  s_waitcnt lgkmcnt(6)
  v_mfma_f32_16x16x32_bf16 v[88:91], v[48:51], v[160:163], v[88:91]
  v_rcp_f32 v82, v82
  v_mfma_f32_16x16x32_bf16 v[92:95], v[48:51], v[164:167], v[92:95]
  v_mul_f32 v114, v114, v82
  s_waitcnt lgkmcnt(4)
  v_mfma_f32_16x16x32_bf16 v[120:123], v[52:55], v[160:163], v[120:123]
  v_rcp_f32 v83, v83
  v_mfma_f32_16x16x32_bf16 v[124:127], v[52:55], v[164:167], v[124:127]
  v_mul_f32 v115, v115, v83
  s_waitcnt lgkmcnt(2)
  v_mfma_f32_16x16x32_bf16 v[88:91], v[32:35], v[168:171], v[88:91]
  v_rcp_f32 v84, v84
  v_mfma_f32_16x16x32_bf16 v[92:95], v[32:35], v[172:175], v[92:95]
  v_mul_f32 v116, v116, v84
  s_waitcnt lgkmcnt(0)
  v_mfma_f32_16x16x32_bf16 v[120:123], v[36:39], v[168:171], v[120:123]
  v_rcp_f32 v85, v85
  v_mfma_f32_16x16x32_bf16 v[124:127], v[36:39], v[172:175], v[124:127]
  v_mul_f32 v117, v117, v85
  s_waitcnt vmcnt(22)
  ds_read_b64_tr_b16 v[48:49], v22 offset:0
  ds_read_b64_tr_b16 v[50:51], v22 offset:2048
  ds_read_b64_tr_b16 v[52:53], v23 offset:0
  ds_read_b64_tr_b16 v[54:55], v23 offset:2048
  ds_read_b64_tr_b16 v[56:57], v24 offset:0
  ds_read_b64_tr_b16 v[58:59], v24 offset:2048
  ds_read_b64_tr_b16 v[60:61], v25 offset:0
  ds_read_b64_tr_b16 v[62:63], v25 offset:2048
  ds_read_b64_tr_b16 v[46:47], v9 offset:2048
  ds_read_b64_tr_b16 v[44:45], v9 offset:0
  ds_read_b64_tr_b16 v[42:43], v8 offset:2048
  ds_read_b64_tr_b16 v[40:41], v8 offset:0
  ds_read_b64_tr_b16 v[38:39], v7 offset:2048
  ds_read_b64_tr_b16 v[36:37], v7 offset:0
  ds_read_b64_tr_b16 v[34:35], v6 offset:2048
  ds_read_b64_tr_b16 v[32:33], v6 offset:0
  v_rcp_f32 v86, v86
  s_nop 0
  v_mul_f32 v118, v118, v86
  v_rcp_f32 v87, v87
  s_nop 0
  v_mul_f32 v119, v119, v87
  s_nop 0
  s_nop 0
  v_add_u32 v14, s18, v14
  v_add_u32 v15, s18, v15
  v_add_u32 v16, s18, v16
  v_add_u32 v17, s18, v17
  v_pk_mul_f32 v[120:121], v[88:89], v[120:121]
  v_pk_mul_f32 v[122:123], v[90:91], v[122:123]
  v_pk_mul_f32 v[124:125], v[92:93], v[124:125]
  v_pk_mul_f32 v[126:127], v[94:95], v[126:127]
  v_pk_mul_f32 v[88:89], v[18:19], v[88:89] op_sel_hi:[0,1]
  v_pk_mul_f32 v[90:91], v[18:19], v[90:91] op_sel_hi:[0,1]
  v_pk_mul_f32 v[92:93], v[18:19], v[92:93] op_sel_hi:[0,1]
  v_pk_mul_f32 v[94:95], v[18:19], v[94:95] op_sel_hi:[0,1]
  v_exp_f32 v88, v88
  v_exp_f32 v89, v89
  v_exp_f32 v90, v90
  v_exp_f32 v91, v91
  v_exp_f32 v92, v92
  v_exp_f32 v93, v93
  v_exp_f32 v94, v94
  v_exp_f32 v95, v95
  v_cvt_pk_bf16_f32 v80, v112, v113
  v_cvt_pk_bf16_f32 v81, v114, v115
  v_cvt_pk_bf16_f32 v84, v116, v117
  v_cvt_pk_bf16_f32 v85, v118, v119
  s_nop 0
  v_pk_add_f32 v[88:89], v[88:89], v[20:21] op_sel_hi:[1,0]
  v_pk_add_f32 v[90:91], v[90:91], v[20:21] op_sel_hi:[1,0]
  v_pk_add_f32 v[92:93], v[92:93], v[20:21] op_sel_hi:[1,0]
  v_pk_add_f32 v[94:95], v[94:95], v[20:21] op_sel_hi:[1,0]
  v_rcp_f32 v88, v88
  v_rcp_f32 v89, v89
  v_rcp_f32 v90, v90
  v_rcp_f32 v91, v91
  v_rcp_f32 v92, v92
  v_rcp_f32 v93, v93
  v_rcp_f32 v94, v94
  v_rcp_f32 v95, v95
  s_nop 0
  v_pk_mul_f32 v[120:121], v[120:121], v[88:89]
  v_pk_mul_f32 v[122:123], v[122:123], v[90:91]
  v_pk_mul_f32 v[124:125], v[124:125], v[92:93]
  v_pk_mul_f32 v[126:127], v[126:127], v[94:95]
  v_cvt_pk_bf16_f32 v82, v120, v121
  v_cvt_pk_bf16_f32 v83, v122, v123
  v_cvt_pk_bf16_f32 v86, v124, v125
  v_cvt_pk_bf16_f32 v87, v126, v127
  buffer_store_dwordx4 v[80:83], v5, s[24:27], s38 offen offset:2048 sc1
  buffer_store_dwordx4 v[84:87], v5, s[24:27], s38 offen offset:3072 sc1
  s_waitcnt lgkmcnt(0)
  s_waitcnt vmcnt(20)
  ds_write_b128 v30, v[208:211] offset:0
  ds_write_b128 v30, v[212:215] offset:1024
  ds_write_b128 v30, v[216:219] offset:2048
  ds_write_b128 v30, v[220:223] offset:3072
  s_waitcnt vmcnt(16)
  ds_write_b128 v10, v[224:227] offset:0
  ds_write_b128 v10, v[228:231] offset:1024
  ds_write_b128 v10, v[232:235] offset:2048
  ds_write_b128 v10, v[236:239] offset:3072
  s_waitcnt vmcnt(0)
  s_barrier
  s_mov_b64 exec, 1
  buffer_store_dword v4, off, s[96:99], s39 offset:0 sc1
  s_mov_b64 exec, -1
  ds_write_b128 v11, v[240:243] offset:0
  ds_write_b128 v11, v[244:247] offset:1024
  ds_write_b128 v11, v[248:251] offset:2048
  ds_write_b128 v11, v[252:255] offset:3072
  ds_write_b128 v11, v[176:179] offset:32768
  ds_write_b128 v11, v[180:183] offset:33792
  ds_write_b128 v11, v[184:187] offset:34816
  ds_write_b128 v11, v[188:191] offset:35840
  s_branch kvattn_kernel_ts2
kvattn_kernel_tidle:
  s_bfe_u32 s37, s2, 0x20003
  s_lshl_b32 s37, s37, 3
  s_add_u32 s37, s37, s12
  s_mul_i32 s37, s37, 57344
  v_lshlrev_b32 v30, 7, v0
  s_add_u32 s19, s37, 0
  buffer_load_dword v128, v30, s[48:51], s19 offen
  s_add_u32 s19, s37, 8192
  buffer_load_dword v129, v30, s[48:51], s19 offen
  s_add_u32 s19, s37, 16384
  buffer_load_dword v130, v30, s[48:51], s19 offen
  s_add_u32 s19, s37, 24576
  buffer_load_dword v131, v30, s[48:51], s19 offen
  s_add_u32 s19, s37, 32768
  buffer_load_dword v132, v30, s[48:51], s19 offen
  s_add_u32 s19, s37, 40960
  buffer_load_dword v133, v30, s[48:51], s19 offen
  s_add_u32 s19, s37, 49152
  buffer_load_dword v134, v30, s[48:51], s19 offen
  s_add_u32 m0, s18, 131072
  s_add_u32 s19, s17, 0
  buffer_load_dwordx4 v13, s[48:51], s19 offen offset:0 lds
  s_add_u32 m0, s18, 131072
  s_add_u32 s19, s17, 7168
  buffer_load_dwordx4 v13, s[48:51], s19 offen offset:1024 lds
  s_add_u32 m0, s18, 131072
  s_add_u32 s19, s17, 14336
  buffer_load_dwordx4 v13, s[48:51], s19 offen offset:2048 lds
  s_add_u32 m0, s18, 131072
  s_add_u32 s19, s17, 21504
  buffer_load_dwordx4 v13, s[48:51], s19 offen offset:3072 lds
  s_add_u32 m0, s18, 0
  s_add_u32 s19, s17, 32768
  buffer_load_dwordx4 v13, s[48:51], s19 offen offset:0 lds
  s_add_u32 m0, s18, 0
  s_add_u32 s19, s17, 39936
  buffer_load_dwordx4 v13, s[48:51], s19 offen offset:1024 lds
  s_add_u32 m0, s18, 0
  s_add_u32 s19, s17, 47104
  buffer_load_dwordx4 v13, s[48:51], s19 offen offset:2048 lds
  s_add_u32 m0, s18, 0
  s_add_u32 s19, s17, 54272
  buffer_load_dwordx4 v13, s[48:51], s19 offen offset:3072 lds
  s_add_u32 m0, s18, 32768
  s_add_u32 s19, s17, 65536
  buffer_load_dwordx4 v13, s[48:51], s19 offen offset:0 lds
  s_add_u32 m0, s18, 32768
  s_add_u32 s19, s17, 72704
  buffer_load_dwordx4 v13, s[48:51], s19 offen offset:1024 lds
  s_add_u32 m0, s18, 32768
  s_add_u32 s19, s17, 79872
  buffer_load_dwordx4 v13, s[48:51], s19 offen offset:2048 lds
  s_add_u32 m0, s18, 32768
  s_add_u32 s19, s17, 87040
  buffer_load_dwordx4 v13, s[48:51], s19 offen offset:3072 lds
  s_add_u32 m0, s18, 65536
  s_add_u32 s19, s17, 98304
  buffer_load_dwordx4 v13, s[48:51], s19 offen offset:0 lds
  s_add_u32 m0, s18, 65536
  s_add_u32 s19, s17, 105472
  buffer_load_dwordx4 v13, s[48:51], s19 offen offset:1024 lds
  s_add_u32 m0, s18, 65536
  s_add_u32 s19, s17, 112640
  buffer_load_dwordx4 v13, s[48:51], s19 offen offset:2048 lds
  s_add_u32 m0, s18, 65536
  s_add_u32 s19, s17, 119808
  buffer_load_dwordx4 v13, s[48:51], s19 offen offset:3072 lds
  s_add_u32 m0, s18, 98304
  s_add_u32 s19, s17, 131072
  buffer_load_dwordx4 v13, s[48:51], s19 offen offset:0 lds
  s_add_u32 m0, s18, 98304
  s_add_u32 s19, s17, 138240
  buffer_load_dwordx4 v13, s[48:51], s19 offen offset:1024 lds
  s_add_u32 m0, s18, 98304
  s_add_u32 s19, s17, 145408
  buffer_load_dwordx4 v13, s[48:51], s19 offen offset:2048 lds
  s_add_u32 m0, s18, 98304
  s_add_u32 s19, s17, 152576
  buffer_load_dwordx4 v13, s[48:51], s19 offen offset:3072 lds
  v_lshrrev_b32 v27, 2, v0
  v_lshlrev_b32 v27, 7, v27
  v_bfe_u32 v26, v0, 3, 2
  v_lshl_add_u32 v27, v26, 5, v27
  v_and_b32 v26, 3, v0
  v_lshl_add_u32 v22, v26, 3, v27
  v_xor_b32 v23, 32, v22
  v_xor_b32 v24, 64, v22
  v_xor_b32 v25, 96, v22
  v_add_u32 v22, s18, v22
  v_add_u32 v6, 0x20000, v22
  v_add_u32 v23, s18, v23
  v_add_u32 v7, 0x20000, v23
  v_add_u32 v24, s18, v24
  v_add_u32 v8, 0x20000, v24
  v_add_u32 v25, s18, v25
  v_add_u32 v9, 0x20000, v25
  v_add_u32 v10, s18, v5
  v_add_u32 v11, 0x10000, v10
  v_add_u32 v30, 0x20000, v10
  s_and_b32 s33, s12, 1
  s_lshl_b32 s32, s16, 1
  s_add_u32 s32, s32, s33
  s_lshr_b32 s33, s12, 1
  s_lshl_b32 s36, s15, 2
  s_add_u32 s36, s36, s33
  s_lshr_b32 s35, s36, 1
  s_lshl_b32 s35, s35, 4
  s_add_u32 s35, s35, s32
  s_lshl_b32 s35, s35, 1
  s_and_b32 s33, s36, 1
  s_add_u32 s35, s35, s33
  s_lshl_b32 s35, s35, 10
  s_lshl_b32 s60, s36, 14
  s_lshl_b32 s33, s32, 6
  s_add_u32 s60, s60, s33
  v_and_b32 v1, 15, v0
  v_lshlrev_b32 v1, 10, v1
  v_bfe_u32 v26, v0, 4, 1
  v_lshl_add_u32 v1, v26, 5, v1
  v_lshrrev_b32 v26, 5, v0
  v_lshl_add_u32 v1, v26, 4, v1
  v_lshrrev_b32 v2, 4, v0
  v_lshlrev_b32 v2, 4, v2
  s_lshl_b32 s61, s32, 7
  s_add_u32 s61, s61, 10240
  s_mov_b32 s20, s92
  s_mov_b32 s21, s93
  s_mov_b32 s22, 0x200000
  s_mov_b32 s23, 0x20000
  v_add_u32 v14, 0x10000, v22
  v_add_u32 v15, 0x10000, v23
  v_add_u32 v16, 0x10000, v24
  v_add_u32 v17, 0x10000, v25
  s_waitcnt vmcnt(12)
  ds_read_b64_tr_b16 v[32:33], v6 offset:0
  ds_read_b64_tr_b16 v[34:35], v6 offset:2048
  ds_read_b64_tr_b16 v[36:37], v7 offset:0
  ds_read_b64_tr_b16 v[38:39], v7 offset:2048
  ds_read_b64_tr_b16 v[40:41], v8 offset:0
  ds_read_b64_tr_b16 v[42:43], v8 offset:2048
  ds_read_b64_tr_b16 v[44:45], v9 offset:0
  ds_read_b64_tr_b16 v[46:47], v9 offset:2048
  ds_read_b64_tr_b16 v[48:49], v22 offset:0
  ds_read_b64_tr_b16 v[50:51], v22 offset:2048
  ds_read_b64_tr_b16 v[52:53], v23 offset:0
  ds_read_b64_tr_b16 v[54:55], v23 offset:2048
  ds_read_b64_tr_b16 v[56:57], v24 offset:0
  ds_read_b64_tr_b16 v[58:59], v24 offset:2048
  ds_read_b64_tr_b16 v[60:61], v25 offset:0
  ds_read_b64_tr_b16 v[62:63], v25 offset:2048
  s_waitcnt lgkmcnt(0)
  s_add_u32 m0, s18, 131072
  s_add_u32 s19, s17, 163840
  buffer_load_dwordx4 v13, s[48:51], s19 offen offset:0 lds
  s_add_u32 m0, s18, 131072
  s_add_u32 s19, s17, 171008
  buffer_load_dwordx4 v13, s[48:51], s19 offen offset:1024 lds
  s_add_u32 m0, s18, 131072
  s_add_u32 s19, s17, 178176
  buffer_load_dwordx4 v13, s[48:51], s19 offen offset:2048 lds
  s_add_u32 m0, s18, 131072
  s_add_u32 s19, s17, 185344
  buffer_load_dwordx4 v13, s[48:51], s19 offen offset:3072 lds
  s_add_u32 m0, s18, 0
  s_add_u32 s19, s17, 196608
  buffer_load_dwordx4 v13, s[48:51], s19 offen offset:0 lds
  s_add_u32 m0, s18, 0
  s_add_u32 s19, s17, 203776
  buffer_load_dwordx4 v13, s[48:51], s19 offen offset:1024 lds
  s_add_u32 m0, s18, 0
  s_add_u32 s19, s17, 210944
  buffer_load_dwordx4 v13, s[48:51], s19 offen offset:2048 lds
  s_add_u32 m0, s18, 0
  s_add_u32 s19, s17, 218112
  buffer_load_dwordx4 v13, s[48:51], s19 offen offset:3072 lds
kvattn_kernel_ts2:
  buffer_load_dword v3, v29, s[96:99], s8 offen sc1
  s_waitcnt vmcnt(0)
  v_cmp_ne_u32 vcc, s85, v3
  s_cbranch_vccnz kvattn_kernel_tsping
kvattn_kernel_treadyg:
  s_waitcnt lgkmcnt(0)
  s_add_u32 s19, s42, 0
  buffer_load_dwordx4 v[128:131], v5, s[24:27], s19 offen offset:0 sc1
  buffer_load_dwordx4 v[132:135], v5, s[24:27], s19 offen offset:1024 sc1
  s_add_u32 s19, s43, 0
  buffer_load_dwordx4 v[136:139], v5, s[24:27], s19 offen offset:0 sc1
  buffer_load_dwordx4 v[140:143], v5, s[24:27], s19 offen offset:1024 sc1
  s_add_u32 s19, s42, 2048
  buffer_load_dwordx4 v[144:147], v5, s[24:27], s19 offen offset:0 sc1
  buffer_load_dwordx4 v[148:151], v5, s[24:27], s19 offen offset:1024 sc1
  s_add_u32 s19, s43, 2048
  buffer_load_dwordx4 v[152:155], v5, s[24:27], s19 offen offset:0 sc1
  buffer_load_dwordx4 v[156:159], v5, s[24:27], s19 offen offset:1024 sc1
  s_add_u32 s19, s42, 4096
  buffer_load_dwordx4 v[160:163], v5, s[24:27], s19 offen offset:0 sc1
  buffer_load_dwordx4 v[164:167], v5, s[24:27], s19 offen offset:1024 sc1
  s_add_u32 s19, s43, 4096
  buffer_load_dwordx4 v[168:171], v5, s[24:27], s19 offen offset:0 sc1
  buffer_load_dwordx4 v[172:175], v5, s[24:27], s19 offen offset:1024 sc1
  s_add_u32 s19, s42, 6144
  buffer_load_dwordx4 v[176:179], v5, s[24:27], s19 offen offset:0 sc1
  buffer_load_dwordx4 v[180:183], v5, s[24:27], s19 offen offset:1024 sc1
  s_add_u32 s19, s43, 6144
  buffer_load_dwordx4 v[184:187], v5, s[24:27], s19 offen offset:0 sc1
  buffer_load_dwordx4 v[188:191], v5, s[24:27], s19 offen offset:1024 sc1
  s_add_u32 s19, s42, 8192
  buffer_load_dwordx4 v[192:195], v5, s[24:27], s19 offen offset:0 sc1
  buffer_load_dwordx4 v[196:199], v5, s[24:27], s19 offen offset:1024 sc1
  s_add_u32 s19, s43, 8192
  buffer_load_dwordx4 v[200:203], v5, s[24:27], s19 offen offset:0 sc1
  buffer_load_dwordx4 v[204:207], v5, s[24:27], s19 offen offset:1024 sc1
  s_add_u32 s19, s42, 10240
  buffer_load_dwordx4 v[208:211], v5, s[24:27], s19 offen offset:0 sc1
  buffer_load_dwordx4 v[212:215], v5, s[24:27], s19 offen offset:1024 sc1
  s_add_u32 s19, s43, 10240
  buffer_load_dwordx4 v[216:219], v5, s[24:27], s19 offen offset:0 sc1
  buffer_load_dwordx4 v[220:223], v5, s[24:27], s19 offen offset:1024 sc1
  s_add_u32 s19, s42, 12288
  buffer_load_dwordx4 v[224:227], v5, s[24:27], s19 offen offset:0 sc1
  buffer_load_dwordx4 v[228:231], v5, s[24:27], s19 offen offset:1024 sc1
  s_add_u32 s19, s43, 12288
  buffer_load_dwordx4 v[232:235], v5, s[24:27], s19 offen offset:0 sc1
  buffer_load_dwordx4 v[236:239], v5, s[24:27], s19 offen offset:1024 sc1
  buffer_load_dwordx4 v[248:251], v5, s[56:59], s35 offen sc1
  buffer_load_dwordx4 v[240:243], v2, s[52:55], s61 offen sc1
  buffer_load_dwordx4 v[244:247], v2, s[52:55], s61 offen offset:64 sc1
  s_waitcnt vmcnt(27)
  v_mfma_f32_16x16x32_bf16 v[64:67], v[32:35], v[128:131], 0
  v_mfma_f32_16x16x32_bf16 v[80:83], v[32:35], v[132:135], 0
  v_mfma_f32_16x16x32_bf16 v[96:99], v[32:35], v[136:139], 0
  v_mfma_f32_16x16x32_bf16 v[112:115], v[32:35], v[140:143], 0
  v_mfma_f32_16x16x32_bf16 v[68:71], v[36:39], v[128:131], 0
  v_mfma_f32_16x16x32_bf16 v[84:87], v[36:39], v[132:135], 0
  v_mfma_f32_16x16x32_bf16 v[100:103], v[36:39], v[136:139], 0
  v_mfma_f32_16x16x32_bf16 v[116:119], v[36:39], v[140:143], 0
  v_mfma_f32_16x16x32_bf16 v[72:75], v[40:43], v[128:131], 0
  v_mfma_f32_16x16x32_bf16 v[88:91], v[40:43], v[132:135], 0
  v_mfma_f32_16x16x32_bf16 v[104:107], v[40:43], v[136:139], 0
  v_mfma_f32_16x16x32_bf16 v[120:123], v[40:43], v[140:143], 0
  v_mfma_f32_16x16x32_bf16 v[76:79], v[44:47], v[128:131], 0
  v_mfma_f32_16x16x32_bf16 v[92:95], v[44:47], v[132:135], 0
  v_mfma_f32_16x16x32_bf16 v[108:111], v[44:47], v[136:139], 0
  v_mfma_f32_16x16x32_bf16 v[124:127], v[44:47], v[140:143], 0
  s_waitcnt vmcnt(23)
  v_mfma_f32_16x16x32_bf16 v[64:67], v[48:51], v[144:147], v[64:67]
  v_mfma_f32_16x16x32_bf16 v[80:83], v[48:51], v[148:151], v[80:83]
  v_mfma_f32_16x16x32_bf16 v[96:99], v[48:51], v[152:155], v[96:99]
  v_mfma_f32_16x16x32_bf16 v[112:115], v[48:51], v[156:159], v[112:115]
  v_mfma_f32_16x16x32_bf16 v[68:71], v[52:55], v[144:147], v[68:71]
  v_mfma_f32_16x16x32_bf16 v[84:87], v[52:55], v[148:151], v[84:87]
  ds_read_b64_tr_b16 v[32:33], v22 offset:32768
  v_mfma_f32_16x16x32_bf16 v[100:103], v[52:55], v[152:155], v[100:103]
  ds_read_b64_tr_b16 v[34:35], v22 offset:34816
  v_mfma_f32_16x16x32_bf16 v[116:119], v[52:55], v[156:159], v[116:119]
  ds_read_b64_tr_b16 v[36:37], v23 offset:32768
  v_mfma_f32_16x16x32_bf16 v[72:75], v[56:59], v[144:147], v[72:75]
  ds_read_b64_tr_b16 v[38:39], v23 offset:34816
  v_mfma_f32_16x16x32_bf16 v[88:91], v[56:59], v[148:151], v[88:91]
  ds_read_b64_tr_b16 v[40:41], v24 offset:32768
  v_mfma_f32_16x16x32_bf16 v[104:107], v[56:59], v[152:155], v[104:107]
  ds_read_b64_tr_b16 v[42:43], v24 offset:34816
  v_mfma_f32_16x16x32_bf16 v[120:123], v[56:59], v[156:159], v[120:123]
  ds_read_b64_tr_b16 v[44:45], v25 offset:32768
  v_mfma_f32_16x16x32_bf16 v[76:79], v[60:63], v[144:147], v[76:79]
  ds_read_b64_tr_b16 v[46:47], v25 offset:34816
  v_mfma_f32_16x16x32_bf16 v[92:95], v[60:63], v[148:151], v[92:95]
  v_mfma_f32_16x16x32_bf16 v[108:111], v[60:63], v[152:155], v[108:111]
  v_mfma_f32_16x16x32_bf16 v[124:127], v[60:63], v[156:159], v[124:127]
  s_waitcnt vmcnt(19) lgkmcnt(0)
  v_mfma_f32_16x16x32_bf16 v[64:67], v[32:35], v[160:163], v[64:67]
  v_mfma_f32_16x16x32_bf16 v[80:83], v[32:35], v[164:167], v[80:83]
  v_mfma_f32_16x16x32_bf16 v[96:99], v[32:35], v[168:171], v[96:99]
  v_mfma_f32_16x16x32_bf16 v[112:115], v[32:35], v[172:175], v[112:115]
  v_mfma_f32_16x16x32_bf16 v[68:71], v[36:39], v[160:163], v[68:71]
  v_mfma_f32_16x16x32_bf16 v[84:87], v[36:39], v[164:167], v[84:87]
  ds_read_b64_tr_b16 v[48:49], v14 offset:0
  v_mfma_f32_16x16x32_bf16 v[100:103], v[36:39], v[168:171], v[100:103]
  ds_read_b64_tr_b16 v[50:51], v14 offset:2048
  v_mfma_f32_16x16x32_bf16 v[116:119], v[36:39], v[172:175], v[116:119]
  ds_read_b64_tr_b16 v[52:53], v15 offset:0
  v_mfma_f32_16x16x32_bf16 v[72:75], v[40:43], v[160:163], v[72:75]
  ds_read_b64_tr_b16 v[54:55], v15 offset:2048
  v_mfma_f32_16x16x32_bf16 v[88:91], v[40:43], v[164:167], v[88:91]
  ds_read_b64_tr_b16 v[56:57], v16 offset:0
  v_mfma_f32_16x16x32_bf16 v[104:107], v[40:43], v[168:171], v[104:107]
  ds_read_b64_tr_b16 v[58:59], v16 offset:2048
  v_mfma_f32_16x16x32_bf16 v[120:123], v[40:43], v[172:175], v[120:123]
  ds_read_b64_tr_b16 v[60:61], v17 offset:0
  v_mfma_f32_16x16x32_bf16 v[76:79], v[44:47], v[160:163], v[76:79]
  ds_read_b64_tr_b16 v[62:63], v17 offset:2048
  v_mfma_f32_16x16x32_bf16 v[92:95], v[44:47], v[164:167], v[92:95]
  v_mfma_f32_16x16x32_bf16 v[108:111], v[44:47], v[168:171], v[108:111]
  v_mfma_f32_16x16x32_bf16 v[124:127], v[44:47], v[172:175], v[124:127]
  s_waitcnt vmcnt(15) lgkmcnt(0)
  v_mfma_f32_16x16x32_bf16 v[64:67], v[48:51], v[176:179], v[64:67]
  v_mfma_f32_16x16x32_bf16 v[80:83], v[48:51], v[180:183], v[80:83]
  v_mfma_f32_16x16x32_bf16 v[96:99], v[48:51], v[184:187], v[96:99]
  v_mfma_f32_16x16x32_bf16 v[112:115], v[48:51], v[188:191], v[112:115]
  v_mfma_f32_16x16x32_bf16 v[68:71], v[52:55], v[176:179], v[68:71]
  v_mfma_f32_16x16x32_bf16 v[84:87], v[52:55], v[180:183], v[84:87]
  ds_read_b64_tr_b16 v[32:33], v14 offset:32768
  v_mfma_f32_16x16x32_bf16 v[100:103], v[52:55], v[184:187], v[100:103]
  ds_read_b64_tr_b16 v[34:35], v14 offset:34816
  v_mfma_f32_16x16x32_bf16 v[116:119], v[52:55], v[188:191], v[116:119]
  ds_read_b64_tr_b16 v[36:37], v15 offset:32768
  v_mfma_f32_16x16x32_bf16 v[72:75], v[56:59], v[176:179], v[72:75]
  ds_read_b64_tr_b16 v[38:39], v15 offset:34816
  v_mfma_f32_16x16x32_bf16 v[88:91], v[56:59], v[180:183], v[88:91]
  ds_read_b64_tr_b16 v[40:41], v16 offset:32768
  v_mfma_f32_16x16x32_bf16 v[104:107], v[56:59], v[184:187], v[104:107]
  ds_read_b64_tr_b16 v[42:43], v16 offset:34816
  v_mfma_f32_16x16x32_bf16 v[120:123], v[56:59], v[188:191], v[120:123]
  ds_read_b64_tr_b16 v[44:45], v17 offset:32768
  v_mfma_f32_16x16x32_bf16 v[76:79], v[60:63], v[176:179], v[76:79]
  ds_read_b64_tr_b16 v[46:47], v17 offset:34816
  v_mfma_f32_16x16x32_bf16 v[92:95], v[60:63], v[180:183], v[92:95]
  v_mfma_f32_16x16x32_bf16 v[108:111], v[60:63], v[184:187], v[108:111]
  v_mfma_f32_16x16x32_bf16 v[124:127], v[60:63], v[188:191], v[124:127]
  s_waitcnt vmcnt(11) lgkmcnt(0)
  v_mfma_f32_16x16x32_bf16 v[64:67], v[32:35], v[192:195], v[64:67]
  v_mfma_f32_16x16x32_bf16 v[80:83], v[32:35], v[196:199], v[80:83]
  v_mfma_f32_16x16x32_bf16 v[96:99], v[32:35], v[200:203], v[96:99]
  v_mfma_f32_16x16x32_bf16 v[112:115], v[32:35], v[204:207], v[112:115]
  v_mfma_f32_16x16x32_bf16 v[68:71], v[36:39], v[192:195], v[68:71]
  v_mfma_f32_16x16x32_bf16 v[84:87], v[36:39], v[196:199], v[84:87]
  ds_read_b64_tr_b16 v[48:49], v6 offset:0
  v_mfma_f32_16x16x32_bf16 v[100:103], v[36:39], v[200:203], v[100:103]
  ds_read_b64_tr_b16 v[50:51], v6 offset:2048
  v_mfma_f32_16x16x32_bf16 v[116:119], v[36:39], v[204:207], v[116:119]
  ds_read_b64_tr_b16 v[52:53], v7 offset:0
  v_mfma_f32_16x16x32_bf16 v[72:75], v[40:43], v[192:195], v[72:75]
  ds_read_b64_tr_b16 v[54:55], v7 offset:2048
  v_mfma_f32_16x16x32_bf16 v[88:91], v[40:43], v[196:199], v[88:91]
  ds_read_b64_tr_b16 v[56:57], v8 offset:0
  v_mfma_f32_16x16x32_bf16 v[104:107], v[40:43], v[200:203], v[104:107]
  ds_read_b64_tr_b16 v[58:59], v8 offset:2048
  v_mfma_f32_16x16x32_bf16 v[120:123], v[40:43], v[204:207], v[120:123]
  ds_read_b64_tr_b16 v[60:61], v9 offset:0
  v_mfma_f32_16x16x32_bf16 v[76:79], v[44:47], v[192:195], v[76:79]
  ds_read_b64_tr_b16 v[62:63], v9 offset:2048
  v_mfma_f32_16x16x32_bf16 v[92:95], v[44:47], v[196:199], v[92:95]
  v_mfma_f32_16x16x32_bf16 v[108:111], v[44:47], v[200:203], v[108:111]
  v_mfma_f32_16x16x32_bf16 v[124:127], v[44:47], v[204:207], v[124:127]
  s_waitcnt vmcnt(7) lgkmcnt(0)
  v_mfma_f32_16x16x32_bf16 v[64:67], v[48:51], v[208:211], v[64:67]
  v_mfma_f32_16x16x32_bf16 v[80:83], v[48:51], v[212:215], v[80:83]
  v_mfma_f32_16x16x32_bf16 v[96:99], v[48:51], v[216:219], v[96:99]
  v_mfma_f32_16x16x32_bf16 v[112:115], v[48:51], v[220:223], v[112:115]
  v_mfma_f32_16x16x32_bf16 v[68:71], v[52:55], v[208:211], v[68:71]
  v_mfma_f32_16x16x32_bf16 v[84:87], v[52:55], v[212:215], v[84:87]
  ds_read_b64_tr_b16 v[32:33], v22 offset:0
  v_mfma_f32_16x16x32_bf16 v[100:103], v[52:55], v[216:219], v[100:103]
  ds_read_b64_tr_b16 v[34:35], v22 offset:2048
  v_mfma_f32_16x16x32_bf16 v[116:119], v[52:55], v[220:223], v[116:119]
  ds_read_b64_tr_b16 v[36:37], v23 offset:0
  v_mfma_f32_16x16x32_bf16 v[72:75], v[56:59], v[208:211], v[72:75]
  ds_read_b64_tr_b16 v[38:39], v23 offset:2048
  v_mfma_f32_16x16x32_bf16 v[88:91], v[56:59], v[212:215], v[88:91]
  ds_read_b64_tr_b16 v[40:41], v24 offset:0
  v_mfma_f32_16x16x32_bf16 v[104:107], v[56:59], v[216:219], v[104:107]
  ds_read_b64_tr_b16 v[42:43], v24 offset:2048
  v_mfma_f32_16x16x32_bf16 v[120:123], v[56:59], v[220:223], v[120:123]
  ds_read_b64_tr_b16 v[44:45], v25 offset:0
  v_mfma_f32_16x16x32_bf16 v[76:79], v[60:63], v[208:211], v[76:79]
  ds_read_b64_tr_b16 v[46:47], v25 offset:2048
  v_mfma_f32_16x16x32_bf16 v[92:95], v[60:63], v[212:215], v[92:95]
  v_mfma_f32_16x16x32_bf16 v[108:111], v[60:63], v[216:219], v[108:111]
  v_mfma_f32_16x16x32_bf16 v[124:127], v[60:63], v[220:223], v[124:127]
  s_waitcnt vmcnt(3) lgkmcnt(0)
  v_mfma_f32_16x16x32_bf16 v[64:67], v[32:35], v[224:227], v[64:67]
  s_lshr_b32 s37, s12, 1
  s_lshl_b32 s37, s37, 15
  v_mfma_f32_16x16x32_bf16 v[80:83], v[32:35], v[228:231], v[80:83]
  s_and_b32 s19, s12, 1
  s_lshl_b32 s19, s19, 11
  v_mfma_f32_16x16x32_bf16 v[96:99], v[32:35], v[232:235], v[96:99]
  s_add_u32 s37, s37, s19
  v_add_u32 v12, s37, v5
  v_mfma_f32_16x16x32_bf16 v[112:115], v[32:35], v[236:239], v[112:115]
  v_mfma_f32_16x16x32_bf16 v[68:71], v[36:39], v[224:227], v[68:71]
  v_mfma_f32_16x16x32_bf16 v[84:87], v[36:39], v[228:231], v[84:87]
  ds_write_b128 v10, v[64:67] offset:0
  v_mfma_f32_16x16x32_bf16 v[100:103], v[36:39], v[232:235], v[100:103]
  ds_write_b128 v10, v[80:83] offset:32768
  v_mfma_f32_16x16x32_bf16 v[116:119], v[36:39], v[236:239], v[116:119]
  ds_write_b128 v11, v[96:99] offset:0
  v_mfma_f32_16x16x32_bf16 v[72:75], v[40:43], v[224:227], v[72:75]
  ds_write_b128 v11, v[112:115] offset:32768
  v_mfma_f32_16x16x32_bf16 v[88:91], v[40:43], v[228:231], v[88:91]
  ds_write_b128 v10, v[68:71] offset:1024
  v_mfma_f32_16x16x32_bf16 v[104:107], v[40:43], v[232:235], v[104:107]
  ds_write_b128 v10, v[84:87] offset:33792
  v_mfma_f32_16x16x32_bf16 v[120:123], v[40:43], v[236:239], v[120:123]
  ds_write_b128 v11, v[100:103] offset:1024
  v_mfma_f32_16x16x32_bf16 v[76:79], v[44:47], v[224:227], v[76:79]
  ds_write_b128 v11, v[116:119] offset:33792
  v_mfma_f32_16x16x32_bf16 v[92:95], v[44:47], v[228:231], v[92:95]
  ds_write_b128 v10, v[72:75] offset:2048
  v_mfma_f32_16x16x32_bf16 v[108:111], v[44:47], v[232:235], v[108:111]
  ds_write_b128 v10, v[88:91] offset:34816
  v_mfma_f32_16x16x32_bf16 v[124:127], v[44:47], v[236:239], v[124:127]
  ds_write_b128 v11, v[104:107] offset:2048
  s_nop 0
  ds_write_b128 v11, v[120:123] offset:34816
  ds_write_b128 v10, v[76:79] offset:3072
  ds_write_b128 v10, v[92:95] offset:35840
  s_nop 0
  ds_write_b128 v11, v[108:111] offset:3072
  s_nop 0
  ds_write_b128 v11, v[124:127] offset:35840
  s_waitcnt lgkmcnt(0)
  s_barrier
  ds_read_b128 v[64:67], v12 offset:0
  ds_read_b128 v[68:71], v12 offset:1024
  ds_read_b128 v[72:75], v12 offset:4096
  ds_read_b128 v[76:79], v12 offset:5120
  ds_read_b128 v[80:83], v12 offset:8192
  ds_read_b128 v[84:87], v12 offset:9216
  ds_read_b128 v[88:91], v12 offset:12288
  ds_read_b128 v[92:95], v12 offset:13312
  ds_read_b128 v[96:99], v12 offset:16384
  ds_read_b128 v[100:103], v12 offset:17408
  ds_read_b128 v[104:107], v12 offset:20480
  ds_read_b128 v[108:111], v12 offset:21504
  ds_read_b128 v[112:115], v12 offset:24576
  ds_read_b128 v[116:119], v12 offset:25600
  ds_read_b128 v[120:123], v12 offset:28672
  ds_read_b128 v[124:127], v12 offset:29696
  s_waitcnt vmcnt(0)
  v_lshlrev_b32 v32, 16, v248
  v_and_b32 v33, 0xffff0000, v248
  v_lshlrev_b32 v34, 16, v249
  v_and_b32 v35, 0xffff0000, v249
  v_lshlrev_b32 v36, 16, v250
  v_and_b32 v37, 0xffff0000, v250
  v_lshlrev_b32 v38, 16, v251
  v_and_b32 v39, 0xffff0000, v251
  v_xor_b32 v240, s85, v240
  v_xor_b32 v241, s85, v241
  v_xor_b32 v242, s85, v242
  v_xor_b32 v243, s85, v243
  v_xor_b32 v244, s85, v244
  v_xor_b32 v245, s85, v245
  v_xor_b32 v246, s85, v246
  v_xor_b32 v247, s85, v247
  s_waitcnt lgkmcnt(12)
  v_pk_add_f32 v[64:65], v[64:65], v[72:73]
  v_pk_add_f32 v[66:67], v[66:67], v[74:75]
  v_pk_add_f32 v[68:69], v[68:69], v[76:77]
  v_pk_add_f32 v[70:71], v[70:71], v[78:79]
  s_waitcnt lgkmcnt(10)
  v_pk_add_f32 v[64:65], v[64:65], v[80:81]
  v_pk_add_f32 v[66:67], v[66:67], v[82:83]
  v_pk_add_f32 v[68:69], v[68:69], v[84:85]
  v_pk_add_f32 v[70:71], v[70:71], v[86:87]
  s_waitcnt lgkmcnt(8)
  v_pk_add_f32 v[64:65], v[64:65], v[88:89]
  v_pk_add_f32 v[66:67], v[66:67], v[90:91]
  v_pk_add_f32 v[68:69], v[68:69], v[92:93]
  v_pk_add_f32 v[70:71], v[70:71], v[94:95]
  s_waitcnt lgkmcnt(6)
  v_pk_add_f32 v[64:65], v[64:65], v[96:97]
  v_pk_add_f32 v[66:67], v[66:67], v[98:99]
  v_pk_add_f32 v[68:69], v[68:69], v[100:101]
  v_pk_add_f32 v[70:71], v[70:71], v[102:103]
  s_waitcnt lgkmcnt(4)
  v_pk_add_f32 v[64:65], v[64:65], v[104:105]
  v_pk_add_f32 v[66:67], v[66:67], v[106:107]
  v_pk_add_f32 v[68:69], v[68:69], v[108:109]
  v_pk_add_f32 v[70:71], v[70:71], v[110:111]
  s_waitcnt lgkmcnt(2)
  v_pk_add_f32 v[64:65], v[64:65], v[112:113]
  v_pk_add_f32 v[66:67], v[66:67], v[114:115]
  v_pk_add_f32 v[68:69], v[68:69], v[116:117]
  v_pk_add_f32 v[70:71], v[70:71], v[118:119]
  s_waitcnt lgkmcnt(0)
  v_pk_add_f32 v[64:65], v[64:65], v[120:121]
  v_pk_add_f32 v[66:67], v[66:67], v[122:123]
  v_pk_add_f32 v[68:69], v[68:69], v[124:125]
  v_pk_add_f32 v[70:71], v[70:71], v[126:127]
  v_pk_fma_f32 v[32:33], v[240:241], v[64:65], v[32:33]
  v_pk_fma_f32 v[34:35], v[242:243], v[66:67], v[34:35]
  v_pk_fma_f32 v[36:37], v[244:245], v[68:69], v[36:37]
  v_pk_fma_f32 v[38:39], v[246:247], v[70:71], v[38:39]
  v_cvt_pk_bf16_f32 v64, v32, v33
  v_cvt_pk_bf16_f32 v65, v34, v35
  v_cvt_pk_bf16_f32 v66, v36, v37
  v_cvt_pk_bf16_f32 v67, v38, v39
  s_nop 0
  v_permlane16_swap_b32 v64, v66
  v_permlane16_swap_b32 v65, v67
  s_nop 0
  buffer_store_dwordx4 v[64:67], v1, s[20:23], s60 offen sc1
  s_endpgm
kvattn_kernel_spinm:
  s_mov_b32 s62, 0
kvattn_kernel_spinm2:
  s_sleep 4
  buffer_load_dwordx2 v[32:33], v39, s[36:39], 0 offen sc1
  s_add_u32 s62, s62, 1
  s_waitcnt vmcnt(0)
  s_cmp_ge_u32 s62, 0x40000
  s_cbranch_scc1 kvattn_kernel_readym
  v_xor_b32 v32, s85, v32
  v_xor_b32 v33, s85, v33
  v_or_b32 v3, v32, v33
  v_cmp_ne_u16 vcc, 0, v3
  s_cbranch_vccnz kvattn_kernel_spinm2
  s_branch kvattn_kernel_readym
kvattn_kernel_spinh:
  s_mov_b32 s62, 0
kvattn_kernel_spinh2:
  s_sleep 2
  v_and_b32 v3, 31, v0
  v_lshlrev_b32 v3, 10, v3
  buffer_load_dword v3, v3, s[96:99], s19 offen sc1
  s_add_u32 s62, s62, 1
  s_cmp_ge_u32 s62, 0x40000
  s_cbranch_scc1 kvattn_kernel_readyh
  s_waitcnt vmcnt(0)
  v_cmp_ne_u32 vcc, s85, v3
  s_cbranch_vccnz kvattn_kernel_spinh2
  s_branch kvattn_kernel_readyh
kvattn_kernel_spink:
  s_mov_b32 s62, 0
kvattn_kernel_spink2:
  s_sleep 2
  v_and_b32 v3, 7, v0
  v_lshlrev_b32 v3, 7, v3
  buffer_load_dword v3, v3, s[96:99], s17 offen sc1
  s_add_u32 s62, s62, 1
  s_cmp_ge_u32 s62, 0x40000
  s_cbranch_scc1 kvattn_kernel_readyk
  s_waitcnt vmcnt(0)
  v_cmp_ne_u32 vcc, s85, v3
  s_cbranch_vccnz kvattn_kernel_spink2
  s_branch kvattn_kernel_readyk
kvattn_kernel_spinv:
  s_mov_b32 s62, 0
kvattn_kernel_spinv2:
  s_sleep 2
  v_and_b32 v3, 7, v0
  v_lshl_or_b32 v3, v3, 7, 8
  buffer_load_dword v3, v3, s[96:99], s17 offen sc1
  s_add_u32 s62, s62, 1
  s_cmp_ge_u32 s62, 0x40000
  s_cbranch_scc1 kvattn_kernel_readyv
  s_waitcnt vmcnt(0)
  v_cmp_ne_u32 vcc, s85, v3
  s_cbranch_vccnz kvattn_kernel_spinv2
  s_branch kvattn_kernel_readyv
kvattn_kernel_spinc:
  s_mov_b32 s62, 0
kvattn_kernel_spinc2:
  s_sleep 2
  v_and_b32 v3, 3, v0
  v_lshlrev_b32 v3, 13, v3
  buffer_load_dword v3, v3, s[96:99], s8 offen sc1
  s_add_u32 s62, s62, 1
  s_cmp_ge_u32 s62, 0x40000
  s_cbranch_scc1 kvattn_kernel_readyc
  s_waitcnt vmcnt(0)
  v_cmp_ne_u32 vcc, s85, v3
  s_cbranch_vccnz kvattn_kernel_spinc2
  s_branch kvattn_kernel_readyc
kvattn_kernel_gpo:
  s_movk_i32 s60, 0xff
  s_mov_b32 s62, 0
  v_permlane16_swap_b32 v8, v10
  v_permlane16_swap_b32 v9, v11
  v_xor_b32 v64, s85, v64
  v_xor_b32 v65, s85, v65
  v_xor_b32 v66, s85, v66
  v_xor_b32 v67, s85, v67
  v_xor_b32 v68, s85, v68
  v_xor_b32 v69, s85, v69
  v_xor_b32 v70, s85, v70
  v_xor_b32 v71, s85, v71
  v_xor_b32 v72, s85, v72
  v_xor_b32 v73, s85, v73
  v_xor_b32 v74, s85, v74
  v_xor_b32 v75, s85, v75
  v_xor_b32 v76, s85, v76
  v_xor_b32 v77, s85, v77
  v_xor_b32 v78, s85, v78
  v_xor_b32 v79, s85, v79
  v_xor_b32 v80, s85, v80
  v_xor_b32 v81, s85, v81
  v_xor_b32 v82, s85, v82
  v_xor_b32 v83, s85, v83
  v_xor_b32 v84, s85, v84
  v_xor_b32 v85, s85, v85
  v_xor_b32 v86, s85, v86
  v_xor_b32 v87, s85, v87
  s_branch kvattn_kernel_gpo_2
kvattn_kernel_gpo_1:
  s_sleep 1
  buffer_load_dword v3, v27, s[96:99], s9 offen sc1
  s_add_u32 s62, s62, 1
  s_waitcnt vmcnt(0)
  s_cmp_eq_u32 s61, 0
  s_cbranch_scc1 kvattn_kernel_gpo_2
  s_bitcmp1_b32 s61, 0
  s_cbranch_scc0 kvattn_kernel_gpu0
  v_lshlrev_b32 v88, 16, v32
  v_and_b32 v89, 0xffff0000, v32
  v_lshlrev_b32 v90, 16, v33
  v_and_b32 v91, 0xffff0000, v33
  v_lshlrev_b32 v92, 16, v34
  v_and_b32 v93, 0xffff0000, v34
  v_lshlrev_b32 v94, 16, v35
  v_and_b32 v95, 0xffff0000, v35
kvattn_kernel_gpu0:
  s_bitcmp1_b32 s61, 1
  s_cbranch_scc0 kvattn_kernel_gpu1
  v_lshlrev_b32 v136, 16, v36
  v_and_b32 v137, 0xffff0000, v36
  v_lshlrev_b32 v138, 16, v37
  v_and_b32 v139, 0xffff0000, v37
  v_lshlrev_b32 v140, 16, v38
  v_and_b32 v141, 0xffff0000, v38
  v_lshlrev_b32 v142, 16, v39
  v_and_b32 v143, 0xffff0000, v39
kvattn_kernel_gpu1:
  s_bitcmp1_b32 s61, 2
  s_cbranch_scc0 kvattn_kernel_gpu2
  v_lshlrev_b32 v144, 16, v40
  v_and_b32 v145, 0xffff0000, v40
  v_lshlrev_b32 v146, 16, v41
  v_and_b32 v147, 0xffff0000, v41
  v_lshlrev_b32 v148, 16, v42
  v_and_b32 v149, 0xffff0000, v42
  v_lshlrev_b32 v150, 16, v43
  v_and_b32 v151, 0xffff0000, v43
kvattn_kernel_gpu2:
  s_bitcmp1_b32 s61, 3
  s_cbranch_scc0 kvattn_kernel_gpu3
  v_lshlrev_b32 v152, 16, v44
  v_and_b32 v153, 0xffff0000, v44
  v_lshlrev_b32 v154, 16, v45
  v_and_b32 v155, 0xffff0000, v45
  v_lshlrev_b32 v156, 16, v46
  v_and_b32 v157, 0xffff0000, v46
  v_lshlrev_b32 v158, 16, v47
  v_and_b32 v159, 0xffff0000, v47
kvattn_kernel_gpu3:
  s_bitcmp1_b32 s61, 4
  s_cbranch_scc0 kvattn_kernel_gpu4
  v_lshlrev_b32 v160, 16, v48
  v_and_b32 v161, 0xffff0000, v48
  v_lshlrev_b32 v162, 16, v49
  v_and_b32 v163, 0xffff0000, v49
  v_lshlrev_b32 v164, 16, v50
  v_and_b32 v165, 0xffff0000, v50
  v_lshlrev_b32 v166, 16, v51
  v_and_b32 v167, 0xffff0000, v51
kvattn_kernel_gpu4:
  s_bitcmp1_b32 s61, 5
  s_cbranch_scc0 kvattn_kernel_gpu5
  v_lshlrev_b32 v168, 16, v52
  v_and_b32 v169, 0xffff0000, v52
  v_lshlrev_b32 v170, 16, v53
  v_and_b32 v171, 0xffff0000, v53
  v_lshlrev_b32 v172, 16, v54
  v_and_b32 v173, 0xffff0000, v54
  v_lshlrev_b32 v174, 16, v55
  v_and_b32 v175, 0xffff0000, v55
kvattn_kernel_gpu5:
  s_bitcmp1_b32 s61, 6
  s_cbranch_scc0 kvattn_kernel_gpu6
  v_lshlrev_b32 v176, 16, v56
  v_and_b32 v177, 0xffff0000, v56
  v_lshlrev_b32 v178, 16, v57
  v_and_b32 v179, 0xffff0000, v57
  v_lshlrev_b32 v180, 16, v58
  v_and_b32 v181, 0xffff0000, v58
  v_lshlrev_b32 v182, 16, v59
  v_and_b32 v183, 0xffff0000, v59
kvattn_kernel_gpu6:
  s_bitcmp1_b32 s61, 7
  s_cbranch_scc0 kvattn_kernel_gpu7
  v_lshlrev_b32 v184, 16, v60
  v_and_b32 v185, 0xffff0000, v60
  v_lshlrev_b32 v186, 16, v61
  v_and_b32 v187, 0xffff0000, v61
  v_lshlrev_b32 v188, 16, v62
  v_and_b32 v189, 0xffff0000, v62
  v_lshlrev_b32 v190, 16, v63
  v_and_b32 v191, 0xffff0000, v63
kvattn_kernel_gpu7:
kvattn_kernel_gpo_2:
  v_cmp_eq_u32 vcc, s85, v3
  s_cmp_ge_u32 s62, 0x40000
  s_cselect_b32 s61, -1, vcc_lo
  s_and_b32 s61, s61, s60
  s_cbranch_scc0 kvattn_kernel_gpo_1
kvattn_kernel_gpo_3:
  s_bitcmp1_b32 s61, 0
  s_cbranch_scc0 kvattn_kernel_gpl0
  s_add_u32 s19, s41, 0
  buffer_load_dwordx4 v[32:35], v22, s[24:27], s19 offen sc1
kvattn_kernel_gpl0:
  s_bitcmp1_b32 s61, 1
  s_cbranch_scc0 kvattn_kernel_gpl1
  s_add_u32 s19, s41, 32768
  buffer_load_dwordx4 v[36:39], v22, s[24:27], s19 offen sc1
kvattn_kernel_gpl1:
  s_bitcmp1_b32 s61, 2
  s_cbranch_scc0 kvattn_kernel_gpl2
  s_add_u32 s19, s41, 65536
  buffer_load_dwordx4 v[40:43], v22, s[24:27], s19 offen sc1
kvattn_kernel_gpl2:
  s_bitcmp1_b32 s61, 3
  s_cbranch_scc0 kvattn_kernel_gpl3
  s_add_u32 s19, s41, 98304
  buffer_load_dwordx4 v[44:47], v22, s[24:27], s19 offen sc1
kvattn_kernel_gpl3:
  s_bitcmp1_b32 s61, 4
  s_cbranch_scc0 kvattn_kernel_gpl4
  s_add_u32 s19, s41, 131072
  buffer_load_dwordx4 v[48:51], v22, s[24:27], s19 offen sc1
kvattn_kernel_gpl4:
  s_bitcmp1_b32 s61, 5
  s_cbranch_scc0 kvattn_kernel_gpl5
  s_add_u32 s19, s41, 163840
  buffer_load_dwordx4 v[52:55], v22, s[24:27], s19 offen sc1
kvattn_kernel_gpl5:
  s_bitcmp1_b32 s61, 6
  s_cbranch_scc0 kvattn_kernel_gpl6
  s_add_u32 s19, s41, 196608
  buffer_load_dwordx4 v[56:59], v22, s[24:27], s19 offen sc1
kvattn_kernel_gpl6:
  s_bitcmp1_b32 s61, 7
  s_cbranch_scc0 kvattn_kernel_gpl7
  s_add_u32 s19, s41, 229376
  buffer_load_dwordx4 v[60:63], v22, s[24:27], s19 offen sc1
kvattn_kernel_gpl7:
  s_andn2_b32 s60, s60, s61
  s_cbranch_scc1 kvattn_kernel_gpo_1
  s_cmp_ge_u32 s2, 224
  s_cbranch_scc1 kvattn_kernel_ti2s
  s_add_u32 m0, s36, 32768
  s_add_u32 s37, s35, 458752
  buffer_load_dwordx4 v12, s[20:23], s37 offen lds
  s_add_u32 m0, s36, 40960
  s_add_u32 s37, s35, 458752
  buffer_load_dwordx4 v12, s[28:31], s37 offen lds
  s_add_u32 m0, s36, 49152
  s_add_u32 s37, s35, 688128
  buffer_load_dwordx4 v12, s[20:23], s37 offen lds
  s_add_u32 m0, s36, 57344
  s_add_u32 s37, s35, 688128
  buffer_load_dwordx4 v12, s[28:31], s37 offen lds
  s_add_u32 m0, s36, 65536
  s_add_u32 s37, s35, 917504
  buffer_load_dwordx4 v12, s[20:23], s37 offen lds
  s_add_u32 m0, s36, 73728
  s_add_u32 s37, s35, 917504
  buffer_load_dwordx4 v12, s[28:31], s37 offen lds
  s_add_u32 m0, s36, 81920
  s_add_u32 s37, s35, 1146880
  buffer_load_dwordx4 v12, s[20:23], s37 offen lds
  s_add_u32 m0, s36, 90112
  s_add_u32 s37, s35, 1146880
  buffer_load_dwordx4 v12, s[28:31], s37 offen lds
  s_add_u32 m0, s36, 98304
  s_add_u32 s37, s35, 1376256
  buffer_load_dwordx4 v12, s[20:23], s37 offen lds
  s_add_u32 m0, s36, 106496
  s_add_u32 s37, s35, 1376256
  buffer_load_dwordx4 v12, s[28:31], s37 offen lds
  s_add_u32 m0, s36, 114688
  s_add_u32 s37, s35, 1605632
  buffer_load_dwordx4 v12, s[20:23], s37 offen lds
  s_add_u32 m0, s36, 122880
  s_add_u32 s37, s35, 1605632
  buffer_load_dwordx4 v12, s[28:31], s37 offen lds
  s_branch kvattn_kernel_tj2s
kvattn_kernel_ti2s:
  s_waitcnt vmcnt(0)
kvattn_kernel_tj2s:
  s_waitcnt vmcnt(12)
  s_bitcmp1_b32 s61, 0
  s_cbranch_scc0 kvattn_kernel_gpv0
  v_lshlrev_b32 v88, 16, v32
  v_and_b32 v89, 0xffff0000, v32
  v_lshlrev_b32 v90, 16, v33
  v_and_b32 v91, 0xffff0000, v33
  v_lshlrev_b32 v92, 16, v34
  v_and_b32 v93, 0xffff0000, v34
  v_lshlrev_b32 v94, 16, v35
  v_and_b32 v95, 0xffff0000, v35
kvattn_kernel_gpv0:
  s_bitcmp1_b32 s61, 1
  s_cbranch_scc0 kvattn_kernel_gpv1
  v_lshlrev_b32 v136, 16, v36
  v_and_b32 v137, 0xffff0000, v36
  v_lshlrev_b32 v138, 16, v37
  v_and_b32 v139, 0xffff0000, v37
  v_lshlrev_b32 v140, 16, v38
  v_and_b32 v141, 0xffff0000, v38
  v_lshlrev_b32 v142, 16, v39
  v_and_b32 v143, 0xffff0000, v39
kvattn_kernel_gpv1:
  s_bitcmp1_b32 s61, 2
  s_cbranch_scc0 kvattn_kernel_gpv2
  v_lshlrev_b32 v144, 16, v40
  v_and_b32 v145, 0xffff0000, v40
  v_lshlrev_b32 v146, 16, v41
  v_and_b32 v147, 0xffff0000, v41
  v_lshlrev_b32 v148, 16, v42
  v_and_b32 v149, 0xffff0000, v42
  v_lshlrev_b32 v150, 16, v43
  v_and_b32 v151, 0xffff0000, v43
kvattn_kernel_gpv2:
  s_bitcmp1_b32 s61, 3
  s_cbranch_scc0 kvattn_kernel_gpv3
  v_lshlrev_b32 v152, 16, v44
  v_and_b32 v153, 0xffff0000, v44
  v_lshlrev_b32 v154, 16, v45
  v_and_b32 v155, 0xffff0000, v45
  v_lshlrev_b32 v156, 16, v46
  v_and_b32 v157, 0xffff0000, v46
  v_lshlrev_b32 v158, 16, v47
  v_and_b32 v159, 0xffff0000, v47
kvattn_kernel_gpv3:
  s_bitcmp1_b32 s61, 4
  s_cbranch_scc0 kvattn_kernel_gpv4
  v_lshlrev_b32 v160, 16, v48
  v_and_b32 v161, 0xffff0000, v48
  v_lshlrev_b32 v162, 16, v49
  v_and_b32 v163, 0xffff0000, v49
  v_lshlrev_b32 v164, 16, v50
  v_and_b32 v165, 0xffff0000, v50
  v_lshlrev_b32 v166, 16, v51
  v_and_b32 v167, 0xffff0000, v51
kvattn_kernel_gpv4:
  s_bitcmp1_b32 s61, 5
  s_cbranch_scc0 kvattn_kernel_gpv5
  v_lshlrev_b32 v168, 16, v52
  v_and_b32 v169, 0xffff0000, v52
  v_lshlrev_b32 v170, 16, v53
  v_and_b32 v171, 0xffff0000, v53
  v_lshlrev_b32 v172, 16, v54
  v_and_b32 v173, 0xffff0000, v54
  v_lshlrev_b32 v174, 16, v55
  v_and_b32 v175, 0xffff0000, v55
kvattn_kernel_gpv5:
  s_bitcmp1_b32 s61, 6
  s_cbranch_scc0 kvattn_kernel_gpv6
  v_lshlrev_b32 v176, 16, v56
  v_and_b32 v177, 0xffff0000, v56
  v_lshlrev_b32 v178, 16, v57
  v_and_b32 v179, 0xffff0000, v57
  v_lshlrev_b32 v180, 16, v58
  v_and_b32 v181, 0xffff0000, v58
  v_lshlrev_b32 v182, 16, v59
  v_and_b32 v183, 0xffff0000, v59
kvattn_kernel_gpv6:
  s_bitcmp1_b32 s61, 7
  s_cbranch_scc0 kvattn_kernel_gpv7
  v_lshlrev_b32 v184, 16, v60
  v_and_b32 v185, 0xffff0000, v60
  v_lshlrev_b32 v186, 16, v61
  v_and_b32 v187, 0xffff0000, v61
  v_lshlrev_b32 v188, 16, v62
  v_and_b32 v189, 0xffff0000, v62
  v_lshlrev_b32 v190, 16, v63
  v_and_b32 v191, 0xffff0000, v63
kvattn_kernel_gpv7:
  v_pk_add_f32 v[88:89], v[88:89], v[136:137]
  v_pk_add_f32 v[90:91], v[90:91], v[138:139]
  v_pk_add_f32 v[92:93], v[92:93], v[140:141]
  v_pk_add_f32 v[94:95], v[94:95], v[142:143]
  v_pk_add_f32 v[144:145], v[144:145], v[152:153]
  v_pk_add_f32 v[146:147], v[146:147], v[154:155]
  v_pk_add_f32 v[148:149], v[148:149], v[156:157]
  v_pk_add_f32 v[150:151], v[150:151], v[158:159]
  v_pk_add_f32 v[160:161], v[160:161], v[168:169]
  v_pk_add_f32 v[162:163], v[162:163], v[170:171]
  v_pk_add_f32 v[164:165], v[164:165], v[172:173]
  v_pk_add_f32 v[166:167], v[166:167], v[174:175]
  v_pk_add_f32 v[176:177], v[176:177], v[184:185]
  v_pk_add_f32 v[178:179], v[178:179], v[186:187]
  v_pk_add_f32 v[180:181], v[180:181], v[188:189]
  v_pk_add_f32 v[182:183], v[182:183], v[190:191]
  v_pk_add_f32 v[88:89], v[88:89], v[144:145]
  v_pk_add_f32 v[90:91], v[90:91], v[146:147]
  v_pk_add_f32 v[92:93], v[92:93], v[148:149]
  v_pk_add_f32 v[94:95], v[94:95], v[150:151]
  v_pk_add_f32 v[160:161], v[160:161], v[176:177]
  v_pk_add_f32 v[162:163], v[162:163], v[178:179]
  v_pk_add_f32 v[164:165], v[164:165], v[180:181]
  v_pk_add_f32 v[166:167], v[166:167], v[182:183]
  v_pk_add_f32 v[88:89], v[88:89], v[160:161]
  v_pk_add_f32 v[90:91], v[90:91], v[162:163]
  v_pk_add_f32 v[92:93], v[92:93], v[164:165]
  v_pk_add_f32 v[94:95], v[94:95], v[166:167]
  s_branch kvattn_kernel_gpr
kvattn_kernel_tspinn:
  s_mov_b32 s62, 0
kvattn_kernel_tspinn2:
  s_sleep 1
  buffer_load_dword v3, v29, s[96:99], s3 offen sc1
  s_add_u32 s62, s62, 1
  s_cmp_ge_u32 s62, 0x40000
  s_waitcnt vmcnt(0)
  s_cbranch_scc1 kvattn_kernel_treadyn
  v_cmp_ne_u32 vcc, s85, v3
  s_cbranch_vccnz kvattn_kernel_tspinn2
  s_branch kvattn_kernel_treadyn
kvattn_kernel_tsping:
  s_mov_b32 s62, 0
kvattn_kernel_tsping2:
  s_sleep 1
  buffer_load_dword v3, v29, s[96:99], s8 offen sc1
  s_add_u32 s62, s62, 1
  s_cmp_ge_u32 s62, 0x40000
  s_waitcnt vmcnt(0)
  s_cbranch_scc1 kvattn_kernel_treadyg
  v_cmp_ne_u32 vcc, s85, v3
  s_cbranch_vccnz kvattn_kernel_tsping2
  s_branch kvattn_kernel_treadyg
kvattn_kernel_lspinb:
  s_mov_b32 s62, 0
kvattn_kernel_lspinb2:
  s_sleep 1
  ds_read_b32 v11, v10 offset:4
  s_add_u32 s62, s62, 1
  s_cmp_ge_u32 s62, 0x400000
  s_cbranch_scc1 kvattn_kernel_lreadyb
  s_waitcnt lgkmcnt(0)
  v_cmp_ne_u32 vcc, s85, v11
  s_cbranch_vccnz kvattn_kernel_lspinb2
  s_branch kvattn_kernel_lreadyb
kvattn_kernel_lspinw:
  s_mov_b32 s62, 0
kvattn_kernel_lspinw2:
  s_sleep 1
  ds_read_b32 v11, v10 offset:0
  s_add_u32 s62, s62, 1
  s_cmp_ge_u32 s62, 0x400000
  s_cbranch_scc1 kvattn_kernel_lreadyw
  s_waitcnt lgkmcnt(0)
  v_cmp_ne_u32 vcc, s85, v11
  s_cbranch_vccnz kvattn_kernel_lspinw2
  s_branch kvattn_kernel_lreadyw
kvattn_kernel_done:
  s_endpgm
.section .rodata,"a"
.p2align 6
.amdhsa_kernel kvattn_kernel
  .amdhsa_next_free_vgpr 256
  .amdhsa_next_free_sgpr 102
  .amdhsa_accum_offset 256
  .amdhsa_group_segment_fixed_size 0
  .amdhsa_kernarg_size 120
  .amdhsa_user_sgpr_count 2
  .amdhsa_user_sgpr_kernarg_segment_ptr 1
  .amdhsa_system_sgpr_workgroup_id_x 1
  .amdhsa_float_denorm_mode_32 3
.end_amdhsa_kernel
```
